```python
import torch

def _softmax(x, axis=-1):
    return torch.softmax(x, dim=axis)
def _gelu(x):
    return torch.nn.functional.gelu(x, approximate="tanh")
def _silu(x):
    return torch.nn.functional.silu(x)
def _sigmoid(x):
    return torch.sigmoid(x)
def _layernorm(x, axis=-1, eps=1e-5):
    m = x.mean(dim=axis, keepdim=True)
    v = x.var(dim=axis, keepdim=True, unbiased=False)
    return (x - m) / torch.sqrt(v + eps)
def _scatter_add(tgt, idx, src, axis=0):
    return tgt.clone().index_add_(axis, idx, src)
def _segment_sum(src, seg, n):
    out = torch.zeros((n,) + src.shape[1:], dtype=src.dtype)
    return out.index_add_(0, seg, src)
def _pad(x, pw):
    flat = tuple(v for pair in reversed(pw) for v in pair)
    return torch.nn.functional.pad(x, flat)

kernel_name = 'standalone__mha_block_cached__near_ridge'

def setup_inputs():

    _w = (lambda a: (lambda t: t.to(torch.bfloat16) if t.is_floating_point() else t)(torch.as_tensor(a)))
    B, Sq, D = 8, 224, 576
    H, Sk, Dh = 32, 1024, 128
    return {
        "x": _w((lambda *s: torch.randn(*s, dtype=torch.bfloat16) * 0.8)(B, Sq, D)),
        "k_cache": _w((lambda *s: torch.randn(*s, dtype=torch.bfloat16) * 0.8)(B, H, Sk, Dh)),
        "v_cache": _w((lambda *s: torch.randn(*s, dtype=torch.bfloat16) * 0.05)(B, H, Sk, Dh)),
        "wq": _w((lambda *s: torch.randn(*s, dtype=torch.bfloat16) * 0.8)(D, H * Dh) * (D ** -0.5)),
        "wo": _w((lambda *s: torch.randn(*s, dtype=torch.bfloat16) * 0.05)(H * Dh, D) * ((H * Dh) ** -0.5)),
    }

def reference(x, k_cache, v_cache, wq, wo):
    B, Sq, D = x.shape
    H, Dh = 32, 128
    q = (lambda x, *d: x.permute(*d))((x @ wq).reshape(B, Sq, H, Dh), 0, 2, 1, 3)
    scores = torch.einsum("bhqd,bhkd->bhqk", q, k_cache) * (Dh ** -0.5)
    p = _softmax(scores, axis=-1)
    o = torch.einsum("bhqk,bhkd->bhqd", p, v_cache)
    return (lambda x, *d: x.permute(*d))(o, 0, 2, 1, 3).reshape(B, Sq, H * Dh) @ wo
```

```asm
; @launch grid=(256,1,1) block=(256,1,1) lds=163840
.amdgcn_target "amdgcn-amd-amdhsa--gfx950"
.text
.globl standalone__mha_block_cached__near_ridge_kernel
.p2align 12
.p2align 8
.type standalone__mha_block_cached__near_ridge_kernel,@function
standalone__mha_block_cached__near_ridge_kernel:
  s_cmp_ge_u32 s2, 256
  s_cbranch_scc1 A_end
  s_load_dwordx2 s[4:5], s[0:1], 0
  s_load_dwordx2 s[6:7], s[0:1], 24
  s_load_dwordx4 s[8:11], s[0:1], 8
  s_load_dwordx2 s[46:47], s[0:1], 56
  s_load_dwordx2 s[44:45], s[0:1], 32
  s_load_dwordx4 s[68:71], s[0:1], 40
  v_lshrrev_b32 v1, 6, v0
  v_and_b32 v0, 63, v0
  v_readfirstlane_b32 s28, v1
  s_bfe_u32 s31, s2, 0x20001
  s_bfe_u32 s32, s2, 0x30003
  s_lshl_b32 s31, s31, 3
  s_add_u32 s30, s31, s32
  s_andn2_b32 s31, 1, s2
  s_lshr_b32 s32, s2, 6
  s_lshl_b32 s31, s31, 2
  s_add_u32 s29, s31, s32
  s_cmp_eq_u32 s28, 3
  s_cbranch_scc1 A_W3
  s_mul_i32 s31, s28, 0x12000
  s_lshl_b32 s36, s28, 13
  s_add_u32 s39, s36, 0x20000
  s_cmp_eq_u32 s28, 2
  s_cselect_b32 s36, 0x18000, s36
  s_add_u32 s37, s36, 0x4000
  v_lshrrev_b32 v28, 3, v0
  v_mul_u32_u24 v28, 0x480, v28
  v_add_u32 v28, s31, v28
  v_and_b32 v29, 7, v0
  v_lshrrev_b32 v30, 4, v0
  v_xor_b32 v29, v29, v30
  v_xor_b32 v30, 4, v29
  v_lshl_add_u32 v29, v29, 4, v28
  v_lshl_add_u32 v30, v30, 4, v28
  v_add_u32 v64, 0, v29
  v_add_u32 v65, 0x2000, v30
  v_add_u32 v66, 0x4000, v29
  v_add_u32 v67, 0x6000, v30
  v_add_u32 v68, 0x9000, v29
  v_add_u32 v69, 0xb000, v30
  v_add_u32 v70, 0xd000, v29
  v_add_u32 v71, 0xf000, v30
  s_mul_i32 s31, s29, 0x3f000
  s_lshl_b32 s32, s30, 8
  s_sub_u32 s22, 0x480000, s32
  s_mov_b32 s23, 0x20000
  s_mov_b32 s18, 0x3f000
  s_mov_b32 s19, 0x20000
  s_and_b32 s33, s30, 7
  s_mul_i32 s33, s33, 1
  s_and_b32 s34, s29, 3
  s_mul_i32 s34, s34, 2
  s_add_u32 s33, s33, s34
  s_sub_u32 s34, s33, 9
  s_cmp_ge_u32 s33, 9
  s_cselect_b32 s33, s34, s33
  s_lshl_b32 s38, s33, 7
  s_waitcnt lgkmcnt(0)
  s_add_u32 s20, s6, s32
  s_addc_u32 s21, s7, 0
  s_add_u32 s16, s4, s31
  s_addc_u32 s17, s5, 0
  s_mov_b32 m0, s36
  s_nop 0
  buffer_load_dwordx4 v64, s[16:19], s38 offen lds
  buffer_load_dwordx4 v65, s[16:19], s38 offen offset:1024 lds
  buffer_load_dwordx4 v66, s[16:19], s38 offen offset:2048 lds
  buffer_load_dwordx4 v67, s[16:19], s38 offen offset:3072 lds
  s_add_u32 m0, s36, 0x1000
  s_nop 0
  buffer_load_dwordx4 v68, s[16:19], s38 offen lds
  buffer_load_dwordx4 v69, s[16:19], s38 offen offset:1024 lds
  buffer_load_dwordx4 v70, s[16:19], s38 offen offset:2048 lds
  buffer_load_dwordx4 v71, s[16:19], s38 offen offset:3072 lds
  s_add_u32 s38, s38, 0x80
  s_cmp_eq_u32 s38, 1152
  s_cselect_b32 s38, 0, s38
  s_bfe_u32 s33, s2, 0x30003
  s_cmp_eq_u32 s28, 1
  s_cbranch_scc1 CYCg2_1
  s_cmp_eq_u32 s28, 2
  s_cbranch_scc1 CYCg2_2
CYCg2_0:
  s_mul_i32 s33, s33, 5
  s_lshr_b32 s33, s33, 3
  s_cmp_eq_u32 s33, 1
  s_cbranch_scc1 PADA_8
  s_cmp_eq_u32 s33, 2
  s_cbranch_scc1 PADA_4
  s_cmp_eq_u32 s33, 3
  s_cbranch_scc1 PADA_12
  s_cmp_eq_u32 s33, 4
  s_cbranch_scc1 PADA_LF_TAIL
  s_branch PADA_1
CYCg2_1:
  s_mul_i32 s33, s33, 5
  s_lshr_b32 s33, s33, 3
  s_cmp_eq_u32 s33, 1
  s_cbranch_scc1 PADA_3
  s_cmp_eq_u32 s33, 2
  s_cbranch_scc1 PADA_10
  s_cmp_eq_u32 s33, 3
  s_cbranch_scc1 PADA_5
  s_cmp_eq_u32 s33, 4
  s_cbranch_scc1 PADA_14
  s_branch PADA_7
CYCg2_2:
  s_mul_i32 s33, s33, 4
  s_lshr_b32 s33, s33, 3
  s_cmp_eq_u32 s33, 1
  s_cbranch_scc1 PADA_9
  s_cmp_eq_u32 s33, 2
  s_cbranch_scc1 PADA_11
  s_cmp_eq_u32 s33, 3
  s_cbranch_scc1 PADA_13
  s_branch PADA_2
HOPRET_g2:
  s_lshl_b32 s31, s29, 5
  s_add_u32 s31, s31, s30
  s_lshr_b32 s32, s31, 14
  s_lshl_b32 s31, s31, 18
  s_add_u32 s12, s10, s31
  s_addc_u32 s13, s11, s32
  s_add_u32 s8, s8, s31
  s_addc_u32 s9, s9, s32
  s_mov_b32 s10, 0x40000
  s_mov_b32 s11, 0x20000
  s_mov_b32 s14, 0x40000
  s_mov_b32 s15, 0x20000
  s_mul_i32 s31, s29, 0x1c0000
  s_lshl_b32 s32, s30, 13
  s_add_u32 s31, s31, s32
  s_add_u32 s24, s46, s31
  s_addc_u32 s25, s47, 0
  s_sub_u32 s26, 0xe00000, s31
  s_mov_b32 s27, 0x20000
  s_mul_i32 s31, s2, 0x4800
  s_add_u32 s4, s44, s31
  s_addc_u32 s5, s45, 0
  s_mov_b32 s6, 0x4800
  s_mov_b32 s7, 0x20000
  s_mov_b32 s42, 0x44800000
  s_mov_b32 s43, 0x3e0293ee
  v_and_b32 v1, 31, v0
  v_lshrrev_b32 v14, 5, v0
  v_and_b32 v15, 3, v1
  v_lshrrev_b32 v28, 3, v1
  v_lshl_or_b32 v15, v28, 2, v15
  v_xor_b32 v15, v15, v14
  v_lshlrev_b32 v28, 8, v1
  v_xor_b32 v29, 0, v15
  v_lshl_add_u32 v2, v29, 4, v28
  v_xor_b32 v29, 2, v15
  v_lshl_add_u32 v3, v29, 4, v28
  v_xor_b32 v29, 4, v15
  v_lshl_add_u32 v4, v29, 4, v28
  v_xor_b32 v29, 6, v15
  v_lshl_add_u32 v5, v29, 4, v28
  v_xor_b32 v29, 8, v15
  v_lshl_add_u32 v6, v29, 4, v28
  v_xor_b32 v29, 10, v15
  v_lshl_add_u32 v7, v29, 4, v28
  v_xor_b32 v29, 12, v15
  v_lshl_add_u32 v8, v29, 4, v28
  v_xor_b32 v29, 14, v15
  v_lshl_add_u32 v9, v29, 4, v28
  v_and_b32 v28, 1, v0
  v_lshlrev_b32 v28, 1, v28
  v_bfe_u32 v29, v0, 1, 1
  v_or_b32 v28, v28, v29
  v_lshlrev_b32 v28, 3, v28
  v_bfe_u32 v29, v0, 4, 1
  v_lshl_or_b32 v28, v29, 5, v28
  v_bfe_u32 v29, v0, 2, 2
  v_lshl_add_u32 v30, v14, 2, v29
  v_lshl_add_u32 v30, v30, 8, v28
  v_add_u32 v30, 0x10000, v30
  v_lshl_add_u32 v31, v14, 3, v29
  v_lshl_add_u32 v31, v31, 8, v28
  v_add_u32 v31, 0x8000, v31
  v_xor_b32 v15, 0, v29
  v_lshl_add_u32 v10, v15, 6, v30
  v_lshl_add_u32 v48, v15, 6, v31
  v_xor_b32 v15, 1, v29
  v_lshl_add_u32 v11, v15, 6, v30
  v_lshl_add_u32 v49, v15, 6, v31
  v_xor_b32 v15, 2, v29
  v_lshl_add_u32 v12, v15, 6, v30
  v_lshl_add_u32 v50, v15, 6, v31
  v_xor_b32 v15, 3, v29
  v_lshl_add_u32 v13, v15, 6, v30
  v_lshl_add_u32 v51, v15, 6, v31
  v_bfe_u32 v15, v1, 1, 3
  v_xor_b32 v15, v15, v14
  v_lshlrev_b32 v28, 7, v1
  v_xor_b32 v29, 0, v15
  v_lshl_add_u32 v52, v29, 4, v28
  v_xor_b32 v29, 2, v15
  v_lshl_add_u32 v53, v29, 4, v28
  v_xor_b32 v29, 4, v15
  v_lshl_add_u32 v54, v29, 4, v28
  v_xor_b32 v29, 6, v15
  v_lshl_add_u32 v55, v29, 4, v28
  v_add_u32 v32, s36, v52
  v_add_u32 v33, s36, v53
  v_add_u32 v34, s36, v54
  v_add_u32 v35, s36, v55
  v_add_u32 v36, s37, v52
  v_add_u32 v37, s37, v53
  v_add_u32 v38, s37, v54
  v_add_u32 v39, s37, v55
  v_add_u32 v40, s39, v52
  v_add_u32 v41, s39, v53
  v_add_u32 v42, s39, v54
  v_add_u32 v43, s39, v55
  s_bfe_u32 s31, s2, 0x20001
  s_and_b32 s32, s2, 1
  s_lshl_b32 s32, s32, 2
  s_add_u32 s31, s31, s32
  s_lshr_b32 s32, s2, 3
  s_lshl_b32 s31, s31, 5
  s_add_u32 s72, s31, s32
  s_mul_i32 s32, s72, 57
  s_lshr_b32 s32, s32, 9
  s_mul_i32 s33, s32, 9
  s_sub_u32 s33, s72, s33
  s_lshl_b32 s33, s33, 7
  s_add_u32 s48, s44, s33
  s_addc_u32 s49, s45, 0
  s_sub_u32 s50, 0x480000, s33
  s_mov_b32 s51, 0x20000
  s_lshl_b32 s31, s32, 19
  s_lshl_b32 s34, s28, 16
  s_add_u32 s31, s31, s34
  s_add_u32 s52, s46, s31
  s_addc_u32 s53, s47, 0
  s_sub_u32 s54, 0xe00000, s31
  s_mov_b32 s55, 0x20000
  s_mul_i32 s31, s32, 0x12000
  s_add_u32 s31, s31, s33
  s_add_u32 s56, s68, s31
  s_addc_u32 s57, s69, 0
  s_sub_u32 s58, 0x1f8000, s31
  s_mov_b32 s59, 0x20000
  s_mov_b32 s60, s39
  s_lshl_b32 s34, s28, 2
  s_or_b32 s34, s34, 0x40000
  s_bfe_u32 s61, 0x1054, s34
  s_lshl_b32 s61, s61, 13
  s_bfe_u32 s62, 0x9dc8, s34
  s_lshl_b32 s62, s62, 13
  s_bfe_u32 s63, 0x7326, s34
  s_lshl_b32 s63, s63, 13
  s_bfe_u32 s64, 0xbafe, s34
  s_lshl_b32 s64, s64, 13
  s_mul_i32 s65, s28, 0x120000
  s_mov_b32 s46, 0x12000
  s_lshl_b32 s31, s32, 1
  s_mul_i32 s45, s31, 37
  s_lshr_b32 s45, s45, 8
  s_lshl_b32 s45, s45, 5
  s_add_u32 s31, s31, 1
  s_mul_i32 s35, s31, 37
  s_lshr_b32 s35, s35, 8
  s_lshl_b32 s35, s35, 5
  s_mov_b32 m0, s37
  s_nop 0
  buffer_load_dwordx4 v64, s[16:19], s38 offen lds
  buffer_load_dwordx4 v65, s[16:19], s38 offen offset:1024 lds
  buffer_load_dwordx4 v66, s[16:19], s38 offen offset:2048 lds
  buffer_load_dwordx4 v67, s[16:19], s38 offen offset:3072 lds
  s_add_u32 m0, s37, 0x1000
  s_nop 0
  buffer_load_dwordx4 v68, s[16:19], s38 offen lds
  buffer_load_dwordx4 v69, s[16:19], s38 offen offset:1024 lds
  buffer_load_dwordx4 v70, s[16:19], s38 offen offset:2048 lds
  buffer_load_dwordx4 v71, s[16:19], s38 offen offset:3072 lds
  s_add_u32 s38, s38, 0x80
  s_cmp_eq_u32 s38, 1152
  s_cselect_b32 s38, 0, s38
  s_bfe_u32 s33, s2, 0x30003
  s_cmp_eq_u32 s28, 1
  s_cbranch_scc1 CYCgb_1
  s_cmp_eq_u32 s28, 2
  s_cbranch_scc1 CYCgb_2
CYCgb_0:
  s_mov_b32 s40, 3
  s_mul_i32 s33, s33, 5
  s_lshr_b32 s33, s33, 3
  s_cmp_eq_u32 s33, 1
  s_cbranch_scc1 PAD_4
  s_cmp_eq_u32 s33, 2
  s_cbranch_scc1 PAD_12
  s_cmp_eq_u32 s33, 3
  s_cbranch_scc1 PAD_LF_TAIL
  s_cmp_eq_u32 s33, 4
  s_cbranch_scc1 PAD_1
  s_branch PAD_8
CYCgb_1:
  s_mov_b32 s40, 3
  s_mul_i32 s33, s33, 5
  s_lshr_b32 s33, s33, 3
  s_cmp_eq_u32 s33, 1
  s_cbranch_scc1 PAD_10
  s_cmp_eq_u32 s33, 2
  s_cbranch_scc1 PAD_5
  s_cmp_eq_u32 s33, 3
  s_cbranch_scc1 PAD_14
  s_cmp_eq_u32 s33, 4
  s_cbranch_scc1 PAD_7
  s_branch PAD_3
CYCgb_2:
  s_mov_b32 s40, 2
  s_mul_i32 s33, s33, 4
  s_lshr_b32 s33, s33, 3
  s_cmp_eq_u32 s33, 1
  s_cbranch_scc1 PAD_11
  s_cmp_eq_u32 s33, 2
  s_cbranch_scc1 PAD_13
  s_cmp_eq_u32 s33, 3
  s_cbranch_scc1 PAD_2
  s_branch PAD_9
HOPRET_gb:
  s_barrier
  ds_read_b64_tr_b16 a[128:129], v48 offset:24576
  ds_read_b64_tr_b16 a[130:131], v48 offset:25600
  ds_read_b64_tr_b16 a[132:133], v49 offset:24576
  ds_read_b64_tr_b16 a[134:135], v49 offset:25600
  ds_read_b64_tr_b16 a[136:137], v50 offset:24576
  ds_read_b64_tr_b16 a[138:139], v50 offset:25600
  ds_read_b64_tr_b16 a[140:141], v51 offset:24576
  ds_read_b64_tr_b16 a[142:143], v51 offset:25600
  ds_read_b64_tr_b16 a[144:145], v48 offset:28672
  ds_read_b64_tr_b16 a[146:147], v48 offset:29696
  ds_read_b64_tr_b16 a[148:149], v49 offset:28672
  ds_read_b64_tr_b16 a[150:151], v49 offset:29696
  ds_read_b64_tr_b16 a[152:153], v50 offset:28672
  ds_read_b64_tr_b16 a[154:155], v50 offset:29696
  ds_read_b64_tr_b16 a[156:157], v51 offset:28672
  ds_read_b64_tr_b16 a[158:159], v51 offset:29696
  s_waitcnt vmcnt(8)
  ds_read_b128 a[192:195], v32
  ds_read_b128 a[208:211], v32 offset:4096
  ds_read_b128 a[196:199], v33
  ds_read_b128 a[212:215], v33 offset:4096
  ds_read_b128 a[200:203], v34
  ds_read_b128 a[216:219], v34 offset:4096
  ds_read_b128 a[204:207], v35
  ds_read_b128 a[220:223], v35 offset:4096
  s_waitcnt lgkmcnt(0)
  s_barrier
  v_mfma_f32_32x32x16_bf16 v[128:143], a[128:131], a[192:195], 0
  ds_read_b64_tr_b16 a[160:161], v48 offset:57344
  s_mov_b32 m0, s39
  v_mfma_f32_32x32x16_bf16 v[144:159], a[132:135], a[192:195], 0
  ds_read_b64_tr_b16 a[162:163], v48 offset:58368
  ds_read_b64_tr_b16 a[164:165], v49 offset:57344
  buffer_load_dwordx4 v64, s[16:19], s38 offen lds
  v_accvgpr_write_b32 a0, 0
  v_mfma_f32_32x32x16_bf16 v[160:175], a[136:139], a[192:195], 0
  ds_read_b64_tr_b16 a[166:167], v49 offset:58368
  v_mfma_f32_32x32x16_bf16 v[176:191], a[140:143], a[192:195], 0
  ds_read_b64_tr_b16 a[168:169], v50 offset:57344
  buffer_load_dwordx4 v65, s[16:19], s38 offen offset:1024 lds
  v_accvgpr_write_b32 a1, 0
  v_mfma_f32_32x32x16_bf16 v[192:207], a[128:131], a[208:211], 0
  ds_read_b64_tr_b16 a[170:171], v50 offset:58368
  ds_read_b64_tr_b16 a[172:173], v51 offset:57344
  buffer_load_dwordx4 v66, s[16:19], s38 offen offset:2048 lds
  v_mfma_f32_32x32x16_bf16 v[208:223], a[132:135], a[208:211], 0
  ds_read_b64_tr_b16 a[174:175], v51 offset:58368
  v_accvgpr_write_b32 a2, 0
  v_mfma_f32_32x32x16_bf16 v[224:239], a[136:139], a[208:211], 0
  ds_read_b64_tr_b16 a[176:177], v48 offset:61440
  buffer_load_dwordx4 v67, s[16:19], s38 offen offset:3072 lds
  v_mfma_f32_32x32x16_bf16 v[240:255], a[140:143], a[208:211], 0
  ds_read_b64_tr_b16 a[178:179], v48 offset:62464
  ds_read_b64_tr_b16 a[180:181], v49 offset:61440
  s_add_u32 m0, s39, 0x1000
  v_accvgpr_write_b32 a3, 0
  v_mfma_f32_32x32x16_bf16 v[128:143], a[144:147], a[196:199], v[128:143]
  ds_read_b64_tr_b16 a[182:183], v49 offset:62464
  buffer_load_dwordx4 v68, s[16:19], s38 offen lds
  v_mfma_f32_32x32x16_bf16 v[144:159], a[148:151], a[196:199], v[144:159]
  ds_read_b64_tr_b16 a[184:185], v50 offset:61440
  v_accvgpr_write_b32 a4, 0
  v_mfma_f32_32x32x16_bf16 v[160:175], a[152:155], a[196:199], v[160:175]
  ds_read_b64_tr_b16 a[186:187], v50 offset:62464
  ds_read_b64_tr_b16 a[188:189], v51 offset:61440
  buffer_load_dwordx4 v69, s[16:19], s38 offen offset:1024 lds
  v_mfma_f32_32x32x16_bf16 v[176:191], a[156:159], a[196:199], v[176:191]
  ds_read_b64_tr_b16 a[190:191], v51 offset:62464
  v_accvgpr_write_b32 a5, 0
  v_mfma_f32_32x32x16_bf16 v[192:207], a[144:147], a[212:215], v[192:207]
  buffer_load_dwordx4 v70, s[16:19], s38 offen offset:2048 lds
  v_mfma_f32_32x32x16_bf16 v[208:223], a[148:151], a[212:215], v[208:223]
  buffer_load_dwordx4 v71, s[16:19], s38 offen offset:3072 lds
  v_accvgpr_write_b32 a6, 0
  v_mfma_f32_32x32x16_bf16 v[224:239], a[152:155], a[212:215], v[224:239]
  s_add_u32 s38, s38, 0x80
  v_mfma_f32_32x32x16_bf16 v[240:255], a[156:159], a[212:215], v[240:255]
  s_cmp_eq_u32 s38, 1152
  s_cselect_b32 s38, 0, s38
  v_accvgpr_write_b32 a7, 0
  s_waitcnt lgkmcnt(0)
  s_barrier
  v_mfma_f32_32x32x16_bf16 v[128:143], a[160:163], a[200:203], v[128:143]
  ds_read_b64_tr_b16 a[128:129], v48
  s_mov_b32 m0, s36
  v_mfma_f32_32x32x16_bf16 v[144:159], a[164:167], a[200:203], v[144:159]
  ds_read_b64_tr_b16 a[130:131], v48 offset:1024
  ds_read_b64_tr_b16 a[132:133], v49
  buffer_load_dwordx4 v64, s[16:19], s38 offen lds
  v_accvgpr_write_b32 a8, 0
  v_mfma_f32_32x32x16_bf16 v[160:175], a[168:171], a[200:203], v[160:175]
  ds_read_b64_tr_b16 a[134:135], v49 offset:1024
  v_mfma_f32_32x32x16_bf16 v[176:191], a[172:175], a[200:203], v[176:191]
  ds_read_b64_tr_b16 a[136:137], v50
  buffer_load_dwordx4 v65, s[16:19], s38 offen offset:1024 lds
  v_accvgpr_write_b32 a9, 0
  v_mfma_f32_32x32x16_bf16 v[192:207], a[160:163], a[216:219], v[192:207]
  ds_read_b64_tr_b16 a[138:139], v50 offset:1024
  ds_read_b64_tr_b16 a[140:141], v51
  buffer_load_dwordx4 v66, s[16:19], s38 offen offset:2048 lds
  v_mfma_f32_32x32x16_bf16 v[208:223], a[164:167], a[216:219], v[208:223]
  ds_read_b64_tr_b16 a[142:143], v51 offset:1024
  v_accvgpr_write_b32 a10, 0
  v_mfma_f32_32x32x16_bf16 v[224:239], a[168:171], a[216:219], v[224:239]
  ds_read_b64_tr_b16 a[144:145], v48 offset:4096
  buffer_load_dwordx4 v67, s[16:19], s38 offen offset:3072 lds
  s_waitcnt vmcnt(12)
  ds_read_b128 a[224:227], v36
  v_mfma_f32_32x32x16_bf16 v[240:255], a[172:175], a[216:219], v[240:255]
  ds_read_b64_tr_b16 a[146:147], v48 offset:5120
  ds_read_b64_tr_b16 a[148:149], v49 offset:4096
  s_add_u32 m0, s36, 0x1000
  ds_read_b128 a[240:243], v36 offset:4096
  ds_read_b128 a[228:231], v37
  v_accvgpr_write_b32 a11, 0
  v_mfma_f32_32x32x16_bf16 v[128:143], a[176:179], a[204:207], v[128:143]
  ds_read_b64_tr_b16 a[150:151], v49 offset:5120
  buffer_load_dwordx4 v68, s[16:19], s38 offen lds
  ds_read_b128 a[244:247], v37 offset:4096
  v_mfma_f32_32x32x16_bf16 v[144:159], a[180:183], a[204:207], v[144:159]
  ds_read_b64_tr_b16 a[152:153], v50 offset:4096
  ds_read_b128 a[232:235], v38
  v_accvgpr_write_b32 a12, 0
  v_mfma_f32_32x32x16_bf16 v[160:175], a[184:187], a[204:207], v[160:175]
  ds_read_b64_tr_b16 a[154:155], v50 offset:5120
  ds_read_b64_tr_b16 a[156:157], v51 offset:4096
  buffer_load_dwordx4 v69, s[16:19], s38 offen offset:1024 lds
  ds_read_b128 a[248:251], v38 offset:4096
  ds_read_b128 a[236:239], v39
  v_mfma_f32_32x32x16_bf16 v[176:191], a[188:191], a[204:207], v[176:191]
  ds_read_b64_tr_b16 a[158:159], v51 offset:5120
  ds_read_b128 a[252:255], v39 offset:4096
  v_accvgpr_write_b32 a13, 0
  v_mfma_f32_32x32x16_bf16 v[192:207], a[176:179], a[220:223], v[192:207]
  buffer_load_dwordx4 v70, s[16:19], s38 offen offset:2048 lds
  v_mfma_f32_32x32x16_bf16 v[208:223], a[180:183], a[220:223], v[208:223]
  buffer_load_dwordx4 v71, s[16:19], s38 offen offset:3072 lds
  v_accvgpr_write_b32 a14, 0
  v_mfma_f32_32x32x16_bf16 v[224:239], a[184:187], a[220:223], v[224:239]
  s_add_u32 s38, s38, 0x80
  v_mfma_f32_32x32x16_bf16 v[240:255], a[188:191], a[220:223], v[240:255]
  s_cmp_eq_u32 s38, 1152
  s_cselect_b32 s38, 0, s38
  v_accvgpr_write_b32 a15, 0
  s_waitcnt lgkmcnt(0)
  s_barrier
  v_mfma_f32_32x32x16_bf16 v[128:143], a[128:131], a[224:227], v[128:143]
  ds_read_b64_tr_b16 a[160:161], v48 offset:32768
  v_mfma_f32_32x32x16_bf16 v[144:159], a[132:135], a[224:227], v[144:159]
  ds_read_b64_tr_b16 a[162:163], v48 offset:33792
  ds_read_b64_tr_b16 a[164:165], v49 offset:32768
  v_accvgpr_write_b32 a16, 0
  v_mfma_f32_32x32x16_bf16 v[160:175], a[136:139], a[224:227], v[160:175]
  ds_read_b64_tr_b16 a[166:167], v49 offset:33792
  v_mfma_f32_32x32x16_bf16 v[176:191], a[140:143], a[224:227], v[176:191]
  ds_read_b64_tr_b16 a[168:169], v50 offset:32768
  v_accvgpr_write_b32 a17, 0
  v_mfma_f32_32x32x16_bf16 v[192:207], a[128:131], a[240:243], v[192:207]
  ds_read_b64_tr_b16 a[170:171], v50 offset:33792
  ds_read_b64_tr_b16 a[172:173], v51 offset:32768
  v_mfma_f32_32x32x16_bf16 v[208:223], a[132:135], a[240:243], v[208:223]
  ds_read_b64_tr_b16 a[174:175], v51 offset:33792
  v_accvgpr_write_b32 a18, 0
  v_mfma_f32_32x32x16_bf16 v[224:239], a[136:139], a[240:243], v[224:239]
  ds_read_b64_tr_b16 a[176:177], v48 offset:36864
  v_mfma_f32_32x32x16_bf16 v[240:255], a[140:143], a[240:243], v[240:255]
  ds_read_b64_tr_b16 a[178:179], v48 offset:37888
  ds_read_b64_tr_b16 a[180:181], v49 offset:36864
  v_accvgpr_write_b32 a19, 0
  v_mfma_f32_32x32x16_bf16 v[128:143], a[144:147], a[228:231], v[128:143]
  ds_read_b64_tr_b16 a[182:183], v49 offset:37888
  v_mfma_f32_32x32x16_bf16 v[144:159], a[148:151], a[228:231], v[144:159]
  ds_read_b64_tr_b16 a[184:185], v50 offset:36864
  v_accvgpr_write_b32 a20, 0
  v_mfma_f32_32x32x16_bf16 v[160:175], a[152:155], a[228:231], v[160:175]
  ds_read_b64_tr_b16 a[186:187], v50 offset:37888
  ds_read_b64_tr_b16 a[188:189], v51 offset:36864
  v_mfma_f32_32x32x16_bf16 v[176:191], a[156:159], a[228:231], v[176:191]
  ds_read_b64_tr_b16 a[190:191], v51 offset:37888
  v_accvgpr_write_b32 a21, 0
  v_mfma_f32_32x32x16_bf16 v[192:207], a[144:147], a[244:247], v[192:207]
  v_mfma_f32_32x32x16_bf16 v[208:223], a[148:151], a[244:247], v[208:223]
  v_accvgpr_write_b32 a22, 0
  v_mfma_f32_32x32x16_bf16 v[224:239], a[152:155], a[244:247], v[224:239]
  v_mfma_f32_32x32x16_bf16 v[240:255], a[156:159], a[244:247], v[240:255]
  v_accvgpr_write_b32 a23, 0
  s_waitcnt lgkmcnt(0)
  s_barrier
  v_mfma_f32_32x32x16_bf16 v[128:143], a[160:163], a[232:235], v[128:143]
  ds_read_b64_tr_b16 a[128:129], v48 offset:8192
  s_mov_b32 m0, s37
  v_mfma_f32_32x32x16_bf16 v[144:159], a[164:167], a[232:235], v[144:159]
  ds_read_b64_tr_b16 a[130:131], v48 offset:9216
  ds_read_b64_tr_b16 a[132:133], v49 offset:8192
  buffer_load_dwordx4 v64, s[16:19], s38 offen lds
  v_accvgpr_write_b32 a24, 0
  v_mfma_f32_32x32x16_bf16 v[160:175], a[168:171], a[232:235], v[160:175]
  ds_read_b64_tr_b16 a[134:135], v49 offset:9216
  v_mfma_f32_32x32x16_bf16 v[176:191], a[172:175], a[232:235], v[176:191]
  ds_read_b64_tr_b16 a[136:137], v50 offset:8192
  buffer_load_dwordx4 v65, s[16:19], s38 offen offset:1024 lds
  v_accvgpr_write_b32 a25, 0
  v_mfma_f32_32x32x16_bf16 v[192:207], a[160:163], a[248:251], v[192:207]
  ds_read_b64_tr_b16 a[138:139], v50 offset:9216
  ds_read_b64_tr_b16 a[140:141], v51 offset:8192
  buffer_load_dwordx4 v66, s[16:19], s38 offen offset:2048 lds
  v_mfma_f32_32x32x16_bf16 v[208:223], a[164:167], a[248:251], v[208:223]
  ds_read_b64_tr_b16 a[142:143], v51 offset:9216
  v_accvgpr_write_b32 a26, 0
  s_branch PADO_1
PADA_1:
  s_branch HOPRET_g2
PAD_1:
  s_sub_u32 s40, s40, 1
  s_cbranch_scc1 HOPRET_gb
  s_branch PAD_8
PADO_1:
  v_mfma_f32_32x32x16_bf16 v[224:239], a[168:171], a[248:251], v[224:239]
  ds_read_b64_tr_b16 a[144:145], v48 offset:12288
  buffer_load_dwordx4 v67, s[16:19], s38 offen offset:3072 lds
  s_waitcnt vmcnt(12)
  ds_read_b128 a[192:195], v40
  v_mfma_f32_32x32x16_bf16 v[240:255], a[172:175], a[248:251], v[240:255]
  ds_read_b64_tr_b16 a[146:147], v48 offset:13312
  ds_read_b64_tr_b16 a[148:149], v49 offset:12288
  s_add_u32 m0, s37, 0x1000
  ds_read_b128 a[208:211], v40 offset:4096
  ds_read_b128 a[196:199], v41
  v_accvgpr_write_b32 a27, 0
  v_mfma_f32_32x32x16_bf16 v[128:143], a[176:179], a[236:239], v[128:143]
  ds_read_b64_tr_b16 a[150:151], v49 offset:13312
  buffer_load_dwordx4 v68, s[16:19], s38 offen lds
  ds_read_b128 a[212:215], v41 offset:4096
  v_mfma_f32_32x32x16_bf16 v[144:159], a[180:183], a[236:239], v[144:159]
  ds_read_b64_tr_b16 a[152:153], v50 offset:12288
  ds_read_b128 a[200:203], v42
  v_accvgpr_write_b32 a28, 0
  v_mfma_f32_32x32x16_bf16 v[160:175], a[184:187], a[236:239], v[160:175]
  ds_read_b64_tr_b16 a[154:155], v50 offset:13312
  ds_read_b64_tr_b16 a[156:157], v51 offset:12288
  buffer_load_dwordx4 v69, s[16:19], s38 offen offset:1024 lds
  ds_read_b128 a[216:219], v42 offset:4096
  ds_read_b128 a[204:207], v43
  v_mfma_f32_32x32x16_bf16 v[176:191], a[188:191], a[236:239], v[176:191]
  ds_read_b64_tr_b16 a[158:159], v51 offset:13312
  ds_read_b128 a[220:223], v43 offset:4096
  v_accvgpr_write_b32 a29, 0
  v_mfma_f32_32x32x16_bf16 v[192:207], a[176:179], a[252:255], v[192:207]
  buffer_load_dwordx4 v70, s[16:19], s38 offen offset:2048 lds
  v_mfma_f32_32x32x16_bf16 v[208:223], a[180:183], a[252:255], v[208:223]
  buffer_load_dwordx4 v71, s[16:19], s38 offen offset:3072 lds
  v_accvgpr_write_b32 a30, 0
  v_mfma_f32_32x32x16_bf16 v[224:239], a[184:187], a[252:255], v[224:239]
  s_add_u32 s38, s38, 0x80
  v_mfma_f32_32x32x16_bf16 v[240:255], a[188:191], a[252:255], v[240:255]
  s_cmp_eq_u32 s38, 1152
  s_cselect_b32 s38, 0, s38
  v_accvgpr_write_b32 a31, 0
  s_waitcnt lgkmcnt(0)
  s_barrier
  v_mfma_f32_32x32x16_bf16 v[128:143], a[128:131], a[192:195], v[128:143]
  ds_read_b64_tr_b16 a[160:161], v48 offset:40960
  s_mov_b32 m0, s39
  v_mfma_f32_32x32x16_bf16 v[144:159], a[132:135], a[192:195], v[144:159]
  ds_read_b64_tr_b16 a[162:163], v48 offset:41984
  ds_read_b64_tr_b16 a[164:165], v49 offset:40960
  buffer_load_dwordx4 v64, s[16:19], s38 offen lds
  v_accvgpr_write_b32 a32, 0
  v_mfma_f32_32x32x16_bf16 v[160:175], a[136:139], a[192:195], v[160:175]
  ds_read_b64_tr_b16 a[166:167], v49 offset:41984
  v_mfma_f32_32x32x16_bf16 v[176:191], a[140:143], a[192:195], v[176:191]
  ds_read_b64_tr_b16 a[168:169], v50 offset:40960
  buffer_load_dwordx4 v65, s[16:19], s38 offen offset:1024 lds
  v_accvgpr_write_b32 a33, 0
  v_mfma_f32_32x32x16_bf16 v[192:207], a[128:131], a[208:211], v[192:207]
  ds_read_b64_tr_b16 a[170:171], v50 offset:41984
  ds_read_b64_tr_b16 a[172:173], v51 offset:40960
  buffer_load_dwordx4 v66, s[16:19], s38 offen offset:2048 lds
  v_mfma_f32_32x32x16_bf16 v[208:223], a[132:135], a[208:211], v[208:223]
  ds_read_b64_tr_b16 a[174:175], v51 offset:41984
  v_accvgpr_write_b32 a34, 0
  v_mfma_f32_32x32x16_bf16 v[224:239], a[136:139], a[208:211], v[224:239]
  ds_read_b64_tr_b16 a[176:177], v48 offset:45056
  buffer_load_dwordx4 v67, s[16:19], s38 offen offset:3072 lds
  v_mfma_f32_32x32x16_bf16 v[240:255], a[140:143], a[208:211], v[240:255]
  ds_read_b64_tr_b16 a[178:179], v48 offset:46080
  ds_read_b64_tr_b16 a[180:181], v49 offset:45056
  s_add_u32 m0, s39, 0x1000
  v_accvgpr_write_b32 a35, 0
  v_mfma_f32_32x32x16_bf16 v[128:143], a[144:147], a[196:199], v[128:143]
  ds_read_b64_tr_b16 a[182:183], v49 offset:46080
  buffer_load_dwordx4 v68, s[16:19], s38 offen lds
  v_mfma_f32_32x32x16_bf16 v[144:159], a[148:151], a[196:199], v[144:159]
  ds_read_b64_tr_b16 a[184:185], v50 offset:45056
  v_accvgpr_write_b32 a36, 0
  v_mfma_f32_32x32x16_bf16 v[160:175], a[152:155], a[196:199], v[160:175]
  ds_read_b64_tr_b16 a[186:187], v50 offset:46080
  ds_read_b64_tr_b16 a[188:189], v51 offset:45056
  buffer_load_dwordx4 v69, s[16:19], s38 offen offset:1024 lds
  v_mfma_f32_32x32x16_bf16 v[176:191], a[156:159], a[196:199], v[176:191]
  ds_read_b64_tr_b16 a[190:191], v51 offset:46080
  v_accvgpr_write_b32 a37, 0
  v_mfma_f32_32x32x16_bf16 v[192:207], a[144:147], a[212:215], v[192:207]
  buffer_load_dwordx4 v70, s[16:19], s38 offen offset:2048 lds
  v_mfma_f32_32x32x16_bf16 v[208:223], a[148:151], a[212:215], v[208:223]
  buffer_load_dwordx4 v71, s[16:19], s38 offen offset:3072 lds
  v_accvgpr_write_b32 a38, 0
  v_mfma_f32_32x32x16_bf16 v[224:239], a[152:155], a[212:215], v[224:239]
  s_add_u32 s38, s38, 0x80
  v_mfma_f32_32x32x16_bf16 v[240:255], a[156:159], a[212:215], v[240:255]
  s_cmp_eq_u32 s38, 1152
  s_cselect_b32 s38, 0, s38
  v_accvgpr_write_b32 a39, 0
  s_waitcnt lgkmcnt(0)
  s_barrier
  v_mfma_f32_32x32x16_bf16 v[128:143], a[160:163], a[200:203], v[128:143]
  ds_read_b64_tr_b16 a[128:129], v48 offset:16384
  v_mfma_f32_32x32x16_bf16 v[144:159], a[164:167], a[200:203], v[144:159]
  ds_read_b64_tr_b16 a[130:131], v48 offset:17408
  ds_read_b64_tr_b16 a[132:133], v49 offset:16384
  v_accvgpr_write_b32 a40, 0
  v_mfma_f32_32x32x16_bf16 v[160:175], a[168:171], a[200:203], v[160:175]
  ds_read_b64_tr_b16 a[134:135], v49 offset:17408
  v_mfma_f32_32x32x16_bf16 v[176:191], a[172:175], a[200:203], v[176:191]
  ds_read_b64_tr_b16 a[136:137], v50 offset:16384
  v_accvgpr_write_b32 a41, 0
  v_mfma_f32_32x32x16_bf16 v[192:207], a[160:163], a[216:219], v[192:207]
  ds_read_b64_tr_b16 a[138:139], v50 offset:17408
  ds_read_b64_tr_b16 a[140:141], v51 offset:16384
  v_mfma_f32_32x32x16_bf16 v[208:223], a[164:167], a[216:219], v[208:223]
  ds_read_b64_tr_b16 a[142:143], v51 offset:17408
  v_accvgpr_write_b32 a42, 0
  v_mfma_f32_32x32x16_bf16 v[224:239], a[168:171], a[216:219], v[224:239]
  ds_read_b64_tr_b16 a[144:145], v48 offset:20480
  s_waitcnt vmcnt(16)
  ds_read_b128 a[224:227], v32
  v_mfma_f32_32x32x16_bf16 v[240:255], a[172:175], a[216:219], v[240:255]
  ds_read_b64_tr_b16 a[146:147], v48 offset:21504
  ds_read_b64_tr_b16 a[148:149], v49 offset:20480
  ds_read_b128 a[240:243], v32 offset:4096
  ds_read_b128 a[228:231], v33
  v_accvgpr_write_b32 a43, 0
  v_mfma_f32_32x32x16_bf16 v[128:143], a[176:179], a[204:207], v[128:143]
  ds_read_b64_tr_b16 a[150:151], v49 offset:21504
  ds_read_b128 a[244:247], v33 offset:4096
  v_mfma_f32_32x32x16_bf16 v[144:159], a[180:183], a[204:207], v[144:159]
  ds_read_b64_tr_b16 a[152:153], v50 offset:20480
  ds_read_b128 a[232:235], v34
  v_accvgpr_write_b32 a44, 0
  v_mfma_f32_32x32x16_bf16 v[160:175], a[184:187], a[204:207], v[160:175]
  ds_read_b64_tr_b16 a[154:155], v50 offset:21504
  ds_read_b64_tr_b16 a[156:157], v51 offset:20480
  ds_read_b128 a[248:251], v34 offset:4096
  ds_read_b128 a[236:239], v35
  v_mfma_f32_32x32x16_bf16 v[176:191], a[188:191], a[204:207], v[176:191]
  ds_read_b64_tr_b16 a[158:159], v51 offset:21504
  ds_read_b128 a[252:255], v35 offset:4096
  v_accvgpr_write_b32 a45, 0
  v_mfma_f32_32x32x16_bf16 v[192:207], a[176:179], a[220:223], v[192:207]
  v_mfma_f32_32x32x16_bf16 v[208:223], a[180:183], a[220:223], v[208:223]
  v_accvgpr_write_b32 a46, 0
  v_mfma_f32_32x32x16_bf16 v[224:239], a[184:187], a[220:223], v[224:239]
  v_mfma_f32_32x32x16_bf16 v[240:255], a[188:191], a[220:223], v[240:255]
  v_accvgpr_write_b32 a47, 0
  s_waitcnt lgkmcnt(0)
  s_barrier
  v_mfma_f32_32x32x16_bf16 v[128:143], a[128:131], a[224:227], v[128:143]
  ds_read_b64_tr_b16 a[160:161], v48 offset:49152
  s_mov_b32 m0, s36
  v_mfma_f32_32x32x16_bf16 v[144:159], a[132:135], a[224:227], v[144:159]
  ds_read_b64_tr_b16 a[162:163], v48 offset:50176
  ds_read_b64_tr_b16 a[164:165], v49 offset:49152
  buffer_load_dwordx4 v64, s[16:19], s38 offen lds
  v_accvgpr_write_b32 a48, 0
  v_mfma_f32_32x32x16_bf16 v[160:175], a[136:139], a[224:227], v[160:175]
  ds_read_b64_tr_b16 a[166:167], v49 offset:50176
  v_mfma_f32_32x32x16_bf16 v[176:191], a[140:143], a[224:227], v[176:191]
  ds_read_b64_tr_b16 a[168:169], v50 offset:49152
  buffer_load_dwordx4 v65, s[16:19], s38 offen offset:1024 lds
  v_accvgpr_write_b32 a49, 0
  v_mfma_f32_32x32x16_bf16 v[192:207], a[128:131], a[240:243], v[192:207]
  ds_read_b64_tr_b16 a[170:171], v50 offset:50176
  ds_read_b64_tr_b16 a[172:173], v51 offset:49152
  buffer_load_dwordx4 v66, s[16:19], s38 offen offset:2048 lds
  v_mfma_f32_32x32x16_bf16 v[208:223], a[132:135], a[240:243], v[208:223]
  ds_read_b64_tr_b16 a[174:175], v51 offset:50176
  v_accvgpr_write_b32 a50, 0
  v_mfma_f32_32x32x16_bf16 v[224:239], a[136:139], a[240:243], v[224:239]
  ds_read_b64_tr_b16 a[176:177], v48 offset:53248
  buffer_load_dwordx4 v67, s[16:19], s38 offen offset:3072 lds
  v_mfma_f32_32x32x16_bf16 v[240:255], a[140:143], a[240:243], v[240:255]
  ds_read_b64_tr_b16 a[178:179], v48 offset:54272
  ds_read_b64_tr_b16 a[180:181], v49 offset:53248
  s_add_u32 m0, s36, 0x1000
  v_accvgpr_write_b32 a51, 0
  v_mfma_f32_32x32x16_bf16 v[128:143], a[144:147], a[228:231], v[128:143]
  ds_read_b64_tr_b16 a[182:183], v49 offset:54272
  buffer_load_dwordx4 v68, s[16:19], s38 offen lds
  v_mfma_f32_32x32x16_bf16 v[144:159], a[148:151], a[228:231], v[144:159]
  ds_read_b64_tr_b16 a[184:185], v50 offset:53248
  v_accvgpr_write_b32 a52, 0
  v_mfma_f32_32x32x16_bf16 v[160:175], a[152:155], a[228:231], v[160:175]
  ds_read_b64_tr_b16 a[186:187], v50 offset:54272
  ds_read_b64_tr_b16 a[188:189], v51 offset:53248
  buffer_load_dwordx4 v69, s[16:19], s38 offen offset:1024 lds
  v_mfma_f32_32x32x16_bf16 v[176:191], a[156:159], a[228:231], v[176:191]
  ds_read_b64_tr_b16 a[190:191], v51 offset:54272
  v_accvgpr_write_b32 a53, 0
  v_mfma_f32_32x32x16_bf16 v[192:207], a[144:147], a[244:247], v[192:207]
  buffer_load_dwordx4 v70, s[16:19], s38 offen offset:2048 lds
  v_mfma_f32_32x32x16_bf16 v[208:223], a[148:151], a[244:247], v[208:223]
  buffer_load_dwordx4 v71, s[16:19], s38 offen offset:3072 lds
  v_accvgpr_write_b32 a54, 0
  v_mfma_f32_32x32x16_bf16 v[224:239], a[152:155], a[244:247], v[224:239]
  s_add_u32 s38, s38, 0x80
  v_mfma_f32_32x32x16_bf16 v[240:255], a[156:159], a[244:247], v[240:255]
  s_cmp_eq_u32 s38, 1152
  s_cselect_b32 s38, 0, s38
  v_accvgpr_write_b32 a55, 0
  s_waitcnt lgkmcnt(0)
  s_barrier
  v_mfma_f32_32x32x16_bf16 v[128:143], a[160:163], a[232:235], v[128:143]
  ds_read_b64_tr_b16 a[128:129], v48 offset:24576
  v_mfma_f32_32x32x16_bf16 v[144:159], a[164:167], a[232:235], v[144:159]
  ds_read_b64_tr_b16 a[130:131], v48 offset:25600
  ds_read_b64_tr_b16 a[132:133], v49 offset:24576
  v_accvgpr_write_b32 a56, 0
  v_mfma_f32_32x32x16_bf16 v[160:175], a[168:171], a[232:235], v[160:175]
  ds_read_b64_tr_b16 a[134:135], v49 offset:25600
  v_mfma_f32_32x32x16_bf16 v[176:191], a[172:175], a[232:235], v[176:191]
  ds_read_b64_tr_b16 a[136:137], v50 offset:24576
  v_accvgpr_write_b32 a57, 0
  v_mfma_f32_32x32x16_bf16 v[192:207], a[160:163], a[248:251], v[192:207]
  ds_read_b64_tr_b16 a[138:139], v50 offset:25600
  ds_read_b64_tr_b16 a[140:141], v51 offset:24576
  v_mfma_f32_32x32x16_bf16 v[208:223], a[164:167], a[248:251], v[208:223]
  ds_read_b64_tr_b16 a[142:143], v51 offset:25600
  v_accvgpr_write_b32 a58, 0
  v_mfma_f32_32x32x16_bf16 v[224:239], a[168:171], a[248:251], v[224:239]
  ds_read_b64_tr_b16 a[144:145], v48 offset:28672
  s_waitcnt vmcnt(16)
  ds_read_b128 a[192:195], v36
  v_mfma_f32_32x32x16_bf16 v[240:255], a[172:175], a[248:251], v[240:255]
  ds_read_b64_tr_b16 a[146:147], v48 offset:29696
  ds_read_b64_tr_b16 a[148:149], v49 offset:28672
  ds_read_b128 a[208:211], v36 offset:4096
  ds_read_b128 a[196:199], v37
  v_accvgpr_write_b32 a59, 0
  v_mfma_f32_32x32x16_bf16 v[128:143], a[176:179], a[236:239], v[128:143]
  ds_read_b64_tr_b16 a[150:151], v49 offset:29696
  ds_read_b128 a[212:215], v37 offset:4096
  v_mfma_f32_32x32x16_bf16 v[144:159], a[180:183], a[236:239], v[144:159]
  ds_read_b64_tr_b16 a[152:153], v50 offset:28672
  ds_read_b128 a[200:203], v38
  v_accvgpr_write_b32 a60, 0
  v_mfma_f32_32x32x16_bf16 v[160:175], a[184:187], a[236:239], v[160:175]
  ds_read_b64_tr_b16 a[154:155], v50 offset:29696
  ds_read_b64_tr_b16 a[156:157], v51 offset:28672
  ds_read_b128 a[216:219], v38 offset:4096
  ds_read_b128 a[204:207], v39
  v_mfma_f32_32x32x16_bf16 v[176:191], a[188:191], a[236:239], v[176:191]
  ds_read_b64_tr_b16 a[158:159], v51 offset:29696
  ds_read_b128 a[220:223], v39 offset:4096
  v_accvgpr_write_b32 a61, 0
  v_mfma_f32_32x32x16_bf16 v[192:207], a[176:179], a[252:255], v[192:207]
  v_mfma_f32_32x32x16_bf16 v[208:223], a[180:183], a[252:255], v[208:223]
  v_accvgpr_write_b32 a62, 0
  v_mfma_f32_32x32x16_bf16 v[224:239], a[184:187], a[252:255], v[224:239]
  v_mfma_f32_32x32x16_bf16 v[240:255], a[188:191], a[252:255], v[240:255]
  v_accvgpr_write_b32 a63, 0
  s_waitcnt lgkmcnt(0)
  s_barrier
  v_mfma_f32_32x32x16_bf16 v[128:143], a[128:131], a[192:195], v[128:143]
  ds_read_b64_tr_b16 a[160:161], v48 offset:57344
  s_mov_b32 m0, s37
  v_mfma_f32_32x32x16_bf16 v[144:159], a[132:135], a[192:195], v[144:159]
  ds_read_b64_tr_b16 a[162:163], v48 offset:58368
  ds_read_b64_tr_b16 a[164:165], v49 offset:57344
  buffer_load_dwordx4 v64, s[16:19], s38 offen lds
  v_accvgpr_write_b32 a64, 0
  v_mfma_f32_32x32x16_bf16 v[160:175], a[136:139], a[192:195], v[160:175]
  ds_read_b64_tr_b16 a[166:167], v49 offset:58368
  v_mfma_f32_32x32x16_bf16 v[176:191], a[140:143], a[192:195], v[176:191]
  ds_read_b64_tr_b16 a[168:169], v50 offset:57344
  buffer_load_dwordx4 v65, s[16:19], s38 offen offset:1024 lds
  v_accvgpr_write_b32 a65, 0
  v_mfma_f32_32x32x16_bf16 v[192:207], a[128:131], a[208:211], v[192:207]
  ds_read_b64_tr_b16 a[170:171], v50 offset:58368
  ds_read_b64_tr_b16 a[172:173], v51 offset:57344
  buffer_load_dwordx4 v66, s[16:19], s38 offen offset:2048 lds
  v_mfma_f32_32x32x16_bf16 v[208:223], a[132:135], a[208:211], v[208:223]
  ds_read_b64_tr_b16 a[174:175], v51 offset:58368
  v_accvgpr_write_b32 a66, 0
  v_mfma_f32_32x32x16_bf16 v[224:239], a[136:139], a[208:211], v[224:239]
  ds_read_b64_tr_b16 a[176:177], v48 offset:61440
  buffer_load_dwordx4 v67, s[16:19], s38 offen offset:3072 lds
  v_mfma_f32_32x32x16_bf16 v[240:255], a[140:143], a[208:211], v[240:255]
  ds_read_b64_tr_b16 a[178:179], v48 offset:62464
  ds_read_b64_tr_b16 a[180:181], v49 offset:61440
  s_add_u32 m0, s37, 0x1000
  v_accvgpr_write_b32 a67, 0
  v_mfma_f32_32x32x16_bf16 v[128:143], a[144:147], a[196:199], v[128:143]
  ds_read_b64_tr_b16 a[182:183], v49 offset:62464
  buffer_load_dwordx4 v68, s[16:19], s38 offen lds
  v_mfma_f32_32x32x16_bf16 v[144:159], a[148:151], a[196:199], v[144:159]
  ds_read_b64_tr_b16 a[184:185], v50 offset:61440
  v_accvgpr_write_b32 a68, 0
  v_mfma_f32_32x32x16_bf16 v[160:175], a[152:155], a[196:199], v[160:175]
  ds_read_b64_tr_b16 a[186:187], v50 offset:62464
  ds_read_b64_tr_b16 a[188:189], v51 offset:61440
  buffer_load_dwordx4 v69, s[16:19], s38 offen offset:1024 lds
  v_mfma_f32_32x32x16_bf16 v[176:191], a[156:159], a[196:199], v[176:191]
  ds_read_b64_tr_b16 a[190:191], v51 offset:62464
  v_accvgpr_write_b32 a69, 0
  v_mfma_f32_32x32x16_bf16 v[192:207], a[144:147], a[212:215], v[192:207]
  buffer_load_dwordx4 v70, s[16:19], s38 offen offset:2048 lds
  v_mfma_f32_32x32x16_bf16 v[208:223], a[148:151], a[212:215], v[208:223]
  buffer_load_dwordx4 v71, s[16:19], s38 offen offset:3072 lds
  v_accvgpr_write_b32 a70, 0
  v_mfma_f32_32x32x16_bf16 v[224:239], a[152:155], a[212:215], v[224:239]
  s_add_u32 s38, s38, 0x80
  v_mfma_f32_32x32x16_bf16 v[240:255], a[156:159], a[212:215], v[240:255]
  s_cmp_eq_u32 s38, 1152
  s_cselect_b32 s38, 0, s38
  v_accvgpr_write_b32 a71, 0
  s_waitcnt lgkmcnt(0)
  s_barrier
  v_mfma_f32_32x32x16_bf16 v[128:143], a[160:163], a[200:203], v[128:143]
  ds_read_b64_tr_b16 a[128:129], v48
  v_mfma_f32_32x32x16_bf16 v[144:159], a[164:167], a[200:203], v[144:159]
  ds_read_b64_tr_b16 a[130:131], v48 offset:1024
  ds_read_b64_tr_b16 a[132:133], v49
  v_accvgpr_write_b32 a72, 0
  v_mfma_f32_32x32x16_bf16 v[160:175], a[168:171], a[200:203], v[160:175]
  ds_read_b64_tr_b16 a[134:135], v49 offset:1024
  v_mfma_f32_32x32x16_bf16 v[176:191], a[172:175], a[200:203], v[176:191]
  ds_read_b64_tr_b16 a[136:137], v50
  v_accvgpr_write_b32 a73, 0
  v_mfma_f32_32x32x16_bf16 v[192:207], a[160:163], a[216:219], v[192:207]
  ds_read_b64_tr_b16 a[138:139], v50 offset:1024
  ds_read_b64_tr_b16 a[140:141], v51
  v_mfma_f32_32x32x16_bf16 v[208:223], a[164:167], a[216:219], v[208:223]
  ds_read_b64_tr_b16 a[142:143], v51 offset:1024
  v_accvgpr_write_b32 a74, 0
  v_mfma_f32_32x32x16_bf16 v[224:239], a[168:171], a[216:219], v[224:239]
  ds_read_b64_tr_b16 a[144:145], v48 offset:4096
  s_waitcnt vmcnt(16)
  ds_read_b128 a[224:227], v40
  v_mfma_f32_32x32x16_bf16 v[240:255], a[172:175], a[216:219], v[240:255]
  ds_read_b64_tr_b16 a[146:147], v48 offset:5120
  ds_read_b64_tr_b16 a[148:149], v49 offset:4096
  ds_read_b128 a[240:243], v40 offset:4096
  ds_read_b128 a[228:231], v41
  v_accvgpr_write_b32 a75, 0
  v_mfma_f32_32x32x16_bf16 v[128:143], a[176:179], a[204:207], v[128:143]
  ds_read_b64_tr_b16 a[150:151], v49 offset:5120
  ds_read_b128 a[244:247], v41 offset:4096
  v_mfma_f32_32x32x16_bf16 v[144:159], a[180:183], a[204:207], v[144:159]
  ds_read_b64_tr_b16 a[152:153], v50 offset:4096
  ds_read_b128 a[232:235], v42
  v_accvgpr_write_b32 a76, 0
  v_mfma_f32_32x32x16_bf16 v[160:175], a[184:187], a[204:207], v[160:175]
  ds_read_b64_tr_b16 a[154:155], v50 offset:5120
  ds_read_b64_tr_b16 a[156:157], v51 offset:4096
  ds_read_b128 a[248:251], v42 offset:4096
  ds_read_b128 a[236:239], v43
  v_mfma_f32_32x32x16_bf16 v[176:191], a[188:191], a[204:207], v[176:191]
  ds_read_b64_tr_b16 a[158:159], v51 offset:5120
  ds_read_b128 a[252:255], v43 offset:4096
  v_accvgpr_write_b32 a77, 0
  v_mfma_f32_32x32x16_bf16 v[192:207], a[176:179], a[220:223], v[192:207]
  v_mfma_f32_32x32x16_bf16 v[208:223], a[180:183], a[220:223], v[208:223]
  v_accvgpr_write_b32 a78, 0
  v_mfma_f32_32x32x16_bf16 v[224:239], a[184:187], a[220:223], v[224:239]
  v_mfma_f32_32x32x16_bf16 v[240:255], a[188:191], a[220:223], v[240:255]
  v_accvgpr_write_b32 a79, 0
  s_waitcnt lgkmcnt(0)
  s_barrier
  v_mfma_f32_32x32x16_bf16 v[128:143], a[128:131], a[224:227], v[128:143]
  ds_read_b64_tr_b16 a[160:161], v48 offset:32768
  s_mov_b32 m0, s39
  v_mfma_f32_32x32x16_bf16 v[144:159], a[132:135], a[224:227], v[144:159]
  ds_read_b64_tr_b16 a[162:163], v48 offset:33792
  ds_read_b64_tr_b16 a[164:165], v49 offset:32768
  buffer_load_dwordx4 v64, s[16:19], s38 offen lds
  v_accvgpr_write_b32 a80, 0
  v_mfma_f32_32x32x16_bf16 v[160:175], a[136:139], a[224:227], v[160:175]
  ds_read_b64_tr_b16 a[166:167], v49 offset:33792
  v_mfma_f32_32x32x16_bf16 v[176:191], a[140:143], a[224:227], v[176:191]
  ds_read_b64_tr_b16 a[168:169], v50 offset:32768
  buffer_load_dwordx4 v65, s[16:19], s38 offen offset:1024 lds
  v_accvgpr_write_b32 a81, 0
  v_mfma_f32_32x32x16_bf16 v[192:207], a[128:131], a[240:243], v[192:207]
  ds_read_b64_tr_b16 a[170:171], v50 offset:33792
  ds_read_b64_tr_b16 a[172:173], v51 offset:32768
  buffer_load_dwordx4 v66, s[16:19], s38 offen offset:2048 lds
  v_mfma_f32_32x32x16_bf16 v[208:223], a[132:135], a[240:243], v[208:223]
  ds_read_b64_tr_b16 a[174:175], v51 offset:33792
  v_accvgpr_write_b32 a82, 0
  v_mfma_f32_32x32x16_bf16 v[224:239], a[136:139], a[240:243], v[224:239]
  ds_read_b64_tr_b16 a[176:177], v48 offset:36864
  buffer_load_dwordx4 v67, s[16:19], s38 offen offset:3072 lds
  v_mfma_f32_32x32x16_bf16 v[240:255], a[140:143], a[240:243], v[240:255]
  ds_read_b64_tr_b16 a[178:179], v48 offset:37888
  ds_read_b64_tr_b16 a[180:181], v49 offset:36864
  s_add_u32 m0, s39, 0x1000
  v_accvgpr_write_b32 a83, 0
  v_mfma_f32_32x32x16_bf16 v[128:143], a[144:147], a[228:231], v[128:143]
  ds_read_b64_tr_b16 a[182:183], v49 offset:37888
  buffer_load_dwordx4 v68, s[16:19], s38 offen lds
  v_mfma_f32_32x32x16_bf16 v[144:159], a[148:151], a[228:231], v[144:159]
  ds_read_b64_tr_b16 a[184:185], v50 offset:36864
  v_accvgpr_write_b32 a84, 0
  v_mfma_f32_32x32x16_bf16 v[160:175], a[152:155], a[228:231], v[160:175]
  ds_read_b64_tr_b16 a[186:187], v50 offset:37888
  ds_read_b64_tr_b16 a[188:189], v51 offset:36864
  buffer_load_dwordx4 v69, s[16:19], s38 offen offset:1024 lds
  v_mfma_f32_32x32x16_bf16 v[176:191], a[156:159], a[228:231], v[176:191]
  ds_read_b64_tr_b16 a[190:191], v51 offset:37888
  v_accvgpr_write_b32 a85, 0
  v_mfma_f32_32x32x16_bf16 v[192:207], a[144:147], a[244:247], v[192:207]
  buffer_load_dwordx4 v70, s[16:19], s38 offen offset:2048 lds
  v_mfma_f32_32x32x16_bf16 v[208:223], a[148:151], a[244:247], v[208:223]
  buffer_load_dwordx4 v71, s[16:19], s38 offen offset:3072 lds
  v_accvgpr_write_b32 a86, 0
  v_mfma_f32_32x32x16_bf16 v[224:239], a[152:155], a[244:247], v[224:239]
  s_add_u32 s38, s38, 0x80
  v_mfma_f32_32x32x16_bf16 v[240:255], a[156:159], a[244:247], v[240:255]
  s_cmp_eq_u32 s38, 1152
  s_cselect_b32 s38, 0, s38
  v_accvgpr_write_b32 a87, 0
  s_waitcnt lgkmcnt(0)
  s_barrier
  v_mfma_f32_32x32x16_bf16 v[128:143], a[160:163], a[232:235], v[128:143]
  ds_read_b64_tr_b16 a[128:129], v48 offset:8192
  v_mfma_f32_32x32x16_bf16 v[144:159], a[164:167], a[232:235], v[144:159]
  ds_read_b64_tr_b16 a[130:131], v48 offset:9216
  ds_read_b64_tr_b16 a[132:133], v49 offset:8192
  v_accvgpr_write_b32 a88, 0
  v_mfma_f32_32x32x16_bf16 v[160:175], a[168:171], a[232:235], v[160:175]
  ds_read_b64_tr_b16 a[134:135], v49 offset:9216
  v_mfma_f32_32x32x16_bf16 v[176:191], a[172:175], a[232:235], v[176:191]
  ds_read_b64_tr_b16 a[136:137], v50 offset:8192
  v_accvgpr_write_b32 a89, 0
  v_mfma_f32_32x32x16_bf16 v[192:207], a[160:163], a[248:251], v[192:207]
  ds_read_b64_tr_b16 a[138:139], v50 offset:9216
  ds_read_b64_tr_b16 a[140:141], v51 offset:8192
  v_mfma_f32_32x32x16_bf16 v[208:223], a[164:167], a[248:251], v[208:223]
  ds_read_b64_tr_b16 a[142:143], v51 offset:9216
  v_accvgpr_write_b32 a90, 0
  v_mfma_f32_32x32x16_bf16 v[224:239], a[168:171], a[248:251], v[224:239]
  ds_read_b64_tr_b16 a[144:145], v48 offset:12288
  s_waitcnt vmcnt(16)
  ds_read_b128 a[192:195], v32
  v_mfma_f32_32x32x16_bf16 v[240:255], a[172:175], a[248:251], v[240:255]
  ds_read_b64_tr_b16 a[146:147], v48 offset:13312
  ds_read_b64_tr_b16 a[148:149], v49 offset:12288
  ds_read_b128 a[208:211], v32 offset:4096
  ds_read_b128 a[196:199], v33
  v_accvgpr_write_b32 a91, 0
  v_mfma_f32_32x32x16_bf16 v[128:143], a[176:179], a[236:239], v[128:143]
  ds_read_b64_tr_b16 a[150:151], v49 offset:13312
  ds_read_b128 a[212:215], v33 offset:4096
  v_mfma_f32_32x32x16_bf16 v[144:159], a[180:183], a[236:239], v[144:159]
  ds_read_b64_tr_b16 a[152:153], v50 offset:12288
  ds_read_b128 a[200:203], v34
  v_accvgpr_write_b32 a92, 0
  v_mfma_f32_32x32x16_bf16 v[160:175], a[184:187], a[236:239], v[160:175]
  ds_read_b64_tr_b16 a[154:155], v50 offset:13312
  ds_read_b64_tr_b16 a[156:157], v51 offset:12288
  ds_read_b128 a[216:219], v34 offset:4096
  ds_read_b128 a[204:207], v35
  v_mfma_f32_32x32x16_bf16 v[176:191], a[188:191], a[236:239], v[176:191]
  ds_read_b64_tr_b16 a[158:159], v51 offset:13312
  ds_read_b128 a[220:223], v35 offset:4096
  v_accvgpr_write_b32 a93, 0
  v_mfma_f32_32x32x16_bf16 v[192:207], a[176:179], a[252:255], v[192:207]
  v_mfma_f32_32x32x16_bf16 v[208:223], a[180:183], a[252:255], v[208:223]
  v_accvgpr_write_b32 a94, 0
  v_mfma_f32_32x32x16_bf16 v[224:239], a[184:187], a[252:255], v[224:239]
  v_mfma_f32_32x32x16_bf16 v[240:255], a[188:191], a[252:255], v[240:255]
  v_accvgpr_write_b32 a95, 0
  s_waitcnt lgkmcnt(0)
  s_barrier
  v_mfma_f32_32x32x16_bf16 v[128:143], a[128:131], a[192:195], v[128:143]
  ds_read_b64_tr_b16 a[160:161], v48 offset:40960
  v_mfma_f32_32x32x16_bf16 v[144:159], a[132:135], a[192:195], v[144:159]
  ds_read_b64_tr_b16 a[162:163], v48 offset:41984
  ds_read_b64_tr_b16 a[164:165], v49 offset:40960
  v_accvgpr_write_b32 a96, 0
  v_mfma_f32_32x32x16_bf16 v[160:175], a[136:139], a[192:195], v[160:175]
  ds_read_b64_tr_b16 a[166:167], v49 offset:41984
  v_mfma_f32_32x32x16_bf16 v[176:191], a[140:143], a[192:195], v[176:191]
  ds_read_b64_tr_b16 a[168:169], v50 offset:40960
  v_accvgpr_write_b32 a97, 0
  v_mfma_f32_32x32x16_bf16 v[192:207], a[128:131], a[208:211], v[192:207]
  ds_read_b64_tr_b16 a[170:171], v50 offset:41984
  ds_read_b64_tr_b16 a[172:173], v51 offset:40960
  v_mfma_f32_32x32x16_bf16 v[208:223], a[132:135], a[208:211], v[208:223]
  ds_read_b64_tr_b16 a[174:175], v51 offset:41984
  v_accvgpr_write_b32 a98, 0
  v_mfma_f32_32x32x16_bf16 v[224:239], a[136:139], a[208:211], v[224:239]
  ds_read_b64_tr_b16 a[176:177], v48 offset:45056
  v_mfma_f32_32x32x16_bf16 v[240:255], a[140:143], a[208:211], v[240:255]
  ds_read_b64_tr_b16 a[178:179], v48 offset:46080
  ds_read_b64_tr_b16 a[180:181], v49 offset:45056
  v_accvgpr_write_b32 a99, 0
  v_mfma_f32_32x32x16_bf16 v[128:143], a[144:147], a[196:199], v[128:143]
  ds_read_b64_tr_b16 a[182:183], v49 offset:46080
  v_mfma_f32_32x32x16_bf16 v[144:159], a[148:151], a[196:199], v[144:159]
  ds_read_b64_tr_b16 a[184:185], v50 offset:45056
  v_accvgpr_write_b32 a100, 0
  v_mfma_f32_32x32x16_bf16 v[160:175], a[152:155], a[196:199], v[160:175]
  ds_read_b64_tr_b16 a[186:187], v50 offset:46080
  ds_read_b64_tr_b16 a[188:189], v51 offset:45056
  v_mfma_f32_32x32x16_bf16 v[176:191], a[156:159], a[196:199], v[176:191]
  ds_read_b64_tr_b16 a[190:191], v51 offset:46080
  v_accvgpr_write_b32 a101, 0
  v_mfma_f32_32x32x16_bf16 v[192:207], a[144:147], a[212:215], v[192:207]
  v_mfma_f32_32x32x16_bf16 v[208:223], a[148:151], a[212:215], v[208:223]
  v_accvgpr_write_b32 a102, 0
  v_mfma_f32_32x32x16_bf16 v[224:239], a[152:155], a[212:215], v[224:239]
  v_mfma_f32_32x32x16_bf16 v[240:255], a[156:159], a[212:215], v[240:255]
  v_accvgpr_write_b32 a103, 0
  s_waitcnt lgkmcnt(0)
  s_barrier
  v_mfma_f32_32x32x16_bf16 v[128:143], a[160:163], a[200:203], v[128:143]
  ds_read_b64_tr_b16 a[128:129], v48 offset:16384
  v_mfma_f32_32x32x16_bf16 v[144:159], a[164:167], a[200:203], v[144:159]
  ds_read_b64_tr_b16 a[130:131], v48 offset:17408
  ds_read_b64_tr_b16 a[132:133], v49 offset:16384
  v_accvgpr_write_b32 a104, 0
  v_mfma_f32_32x32x16_bf16 v[160:175], a[168:171], a[200:203], v[160:175]
  ds_read_b64_tr_b16 a[134:135], v49 offset:17408
  v_mfma_f32_32x32x16_bf16 v[176:191], a[172:175], a[200:203], v[176:191]
  ds_read_b64_tr_b16 a[136:137], v50 offset:16384
  v_accvgpr_write_b32 a105, 0
  v_mfma_f32_32x32x16_bf16 v[192:207], a[160:163], a[216:219], v[192:207]
  ds_read_b64_tr_b16 a[138:139], v50 offset:17408
  ds_read_b64_tr_b16 a[140:141], v51 offset:16384
  v_mfma_f32_32x32x16_bf16 v[208:223], a[164:167], a[216:219], v[208:223]
  ds_read_b64_tr_b16 a[142:143], v51 offset:17408
  v_accvgpr_write_b32 a106, 0
  s_branch PADO_2
PADA_2:
  s_branch HOPRET_g2
PAD_2:
  s_sub_u32 s40, s40, 1
  s_cbranch_scc1 HOPRET_gb
  s_branch PAD_9
PADO_2:
  v_mfma_f32_32x32x16_bf16 v[224:239], a[168:171], a[216:219], v[224:239]
  ds_read_b64_tr_b16 a[144:145], v48 offset:20480
  s_waitcnt vmcnt(8)
  ds_read_b128 a[224:227], v36
  v_mfma_f32_32x32x16_bf16 v[240:255], a[172:175], a[216:219], v[240:255]
  ds_read_b64_tr_b16 a[146:147], v48 offset:21504
  ds_read_b64_tr_b16 a[148:149], v49 offset:20480
  ds_read_b128 a[240:243], v36 offset:4096
  ds_read_b128 a[228:231], v37
  v_accvgpr_write_b32 a107, 0
  v_mfma_f32_32x32x16_bf16 v[128:143], a[176:179], a[204:207], v[128:143]
  ds_read_b64_tr_b16 a[150:151], v49 offset:21504
  ds_read_b128 a[244:247], v37 offset:4096
  v_mfma_f32_32x32x16_bf16 v[144:159], a[180:183], a[204:207], v[144:159]
  ds_read_b64_tr_b16 a[152:153], v50 offset:20480
  ds_read_b128 a[232:235], v38
  v_accvgpr_write_b32 a108, 0
  v_mfma_f32_32x32x16_bf16 v[160:175], a[184:187], a[204:207], v[160:175]
  ds_read_b64_tr_b16 a[154:155], v50 offset:21504
  ds_read_b64_tr_b16 a[156:157], v51 offset:20480
  ds_read_b128 a[248:251], v38 offset:4096
  ds_read_b128 a[236:239], v39
  v_mfma_f32_32x32x16_bf16 v[176:191], a[188:191], a[204:207], v[176:191]
  ds_read_b64_tr_b16 a[158:159], v51 offset:21504
  ds_read_b128 a[252:255], v39 offset:4096
  v_accvgpr_write_b32 a109, 0
  v_mfma_f32_32x32x16_bf16 v[192:207], a[176:179], a[220:223], v[192:207]
  v_mfma_f32_32x32x16_bf16 v[208:223], a[180:183], a[220:223], v[208:223]
  v_accvgpr_write_b32 a110, 0
  v_mfma_f32_32x32x16_bf16 v[224:239], a[184:187], a[220:223], v[224:239]
  v_mfma_f32_32x32x16_bf16 v[240:255], a[188:191], a[220:223], v[240:255]
  v_accvgpr_write_b32 a111, 0
  s_waitcnt lgkmcnt(0)
  s_barrier
  v_mfma_f32_32x32x16_bf16 v[128:143], a[128:131], a[224:227], v[128:143]
  ds_read_b64_tr_b16 a[160:161], v48 offset:49152
  v_mfma_f32_32x32x16_bf16 v[144:159], a[132:135], a[224:227], v[144:159]
  ds_read_b64_tr_b16 a[162:163], v48 offset:50176
  ds_read_b64_tr_b16 a[164:165], v49 offset:49152
  v_accvgpr_write_b32 a112, 0
  v_mfma_f32_32x32x16_bf16 v[160:175], a[136:139], a[224:227], v[160:175]
  ds_read_b64_tr_b16 a[166:167], v49 offset:50176
  v_mfma_f32_32x32x16_bf16 v[176:191], a[140:143], a[224:227], v[176:191]
  ds_read_b64_tr_b16 a[168:169], v50 offset:49152
  v_accvgpr_write_b32 a113, 0
  v_mfma_f32_32x32x16_bf16 v[192:207], a[128:131], a[240:243], v[192:207]
  ds_read_b64_tr_b16 a[170:171], v50 offset:50176
  ds_read_b64_tr_b16 a[172:173], v51 offset:49152
  v_mfma_f32_32x32x16_bf16 v[208:223], a[132:135], a[240:243], v[208:223]
  ds_read_b64_tr_b16 a[174:175], v51 offset:50176
  v_accvgpr_write_b32 a114, 0
  v_mfma_f32_32x32x16_bf16 v[224:239], a[136:139], a[240:243], v[224:239]
  ds_read_b64_tr_b16 a[176:177], v48 offset:53248
  v_mfma_f32_32x32x16_bf16 v[240:255], a[140:143], a[240:243], v[240:255]
  ds_read_b64_tr_b16 a[178:179], v48 offset:54272
  ds_read_b64_tr_b16 a[180:181], v49 offset:53248
  v_accvgpr_write_b32 a115, 0
  v_mfma_f32_32x32x16_bf16 v[128:143], a[144:147], a[228:231], v[128:143]
  ds_read_b64_tr_b16 a[182:183], v49 offset:54272
  v_mfma_f32_32x32x16_bf16 v[144:159], a[148:151], a[228:231], v[144:159]
  ds_read_b64_tr_b16 a[184:185], v50 offset:53248
  v_accvgpr_write_b32 a116, 0
  v_mfma_f32_32x32x16_bf16 v[160:175], a[152:155], a[228:231], v[160:175]
  ds_read_b64_tr_b16 a[186:187], v50 offset:54272
  ds_read_b64_tr_b16 a[188:189], v51 offset:53248
  v_mfma_f32_32x32x16_bf16 v[176:191], a[156:159], a[228:231], v[176:191]
  ds_read_b64_tr_b16 a[190:191], v51 offset:54272
  v_accvgpr_write_b32 a117, 0
  v_mfma_f32_32x32x16_bf16 v[192:207], a[144:147], a[244:247], v[192:207]
  v_mfma_f32_32x32x16_bf16 v[208:223], a[148:151], a[244:247], v[208:223]
  v_accvgpr_write_b32 a118, 0
  v_mfma_f32_32x32x16_bf16 v[224:239], a[152:155], a[244:247], v[224:239]
  v_mfma_f32_32x32x16_bf16 v[240:255], a[156:159], a[244:247], v[240:255]
  v_accvgpr_write_b32 a119, 0
  s_waitcnt lgkmcnt(0)
  s_barrier
  v_mfma_f32_32x32x16_bf16 v[128:143], a[160:163], a[232:235], v[128:143]
  ds_read_b64_tr_b16 a[128:129], v48 offset:24576
  v_mfma_f32_32x32x16_bf16 v[144:159], a[164:167], a[232:235], v[144:159]
  ds_read_b64_tr_b16 a[130:131], v48 offset:25600
  ds_read_b64_tr_b16 a[132:133], v49 offset:24576
  v_accvgpr_write_b32 a120, 0
  v_mfma_f32_32x32x16_bf16 v[160:175], a[168:171], a[232:235], v[160:175]
  ds_read_b64_tr_b16 a[134:135], v49 offset:25600
  v_mfma_f32_32x32x16_bf16 v[176:191], a[172:175], a[232:235], v[176:191]
  ds_read_b64_tr_b16 a[136:137], v50 offset:24576
  v_accvgpr_write_b32 a121, 0
  v_mfma_f32_32x32x16_bf16 v[192:207], a[160:163], a[248:251], v[192:207]
  ds_read_b64_tr_b16 a[138:139], v50 offset:25600
  ds_read_b64_tr_b16 a[140:141], v51 offset:24576
  v_mfma_f32_32x32x16_bf16 v[208:223], a[164:167], a[248:251], v[208:223]
  ds_read_b64_tr_b16 a[142:143], v51 offset:25600
  v_accvgpr_write_b32 a122, 0
  v_mfma_f32_32x32x16_bf16 v[224:239], a[168:171], a[248:251], v[224:239]
  ds_read_b64_tr_b16 a[144:145], v48 offset:28672
  s_waitcnt vmcnt(0)
  ds_read_b128 a[192:195], v40
  v_mfma_f32_32x32x16_bf16 v[240:255], a[172:175], a[248:251], v[240:255]
  ds_read_b64_tr_b16 a[146:147], v48 offset:29696
  ds_read_b64_tr_b16 a[148:149], v49 offset:28672
  ds_read_b128 a[208:211], v40 offset:4096
  ds_read_b128 a[196:199], v41
  v_accvgpr_write_b32 a123, 0
  v_mfma_f32_32x32x16_bf16 v[128:143], a[176:179], a[236:239], v[128:143]
  ds_read_b64_tr_b16 a[150:151], v49 offset:29696
  ds_read_b128 a[212:215], v41 offset:4096
  v_mfma_f32_32x32x16_bf16 v[144:159], a[180:183], a[236:239], v[144:159]
  ds_read_b64_tr_b16 a[152:153], v50 offset:28672
  ds_read_b128 a[200:203], v42
  v_accvgpr_write_b32 a124, 0
  v_mfma_f32_32x32x16_bf16 v[160:175], a[184:187], a[236:239], v[160:175]
  ds_read_b64_tr_b16 a[154:155], v50 offset:29696
  ds_read_b64_tr_b16 a[156:157], v51 offset:28672
  ds_read_b128 a[216:219], v42 offset:4096
  ds_read_b128 a[204:207], v43
  v_mfma_f32_32x32x16_bf16 v[176:191], a[188:191], a[236:239], v[176:191]
  ds_read_b64_tr_b16 a[158:159], v51 offset:29696
  ds_read_b128 a[220:223], v43 offset:4096
  v_accvgpr_write_b32 a125, 0
  v_mfma_f32_32x32x16_bf16 v[192:207], a[176:179], a[252:255], v[192:207]
  v_mfma_f32_32x32x16_bf16 v[208:223], a[180:183], a[252:255], v[208:223]
  v_accvgpr_write_b32 a126, 0
  v_mfma_f32_32x32x16_bf16 v[224:239], a[184:187], a[252:255], v[224:239]
  v_mfma_f32_32x32x16_bf16 v[240:255], a[188:191], a[252:255], v[240:255]
  v_accvgpr_write_b32 a127, 0
  s_waitcnt lgkmcnt(0)
  s_barrier
  v_mfma_f32_32x32x16_bf16 v[128:143], a[128:131], a[192:195], v[128:143]
  ds_read_b64_tr_b16 a[160:161], v48 offset:57344
  v_mfma_f32_32x32x16_bf16 v[144:159], a[132:135], a[192:195], v[144:159]
  ds_read_b64_tr_b16 a[162:163], v48 offset:58368
  ds_read_b64_tr_b16 a[164:165], v49 offset:57344
  v_mfma_f32_32x32x16_bf16 v[160:175], a[136:139], a[192:195], v[160:175]
  ds_read_b64_tr_b16 a[166:167], v49 offset:58368
  v_mfma_f32_32x32x16_bf16 v[176:191], a[140:143], a[192:195], v[176:191]
  ds_read_b64_tr_b16 a[168:169], v50 offset:57344
  v_mfma_f32_32x32x16_bf16 v[192:207], a[128:131], a[208:211], v[192:207]
  ds_read_b64_tr_b16 a[170:171], v50 offset:58368
  ds_read_b64_tr_b16 a[172:173], v51 offset:57344
  v_mfma_f32_32x32x16_bf16 v[208:223], a[132:135], a[208:211], v[208:223]
  ds_read_b64_tr_b16 a[174:175], v51 offset:58368
  v_mfma_f32_32x32x16_bf16 v[224:239], a[136:139], a[208:211], v[224:239]
  ds_read_b64_tr_b16 a[176:177], v48 offset:61440
  v_mfma_f32_32x32x16_bf16 v[240:255], a[140:143], a[208:211], v[240:255]
  ds_read_b64_tr_b16 a[178:179], v48 offset:62464
  ds_read_b64_tr_b16 a[180:181], v49 offset:61440
  v_mfma_f32_32x32x16_bf16 v[128:143], a[144:147], a[196:199], v[128:143]
  ds_read_b64_tr_b16 a[182:183], v49 offset:62464
  v_mfma_f32_32x32x16_bf16 v[144:159], a[148:151], a[196:199], v[144:159]
  ds_read_b64_tr_b16 a[184:185], v50 offset:61440
  v_mfma_f32_32x32x16_bf16 v[160:175], a[152:155], a[196:199], v[160:175]
  ds_read_b64_tr_b16 a[186:187], v50 offset:62464
  ds_read_b64_tr_b16 a[188:189], v51 offset:61440
  v_mfma_f32_32x32x16_bf16 v[176:191], a[156:159], a[196:199], v[176:191]
  ds_read_b64_tr_b16 a[190:191], v51 offset:62464
  v_mfma_f32_32x32x16_bf16 v[192:207], a[144:147], a[212:215], v[192:207]
  v_mfma_f32_32x32x16_bf16 v[208:223], a[148:151], a[212:215], v[208:223]
  v_mfma_f32_32x32x16_bf16 v[224:239], a[152:155], a[212:215], v[224:239]
  v_mfma_f32_32x32x16_bf16 v[240:255], a[156:159], a[212:215], v[240:255]
  s_waitcnt lgkmcnt(0)
  s_barrier
  v_mfma_f32_32x32x16_bf16 v[128:143], a[160:163], a[200:203], v[128:143]
  ds_read_b128 a[128:131], v2 offset:32768
  v_mfma_f32_32x32x16_bf16 v[144:159], a[164:167], a[200:203], v[144:159]
  ds_read_b128 a[132:135], v3 offset:32768
  v_mfma_f32_32x32x16_bf16 v[160:175], a[168:171], a[200:203], v[160:175]
  ds_read_b128 a[136:139], v4 offset:32768
  v_mfma_f32_32x32x16_bf16 v[176:191], a[172:175], a[200:203], v[176:191]
  ds_read_b128 a[140:143], v5 offset:32768
  v_mfma_f32_32x32x16_bf16 v[128:143], a[176:179], a[204:207], v[128:143]
  ds_read_b128 a[144:147], v6 offset:32768
  v_mfma_f32_32x32x16_bf16 v[144:159], a[180:183], a[204:207], v[144:159]
  ds_read_b128 a[148:151], v7 offset:32768
  v_mfma_f32_32x32x16_bf16 v[160:175], a[184:187], a[204:207], v[160:175]
  ds_read_b128 a[152:155], v8 offset:32768
  v_mfma_f32_32x32x16_bf16 v[176:191], a[188:191], a[204:207], v[176:191]
  ds_read_b128 a[156:159], v9 offset:32768
  v_mfma_f32_32x32x16_bf16 v[192:207], a[160:163], a[216:219], v[192:207]
  v_mfma_f32_32x32x16_bf16 v[208:223], a[164:167], a[216:219], v[208:223]
  v_pk_mul_f32 v[128:129], v[128:129], s[42:43] op_sel:[0,1] op_sel_hi:[1,1]
  v_pk_mul_f32 v[130:131], v[130:131], s[42:43] op_sel:[0,1] op_sel_hi:[1,1]
  v_pk_mul_f32 v[132:133], v[132:133], s[42:43] op_sel:[0,1] op_sel_hi:[1,1]
  v_pk_mul_f32 v[134:135], v[134:135], s[42:43] op_sel:[0,1] op_sel_hi:[1,1]
  v_cvt_pk_bf16_f32 v64, v128, v129
  v_cvt_pk_bf16_f32 v65, v130, v131
  v_mfma_f32_32x32x16_bf16 v[224:239], a[168:171], a[216:219], v[224:239]
  v_cvt_pk_bf16_f32 v66, v132, v133
  v_cvt_pk_bf16_f32 v67, v134, v135
  v_pk_mul_f32 v[136:137], v[136:137], s[42:43] op_sel:[0,1] op_sel_hi:[1,1]
  v_pk_mul_f32 v[138:139], v[138:139], s[42:43] op_sel:[0,1] op_sel_hi:[1,1]
  v_pk_mul_f32 v[140:141], v[140:141], s[42:43] op_sel:[0,1] op_sel_hi:[1,1]
  v_mfma_f32_32x32x16_bf16 v[240:255], a[172:175], a[216:219], v[240:255]
  v_pk_mul_f32 v[142:143], v[142:143], s[42:43] op_sel:[0,1] op_sel_hi:[1,1]
  v_cvt_pk_bf16_f32 v68, v136, v137
  v_cvt_pk_bf16_f32 v69, v138, v139
  v_cvt_pk_bf16_f32 v70, v140, v141
  v_cvt_pk_bf16_f32 v71, v142, v143
  v_pk_mul_f32 v[144:145], v[144:145], s[42:43] op_sel:[0,1] op_sel_hi:[1,1]
  v_mfma_f32_32x32x16_bf16 v[192:207], a[176:179], a[220:223], v[192:207]
  v_pk_mul_f32 v[146:147], v[146:147], s[42:43] op_sel:[0,1] op_sel_hi:[1,1]
  v_pk_mul_f32 v[148:149], v[148:149], s[42:43] op_sel:[0,1] op_sel_hi:[1,1]
  v_pk_mul_f32 v[150:151], v[150:151], s[42:43] op_sel:[0,1] op_sel_hi:[1,1]
  v_cvt_pk_bf16_f32 v72, v144, v145
  v_cvt_pk_bf16_f32 v73, v146, v147
  v_cvt_pk_bf16_f32 v74, v148, v149
  v_mfma_f32_32x32x16_bf16 v[208:223], a[180:183], a[220:223], v[208:223]
  v_cvt_pk_bf16_f32 v75, v150, v151
  v_pk_mul_f32 v[152:153], v[152:153], s[42:43] op_sel:[0,1] op_sel_hi:[1,1]
  v_pk_mul_f32 v[154:155], v[154:155], s[42:43] op_sel:[0,1] op_sel_hi:[1,1]
  v_pk_mul_f32 v[156:157], v[156:157], s[42:43] op_sel:[0,1] op_sel_hi:[1,1]
  v_pk_mul_f32 v[158:159], v[158:159], s[42:43] op_sel:[0,1] op_sel_hi:[1,1]
  v_cvt_pk_bf16_f32 v76, v152, v153
  v_mfma_f32_32x32x16_bf16 v[224:239], a[184:187], a[220:223], v[224:239]
  v_cvt_pk_bf16_f32 v77, v154, v155
  v_cvt_pk_bf16_f32 v78, v156, v157
  v_cvt_pk_bf16_f32 v79, v158, v159
  v_pk_mul_f32 v[160:161], v[160:161], s[42:43] op_sel:[0,1] op_sel_hi:[1,1]
  v_pk_mul_f32 v[162:163], v[162:163], s[42:43] op_sel:[0,1] op_sel_hi:[1,1]
  v_mfma_f32_32x32x16_bf16 v[240:255], a[188:191], a[220:223], v[240:255]
  v_pk_mul_f32 v[164:165], v[164:165], s[42:43] op_sel:[0,1] op_sel_hi:[1,1]
  v_pk_mul_f32 v[166:167], v[166:167], s[42:43] op_sel:[0,1] op_sel_hi:[1,1]
  v_cvt_pk_bf16_f32 v80, v160, v161
  v_cvt_pk_bf16_f32 v81, v162, v163
  v_cvt_pk_bf16_f32 v82, v164, v165
  v_cvt_pk_bf16_f32 v83, v166, v167
  v_pk_mul_f32 v[168:169], v[168:169], s[42:43] op_sel:[0,1] op_sel_hi:[1,1]
  v_pk_mul_f32 v[170:171], v[170:171], s[42:43] op_sel:[0,1] op_sel_hi:[1,1]
  v_pk_mul_f32 v[172:173], v[172:173], s[42:43] op_sel:[0,1] op_sel_hi:[1,1]
  v_pk_mul_f32 v[174:175], v[174:175], s[42:43] op_sel:[0,1] op_sel_hi:[1,1]
  v_cvt_pk_bf16_f32 v84, v168, v169
  v_cvt_pk_bf16_f32 v85, v170, v171
  v_cvt_pk_bf16_f32 v86, v172, v173
  v_cvt_pk_bf16_f32 v87, v174, v175
  v_pk_mul_f32 v[176:177], v[176:177], s[42:43] op_sel:[0,1] op_sel_hi:[1,1]
  v_pk_mul_f32 v[178:179], v[178:179], s[42:43] op_sel:[0,1] op_sel_hi:[1,1]
  v_pk_mul_f32 v[180:181], v[180:181], s[42:43] op_sel:[0,1] op_sel_hi:[1,1]
  v_pk_mul_f32 v[182:183], v[182:183], s[42:43] op_sel:[0,1] op_sel_hi:[1,1]
  v_cvt_pk_bf16_f32 v88, v176, v177
  v_cvt_pk_bf16_f32 v89, v178, v179
  v_cvt_pk_bf16_f32 v90, v180, v181
  v_cvt_pk_bf16_f32 v91, v182, v183
  v_pk_mul_f32 v[184:185], v[184:185], s[42:43] op_sel:[0,1] op_sel_hi:[1,1]
  v_pk_mul_f32 v[186:187], v[186:187], s[42:43] op_sel:[0,1] op_sel_hi:[1,1]
  v_pk_mul_f32 v[188:189], v[188:189], s[42:43] op_sel:[0,1] op_sel_hi:[1,1]
  v_pk_mul_f32 v[190:191], v[190:191], s[42:43] op_sel:[0,1] op_sel_hi:[1,1]
  v_cvt_pk_bf16_f32 v92, v184, v185
  v_cvt_pk_bf16_f32 v93, v186, v187
  v_cvt_pk_bf16_f32 v94, v188, v189
  v_cvt_pk_bf16_f32 v95, v190, v191
A_ATT2:
  s_waitcnt lgkmcnt(7)
  v_mfma_f32_32x32x16_bf16 v[128:143], a[128:131], v[64:67], 0
  v_pk_mul_f32 v[192:193], v[192:193], s[42:43] op_sel:[0,1] op_sel_hi:[1,1]
  v_pk_mul_f32 v[194:195], v[194:195], s[42:43] op_sel:[0,1] op_sel_hi:[1,1]
  v_pk_mul_f32 v[196:197], v[196:197], s[42:43] op_sel:[0,1] op_sel_hi:[1,1]
  v_pk_mul_f32 v[198:199], v[198:199], s[42:43] op_sel:[0,1] op_sel_hi:[1,1]
  v_cvt_pk_bf16_f32 v96, v192, v193
  s_waitcnt lgkmcnt(6)
  v_mfma_f32_32x32x16_bf16 v[128:143], a[132:135], v[68:71], v[128:143]
  v_cvt_pk_bf16_f32 v97, v194, v195
  v_cvt_pk_bf16_f32 v98, v196, v197
  v_cvt_pk_bf16_f32 v99, v198, v199
  v_pk_mul_f32 v[200:201], v[200:201], s[42:43] op_sel:[0,1] op_sel_hi:[1,1]
  v_pk_mul_f32 v[202:203], v[202:203], s[42:43] op_sel:[0,1] op_sel_hi:[1,1]
  s_waitcnt lgkmcnt(5)
  v_mfma_f32_32x32x16_bf16 v[128:143], a[136:139], v[72:75], v[128:143]
  v_pk_mul_f32 v[204:205], v[204:205], s[42:43] op_sel:[0,1] op_sel_hi:[1,1]
  v_pk_mul_f32 v[206:207], v[206:207], s[42:43] op_sel:[0,1] op_sel_hi:[1,1]
  v_cvt_pk_bf16_f32 v100, v200, v201
  v_cvt_pk_bf16_f32 v101, v202, v203
  v_cvt_pk_bf16_f32 v102, v204, v205
  s_waitcnt lgkmcnt(4)
  v_mfma_f32_32x32x16_bf16 v[128:143], a[140:143], v[76:79], v[128:143]
  v_cvt_pk_bf16_f32 v103, v206, v207
  v_pk_mul_f32 v[208:209], v[208:209], s[42:43] op_sel:[0,1] op_sel_hi:[1,1]
  v_pk_mul_f32 v[210:211], v[210:211], s[42:43] op_sel:[0,1] op_sel_hi:[1,1]
  v_pk_mul_f32 v[212:213], v[212:213], s[42:43] op_sel:[0,1] op_sel_hi:[1,1]
  v_pk_mul_f32 v[214:215], v[214:215], s[42:43] op_sel:[0,1] op_sel_hi:[1,1]
  s_waitcnt lgkmcnt(3)
  v_mfma_f32_32x32x16_bf16 v[128:143], a[144:147], v[80:83], v[128:143]
  v_cvt_pk_bf16_f32 v104, v208, v209
  v_cvt_pk_bf16_f32 v105, v210, v211
  v_cvt_pk_bf16_f32 v106, v212, v213
  v_cvt_pk_bf16_f32 v107, v214, v215
  v_pk_mul_f32 v[216:217], v[216:217], s[42:43] op_sel:[0,1] op_sel_hi:[1,1]
  s_waitcnt lgkmcnt(2)
  v_mfma_f32_32x32x16_bf16 v[128:143], a[148:151], v[84:87], v[128:143]
  v_pk_mul_f32 v[218:219], v[218:219], s[42:43] op_sel:[0,1] op_sel_hi:[1,1]
  v_pk_mul_f32 v[220:221], v[220:221], s[42:43] op_sel:[0,1] op_sel_hi:[1,1]
  v_pk_mul_f32 v[222:223], v[222:223], s[42:43] op_sel:[0,1] op_sel_hi:[1,1]
  v_cvt_pk_bf16_f32 v108, v216, v217
  v_cvt_pk_bf16_f32 v109, v218, v219
  s_waitcnt lgkmcnt(1)
  v_mfma_f32_32x32x16_bf16 v[128:143], a[152:155], v[88:91], v[128:143]
  v_cvt_pk_bf16_f32 v110, v220, v221
  v_cvt_pk_bf16_f32 v111, v222, v223
  v_pk_mul_f32 v[224:225], v[224:225], s[42:43] op_sel:[0,1] op_sel_hi:[1,1]
  v_pk_mul_f32 v[226:227], v[226:227], s[42:43] op_sel:[0,1] op_sel_hi:[1,1]
  v_pk_mul_f32 v[228:229], v[228:229], s[42:43] op_sel:[0,1] op_sel_hi:[1,1]
  s_waitcnt lgkmcnt(0)
  v_mfma_f32_32x32x16_bf16 v[128:143], a[156:159], v[92:95], v[128:143]
  v_pk_mul_f32 v[230:231], v[230:231], s[42:43] op_sel:[0,1] op_sel_hi:[1,1]
  v_cvt_pk_bf16_f32 v112, v224, v225
  v_cvt_pk_bf16_f32 v113, v226, v227
  v_cvt_pk_bf16_f32 v114, v228, v229
  v_cvt_pk_bf16_f32 v115, v230, v231
  v_pk_mul_f32 v[232:233], v[232:233], s[42:43] op_sel:[0,1] op_sel_hi:[1,1]
  v_pk_mul_f32 v[234:235], v[234:235], s[42:43] op_sel:[0,1] op_sel_hi:[1,1]
  v_pk_mul_f32 v[236:237], v[236:237], s[42:43] op_sel:[0,1] op_sel_hi:[1,1]
  v_pk_mul_f32 v[238:239], v[238:239], s[42:43] op_sel:[0,1] op_sel_hi:[1,1]
  v_cvt_pk_bf16_f32 v116, v232, v233
  v_cvt_pk_bf16_f32 v117, v234, v235
  v_cvt_pk_bf16_f32 v118, v236, v237
  v_cvt_pk_bf16_f32 v119, v238, v239
  v_pk_mul_f32 v[240:241], v[240:241], s[42:43] op_sel:[0,1] op_sel_hi:[1,1]
  v_pk_mul_f32 v[242:243], v[242:243], s[42:43] op_sel:[0,1] op_sel_hi:[1,1]
  v_pk_mul_f32 v[244:245], v[244:245], s[42:43] op_sel:[0,1] op_sel_hi:[1,1]
  v_pk_mul_f32 v[246:247], v[246:247], s[42:43] op_sel:[0,1] op_sel_hi:[1,1]
  v_cvt_pk_bf16_f32 v120, v240, v241
  v_cvt_pk_bf16_f32 v121, v242, v243
  v_cvt_pk_bf16_f32 v122, v244, v245
  v_cvt_pk_bf16_f32 v123, v246, v247
  v_pk_mul_f32 v[248:249], v[248:249], s[42:43] op_sel:[0,1] op_sel_hi:[1,1]
  v_pk_mul_f32 v[250:251], v[250:251], s[42:43] op_sel:[0,1] op_sel_hi:[1,1]
  v_pk_mul_f32 v[252:253], v[252:253], s[42:43] op_sel:[0,1] op_sel_hi:[1,1]
  v_pk_mul_f32 v[254:255], v[254:255], s[42:43] op_sel:[0,1] op_sel_hi:[1,1]
  v_cvt_pk_bf16_f32 v124, v248, v249
  v_cvt_pk_bf16_f32 v125, v250, v251
  v_cvt_pk_bf16_f32 v126, v252, v253
  v_cvt_pk_bf16_f32 v127, v254, v255
  v_mfma_f32_32x32x16_bf16 v[144:159], a[128:131], v[96:99], 0
  ds_read_b64_tr_b16 a[160:161], v10
  ds_read_b64_tr_b16 a[162:163], v10 offset:2048
  v_mfma_f32_32x32x16_bf16 v[144:159], a[132:135], v[100:103], v[144:159]
  ds_read_b64_tr_b16 a[164:165], v11
  ds_read_b64_tr_b16 a[166:167], v11 offset:2048
  v_mfma_f32_32x32x16_bf16 v[144:159], a[136:139], v[104:107], v[144:159]
  ds_read_b64_tr_b16 a[168:169], v12
  ds_read_b64_tr_b16 a[170:171], v12 offset:2048
  v_mfma_f32_32x32x16_bf16 v[144:159], a[140:143], v[108:111], v[144:159]
  ds_read_b64_tr_b16 a[172:173], v13
  ds_read_b64_tr_b16 a[174:175], v13 offset:2048
  v_max3_f32 v28, v128, v129, v130
  v_max3_f32 v28, v28, v131, v132
  v_max3_f32 v28, v28, v133, v134
  v_max3_f32 v28, v28, v135, v136
  v_max3_f32 v28, v28, v137, v138
  v_max3_f32 v28, v28, v139, v140
  v_mfma_f32_32x32x16_bf16 v[144:159], a[144:147], v[112:115], v[144:159]
  ds_read_b64_tr_b16 a[176:177], v10 offset:4096
  ds_read_b64_tr_b16 a[178:179], v10 offset:6144
  v_max3_f32 v28, v28, v141, v142
  v_max_f32 v28, v28, v143
  v_mov_b32 v29, v28
  s_nop 1
  v_permlane32_swap_b32 v28, v29
  v_max_f32 v28, v28, v29
  v_sub_f32 v160, 0, v28
  v_mfma_f32_32x32x16_bf16 v[144:159], a[148:151], v[116:119], v[144:159]
  ds_read_b64_tr_b16 a[180:181], v11 offset:4096
  ds_read_b64_tr_b16 a[182:183], v11 offset:6144
  v_mov_b32 v161, v160
  v_mov_b32 v162, v160
  v_mov_b32 v163, v160
  v_mov_b32 v164, v160
  v_mov_b32 v165, v160
  v_mov_b32 v166, v160
  v_mfma_f32_32x32x16_bf16 v[144:159], a[152:155], v[120:123], v[144:159]
  ds_read_b64_tr_b16 a[184:185], v12 offset:4096
  ds_read_b64_tr_b16 a[186:187], v12 offset:6144
  v_mov_b32 v167, v160
  v_mov_b32 v168, v160
  v_mov_b32 v169, v160
  v_mov_b32 v170, v160
  v_mov_b32 v171, v160
  v_mov_b32 v172, v160
  v_mfma_f32_32x32x16_bf16 v[144:159], a[156:159], v[124:127], v[144:159]
  ds_read_b64_tr_b16 a[188:189], v13 offset:4096
  ds_read_b64_tr_b16 a[190:191], v13 offset:6144
  v_mov_b32 v173, v160
  v_mov_b32 v174, v160
  v_mov_b32 v175, v160
  v_sub_f32 v128, v128, v28
  v_sub_f32 v129, v129, v28
  v_sub_f32 v130, v130, v28
  v_sub_f32 v131, v131, v28
  v_sub_f32 v132, v132, v28
  v_sub_f32 v133, v133, v28
  v_sub_f32 v134, v134, v28
  v_sub_f32 v135, v135, v28
  v_sub_f32 v136, v136, v28
  v_sub_f32 v137, v137, v28
  v_sub_f32 v138, v138, v28
  v_sub_f32 v139, v139, v28
  v_sub_f32 v140, v140, v28
  v_sub_f32 v141, v141, v28
  v_sub_f32 v142, v142, v28
  v_sub_f32 v143, v143, v28
  v_exp_f32 v16, v128
  v_exp_f32 v17, v129
  v_exp_f32 v18, v130
  v_add_f32 v24, v16, v17
  v_cvt_pk_bf16_f32 v32, v16, v17
  v_exp_f32 v19, v131
  v_add_f32 v24, v24, v18
  v_exp_f32 v20, v132
  v_add_f32 v24, v24, v19
  v_cvt_pk_bf16_f32 v33, v18, v19
  v_exp_f32 v21, v133
  v_add_f32 v24, v24, v20
  v_exp_f32 v22, v134
  v_add_f32 v24, v24, v21
  v_cvt_pk_bf16_f32 v34, v20, v21
  v_exp_f32 v23, v135
  v_add_f32 v24, v24, v22
  v_exp_f32 v16, v136
  v_add_f32 v24, v24, v23
  v_cvt_pk_bf16_f32 v35, v22, v23
  v_exp_f32 v17, v137
  v_add_f32 v24, v24, v16
  v_exp_f32 v18, v138
  v_add_f32 v24, v24, v17
  v_cvt_pk_bf16_f32 v36, v16, v17
  v_exp_f32 v19, v139
  v_add_f32 v24, v24, v18
  v_exp_f32 v20, v140
  v_add_f32 v24, v24, v19
  v_cvt_pk_bf16_f32 v37, v18, v19
  v_exp_f32 v21, v141
  v_add_f32 v24, v24, v20
  v_exp_f32 v22, v142
  v_add_f32 v24, v24, v21
  v_cvt_pk_bf16_f32 v38, v20, v21
  v_exp_f32 v23, v143
  v_add_f32 v24, v24, v22
  v_add_f32 v24, v24, v23
  v_cvt_pk_bf16_f32 v39, v22, v23
  v_mov_b32 v26, v24
  v_max3_f32 v28, v144, v145, v146
  v_max3_f32 v28, v28, v147, v148
  v_max3_f32 v28, v28, v149, v150
  v_max3_f32 v28, v28, v151, v152
  v_max3_f32 v28, v28, v153, v154
  v_max3_f32 v28, v28, v155, v156
  v_max3_f32 v28, v28, v157, v158
  v_max_f32 v28, v28, v159
  v_mov_b32 v29, v28
  s_nop 1
  v_permlane32_swap_b32 v28, v29
  v_max_f32 v28, v28, v29
  v_sub_f32 v176, 0, v28
  v_mov_b32 v177, v176
  v_mov_b32 v178, v176
  v_mov_b32 v179, v176
  v_mov_b32 v180, v176
  v_mov_b32 v181, v176
  v_mov_b32 v182, v176
  v_mov_b32 v183, v176
  v_mov_b32 v184, v176
  v_mov_b32 v185, v176
  v_mov_b32 v186, v176
  v_mov_b32 v187, v176
  v_mov_b32 v188, v176
  v_mov_b32 v189, v176
  v_mov_b32 v190, v176
  v_mov_b32 v191, v176
  v_sub_f32 v144, v144, v28
  v_sub_f32 v145, v145, v28
  v_sub_f32 v146, v146, v28
  v_sub_f32 v147, v147, v28
  v_sub_f32 v148, v148, v28
  v_sub_f32 v149, v149, v28
  v_sub_f32 v150, v150, v28
  v_sub_f32 v151, v151, v28
  v_sub_f32 v152, v152, v28
  v_sub_f32 v153, v153, v28
  v_sub_f32 v154, v154, v28
  v_sub_f32 v155, v155, v28
  v_sub_f32 v156, v156, v28
  v_sub_f32 v157, v157, v28
  v_sub_f32 v158, v158, v28
  v_sub_f32 v159, v159, v28
  v_mov_b32 v27, 0
  v_lshrrev_b32 v52, 3, v0
  v_mul_u32_u24 v52, 0x480, v52
  v_and_b32 v53, 7, v0
  v_bfe_u32 v54, v0, 4, 1
  v_lshlrev_b32 v54, 2, v54
  v_xor_b32 v53, v53, v54
  v_lshl_add_u32 v48, v53, 4, v52
  v_add_u32 v49, 0x2000, v48
  v_and_b32 v52, 1, v0
  v_lshlrev_b32 v52, 1, v52
  v_bfe_u32 v53, v0, 1, 1
  v_or_b32 v52, v52, v53
  v_lshlrev_b32 v52, 3, v52
  v_bfe_u32 v53, v0, 4, 1
  v_lshl_or_b32 v52, v53, 5, v52
  v_bfe_u32 v53, v0, 2, 2
  v_lshrrev_b32 v54, 5, v0
  v_lshl_add_u32 v54, v54, 3, v53
  v_lshl_add_u32 v52, v54, 7, v52
  v_lshrrev_b32 v53, 1, v53
  v_mov_b32 v54, s28
  v_and_b32 v54, 1, v54
  v_xor_b32 v53, v53, v54
  v_lshl_add_u32 v50, v53, 6, v52
  v_xor_b32 v53, 1, v53
  v_lshl_add_u32 v51, v53, 6, v52
  v_add_u32 v52, s60, v50
  v_add_u32 v53, s60, v51
  s_mov_b32 s40, 0
A_LOOP2:
  s_waitcnt lgkmcnt(14)
  v_mfma_f32_32x32x16_bf16 a[0:15], a[160:163], v[32:35], a[0:15]
  ds_read_b128 a[128:131], v2 offset:40960
  s_waitcnt lgkmcnt(13)
  v_mfma_f32_32x32x16_bf16 a[16:31], a[164:167], v[32:35], a[16:31]
  ds_read_b128 a[132:135], v3 offset:40960
  v_exp_f32 v16, v144
  v_exp_f32 v17, v145
  s_waitcnt lgkmcnt(12)
  v_mfma_f32_32x32x16_bf16 a[32:47], a[168:171], v[32:35], a[32:47]
  ds_read_b128 a[136:139], v4 offset:40960
  v_exp_f32 v18, v146
  v_add_f32 v25, v16, v17
  v_cvt_pk_bf16_f32 v40, v16, v17
  s_waitcnt lgkmcnt(11)
  v_mfma_f32_32x32x16_bf16 a[48:63], a[172:175], v[32:35], a[48:63]
  ds_read_b128 a[140:143], v5 offset:40960
  v_exp_f32 v19, v147
  v_add_f32 v25, v25, v18
  s_waitcnt lgkmcnt(10)
  v_mfma_f32_32x32x16_bf16 a[0:15], a[176:179], v[36:39], a[0:15]
  ds_read_b128 a[144:147], v6 offset:40960
  v_exp_f32 v20, v148
  v_add_f32 v25, v25, v19
  v_cvt_pk_bf16_f32 v41, v18, v19
  s_waitcnt lgkmcnt(9)
  v_mfma_f32_32x32x16_bf16 a[16:31], a[180:183], v[36:39], a[16:31]
  ds_read_b128 a[148:151], v7 offset:40960
  v_exp_f32 v21, v149
  v_add_f32 v25, v25, v20
  v_exp_f32 v22, v150
  s_waitcnt lgkmcnt(8)
  v_mfma_f32_32x32x16_bf16 a[32:47], a[184:187], v[36:39], a[32:47]
  ds_read_b128 a[152:155], v8 offset:40960
  v_add_f32 v25, v25, v21
  v_cvt_pk_bf16_f32 v42, v20, v21
  v_exp_f32 v23, v151
  s_waitcnt lgkmcnt(7)
  v_mfma_f32_32x32x16_bf16 a[48:63], a[188:191], v[36:39], a[48:63]
  ds_read_b128 a[156:159], v9 offset:40960
  v_add_f32 v25, v25, v22
  v_exp_f32 v16, v152
  s_waitcnt lgkmcnt(7)
  v_mfma_f32_32x32x16_bf16 v[128:143], a[128:131], v[64:67], v[160:175]
  v_add_f32 v25, v25, v23
  v_cvt_pk_bf16_f32 v43, v22, v23
  v_exp_f32 v17, v153
  s_waitcnt lgkmcnt(6)
  v_mfma_f32_32x32x16_bf16 v[128:143], a[132:135], v[68:71], v[128:143]
  v_add_f32 v25, v25, v16
  v_exp_f32 v18, v154
  v_add_f32 v25, v25, v17
  s_waitcnt lgkmcnt(5)
  v_mfma_f32_32x32x16_bf16 v[128:143], a[136:139], v[72:75], v[128:143]
  v_cvt_pk_bf16_f32 v44, v16, v17
  v_exp_f32 v19, v155
  v_add_f32 v25, v25, v18
  s_waitcnt lgkmcnt(4)
  v_mfma_f32_32x32x16_bf16 v[128:143], a[140:143], v[76:79], v[128:143]
  v_exp_f32 v20, v156
  v_add_f32 v25, v25, v19
  v_cvt_pk_bf16_f32 v45, v18, v19
  s_waitcnt lgkmcnt(3)
  v_mfma_f32_32x32x16_bf16 v[128:143], a[144:147], v[80:83], v[128:143]
  v_exp_f32 v21, v157
  v_add_f32 v25, v25, v20
  s_waitcnt lgkmcnt(2)
  v_mfma_f32_32x32x16_bf16 v[128:143], a[148:151], v[84:87], v[128:143]
  v_exp_f32 v22, v158
  v_add_f32 v25, v25, v21
  v_cvt_pk_bf16_f32 v46, v20, v21
  s_waitcnt lgkmcnt(1)
  v_mfma_f32_32x32x16_bf16 v[128:143], a[152:155], v[88:91], v[128:143]
  v_exp_f32 v23, v159
  v_add_f32 v25, v25, v22
  v_add_f32 v25, v25, v23
  s_waitcnt lgkmcnt(0)
  v_mfma_f32_32x32x16_bf16 v[128:143], a[156:159], v[92:95], v[128:143]
  s_barrier
  v_cvt_pk_bf16_f32 v47, v22, v23
  v_cmp_nge_f32 vcc, s42, v25
  s_nop 0
  s_cbranch_vccnz FBS_0
RET_0:
  v_add_f32 v27, v27, v25
  v_mfma_f32_32x32x16_bf16 a[64:79], a[160:163], v[40:43], a[64:79]
  ds_read_b64_tr_b16 a[160:161], v10 offset:32768
  v_mfma_f32_32x32x16_bf16 a[80:95], a[164:167], v[40:43], a[80:95]
  ds_read_b64_tr_b16 a[162:163], v10 offset:34816
  v_exp_f32 v16, v128
  v_exp_f32 v17, v129
  v_mfma_f32_32x32x16_bf16 a[96:111], a[168:171], v[40:43], a[96:111]
  ds_read_b64_tr_b16 a[164:165], v11 offset:32768
  v_exp_f32 v18, v130
  v_add_f32 v24, v16, v17
  v_cvt_pk_bf16_f32 v32, v16, v17
  v_mfma_f32_32x32x16_bf16 a[112:127], a[172:175], v[40:43], a[112:127]
  ds_read_b64_tr_b16 a[166:167], v11 offset:34816
  v_exp_f32 v19, v131
  s_branch PADO_3
PADA_3:
  s_branch HOPRET_g2
PAD_3:
  s_sub_u32 s40, s40, 1
  s_cbranch_scc1 HOPRET_gb
  s_branch PAD_10
PADO_3:
  v_add_f32 v24, v24, v18
  v_mfma_f32_32x32x16_bf16 a[64:79], a[176:179], v[44:47], a[64:79]
  ds_read_b64_tr_b16 a[168:169], v12 offset:32768
  v_exp_f32 v20, v132
  v_add_f32 v24, v24, v19
  v_cvt_pk_bf16_f32 v33, v18, v19
  v_mfma_f32_32x32x16_bf16 a[80:95], a[180:183], v[44:47], a[80:95]
  ds_read_b64_tr_b16 a[170:171], v12 offset:34816
  v_exp_f32 v21, v133
  v_add_f32 v24, v24, v20
  v_exp_f32 v22, v134
  v_mfma_f32_32x32x16_bf16 a[96:111], a[184:187], v[44:47], a[96:111]
  ds_read_b64_tr_b16 a[172:173], v13 offset:32768
  v_add_f32 v24, v24, v21
  v_cvt_pk_bf16_f32 v34, v20, v21
  v_exp_f32 v23, v135
  v_mfma_f32_32x32x16_bf16 a[112:127], a[188:191], v[44:47], a[112:127]
  ds_read_b64_tr_b16 a[174:175], v13 offset:34816
  v_add_f32 v24, v24, v22
  v_exp_f32 v16, v136
  v_mfma_f32_32x32x16_bf16 v[144:159], a[128:131], v[96:99], v[176:191]
  ds_read_b64_tr_b16 a[176:177], v10 offset:36864
  v_add_f32 v24, v24, v23
  v_cvt_pk_bf16_f32 v35, v22, v23
  v_exp_f32 v17, v137
  v_mfma_f32_32x32x16_bf16 v[144:159], a[132:135], v[100:103], v[144:159]
  ds_read_b64_tr_b16 a[178:179], v10 offset:38912
  v_add_f32 v24, v24, v16
  v_exp_f32 v18, v138
  v_add_f32 v24, v24, v17
  v_mfma_f32_32x32x16_bf16 v[144:159], a[136:139], v[104:107], v[144:159]
  ds_read_b64_tr_b16 a[180:181], v11 offset:36864
  v_cvt_pk_bf16_f32 v36, v16, v17
  v_exp_f32 v19, v139
  v_add_f32 v24, v24, v18
  v_mfma_f32_32x32x16_bf16 v[144:159], a[140:143], v[108:111], v[144:159]
  ds_read_b64_tr_b16 a[182:183], v11 offset:38912
  v_exp_f32 v20, v140
  v_add_f32 v24, v24, v19
  v_cvt_pk_bf16_f32 v37, v18, v19
  v_mfma_f32_32x32x16_bf16 v[144:159], a[144:147], v[112:115], v[144:159]
  ds_read_b64_tr_b16 a[184:185], v12 offset:36864
  v_exp_f32 v21, v141
  v_add_f32 v24, v24, v20
  v_mfma_f32_32x32x16_bf16 v[144:159], a[148:151], v[116:119], v[144:159]
  ds_read_b64_tr_b16 a[186:187], v12 offset:38912
  v_exp_f32 v22, v142
  v_add_f32 v24, v24, v21
  v_cvt_pk_bf16_f32 v38, v20, v21
  v_mfma_f32_32x32x16_bf16 v[144:159], a[152:155], v[120:123], v[144:159]
  ds_read_b64_tr_b16 a[188:189], v13 offset:36864
  v_exp_f32 v23, v143
  v_add_f32 v24, v24, v22
  v_add_f32 v24, v24, v23
  v_mfma_f32_32x32x16_bf16 v[144:159], a[156:159], v[124:127], v[144:159]
  ds_read_b64_tr_b16 a[190:191], v13 offset:38912
  v_cvt_pk_bf16_f32 v39, v22, v23
  v_cmp_nge_f32 vcc, s42, v24
  s_nop 0
  s_cbranch_vccnz FBS_1
RET_1:
  v_add_f32 v26, v26, v24
  s_waitcnt lgkmcnt(14)
  v_mfma_f32_32x32x16_bf16 a[0:15], a[160:163], v[32:35], a[0:15]
  ds_read_b128 a[128:131], v2
  s_waitcnt lgkmcnt(13)
  v_mfma_f32_32x32x16_bf16 a[16:31], a[164:167], v[32:35], a[16:31]
  ds_read_b128 a[132:135], v3
  v_exp_f32 v16, v144
  v_exp_f32 v17, v145
  s_waitcnt lgkmcnt(12)
  v_mfma_f32_32x32x16_bf16 a[32:47], a[168:171], v[32:35], a[32:47]
  ds_read_b128 a[136:139], v4
  v_exp_f32 v18, v146
  v_add_f32 v25, v16, v17
  v_cvt_pk_bf16_f32 v40, v16, v17
  s_waitcnt lgkmcnt(11)
  v_mfma_f32_32x32x16_bf16 a[48:63], a[172:175], v[32:35], a[48:63]
  ds_read_b128 a[140:143], v5
  v_exp_f32 v19, v147
  v_add_f32 v25, v25, v18
  s_waitcnt lgkmcnt(10)
  v_mfma_f32_32x32x16_bf16 a[0:15], a[176:179], v[36:39], a[0:15]
  ds_read_b128 a[144:147], v6
  v_exp_f32 v20, v148
  v_add_f32 v25, v25, v19
  v_cvt_pk_bf16_f32 v41, v18, v19
  s_waitcnt lgkmcnt(9)
  v_mfma_f32_32x32x16_bf16 a[16:31], a[180:183], v[36:39], a[16:31]
  ds_read_b128 a[148:151], v7
  v_exp_f32 v21, v149
  v_add_f32 v25, v25, v20
  v_exp_f32 v22, v150
  s_waitcnt lgkmcnt(8)
  v_mfma_f32_32x32x16_bf16 a[32:47], a[184:187], v[36:39], a[32:47]
  ds_read_b128 a[152:155], v8
  v_add_f32 v25, v25, v21
  v_cvt_pk_bf16_f32 v42, v20, v21
  v_exp_f32 v23, v151
  s_waitcnt lgkmcnt(7)
  v_mfma_f32_32x32x16_bf16 a[48:63], a[188:191], v[36:39], a[48:63]
  ds_read_b128 a[156:159], v9
  v_add_f32 v25, v25, v22
  v_exp_f32 v16, v152
  s_waitcnt lgkmcnt(7)
  v_mfma_f32_32x32x16_bf16 v[128:143], a[128:131], v[64:67], v[160:175]
  v_add_f32 v25, v25, v23
  v_cvt_pk_bf16_f32 v43, v22, v23
  v_exp_f32 v17, v153
  s_waitcnt lgkmcnt(6)
  v_mfma_f32_32x32x16_bf16 v[128:143], a[132:135], v[68:71], v[128:143]
  v_add_f32 v25, v25, v16
  v_exp_f32 v18, v154
  v_add_f32 v25, v25, v17
  s_waitcnt lgkmcnt(5)
  v_mfma_f32_32x32x16_bf16 v[128:143], a[136:139], v[72:75], v[128:143]
  v_cvt_pk_bf16_f32 v44, v16, v17
  v_exp_f32 v19, v155
  v_add_f32 v25, v25, v18
  s_waitcnt lgkmcnt(4)
  v_mfma_f32_32x32x16_bf16 v[128:143], a[140:143], v[76:79], v[128:143]
  v_exp_f32 v20, v156
  v_add_f32 v25, v25, v19
  v_cvt_pk_bf16_f32 v45, v18, v19
  s_waitcnt lgkmcnt(3)
  v_mfma_f32_32x32x16_bf16 v[128:143], a[144:147], v[80:83], v[128:143]
  v_exp_f32 v21, v157
  v_add_f32 v25, v25, v20
  s_waitcnt lgkmcnt(2)
  v_mfma_f32_32x32x16_bf16 v[128:143], a[148:151], v[84:87], v[128:143]
  v_exp_f32 v22, v158
  v_add_f32 v25, v25, v21
  v_cvt_pk_bf16_f32 v46, v20, v21
  s_waitcnt lgkmcnt(1)
  v_mfma_f32_32x32x16_bf16 v[128:143], a[152:155], v[88:91], v[128:143]
  v_exp_f32 v23, v159
  v_add_f32 v25, v25, v22
  v_add_f32 v25, v25, v23
  s_waitcnt lgkmcnt(0)
  v_mfma_f32_32x32x16_bf16 v[128:143], a[156:159], v[92:95], v[128:143]
  s_barrier
  v_cvt_pk_bf16_f32 v47, v22, v23
  v_cmp_nge_f32 vcc, s42, v25
  s_nop 0
  s_cbranch_vccnz FBS_2
RET_2:
  v_add_f32 v27, v27, v25
  v_mfma_f32_32x32x16_bf16 a[64:79], a[160:163], v[40:43], a[64:79]
  ds_read_b64_tr_b16 a[160:161], v10 offset:40960
  v_mfma_f32_32x32x16_bf16 a[80:95], a[164:167], v[40:43], a[80:95]
  ds_read_b64_tr_b16 a[162:163], v10 offset:43008
  v_exp_f32 v16, v128
  v_exp_f32 v17, v129
  v_mfma_f32_32x32x16_bf16 a[96:111], a[168:171], v[40:43], a[96:111]
  ds_read_b64_tr_b16 a[164:165], v11 offset:40960
  v_exp_f32 v18, v130
  v_add_f32 v24, v16, v17
  v_cvt_pk_bf16_f32 v32, v16, v17
  v_mfma_f32_32x32x16_bf16 a[112:127], a[172:175], v[40:43], a[112:127]
  ds_read_b64_tr_b16 a[166:167], v11 offset:43008
  v_exp_f32 v19, v131
  v_add_f32 v24, v24, v18
  v_mfma_f32_32x32x16_bf16 a[64:79], a[176:179], v[44:47], a[64:79]
  ds_read_b64_tr_b16 a[168:169], v12 offset:40960
  v_exp_f32 v20, v132
  v_add_f32 v24, v24, v19
  v_cvt_pk_bf16_f32 v33, v18, v19
  v_mfma_f32_32x32x16_bf16 a[80:95], a[180:183], v[44:47], a[80:95]
  ds_read_b64_tr_b16 a[170:171], v12 offset:43008
  v_exp_f32 v21, v133
  v_add_f32 v24, v24, v20
  v_exp_f32 v22, v134
  v_mfma_f32_32x32x16_bf16 a[96:111], a[184:187], v[44:47], a[96:111]
  ds_read_b64_tr_b16 a[172:173], v13 offset:40960
  v_add_f32 v24, v24, v21
  v_cvt_pk_bf16_f32 v34, v20, v21
  v_exp_f32 v23, v135
  v_mfma_f32_32x32x16_bf16 a[112:127], a[188:191], v[44:47], a[112:127]
  ds_read_b64_tr_b16 a[174:175], v13 offset:43008
  v_add_f32 v24, v24, v22
  v_exp_f32 v16, v136
  v_mfma_f32_32x32x16_bf16 v[144:159], a[128:131], v[96:99], v[176:191]
  ds_read_b64_tr_b16 a[176:177], v10 offset:45056
  v_add_f32 v24, v24, v23
  v_cvt_pk_bf16_f32 v35, v22, v23
  v_exp_f32 v17, v137
  v_mfma_f32_32x32x16_bf16 v[144:159], a[132:135], v[100:103], v[144:159]
  ds_read_b64_tr_b16 a[178:179], v10 offset:47104
  v_add_f32 v24, v24, v16
  v_exp_f32 v18, v138
  v_add_f32 v24, v24, v17
  v_mfma_f32_32x32x16_bf16 v[144:159], a[136:139], v[104:107], v[144:159]
  ds_read_b64_tr_b16 a[180:181], v11 offset:45056
  v_cvt_pk_bf16_f32 v36, v16, v17
  v_exp_f32 v19, v139
  v_add_f32 v24, v24, v18
  v_mfma_f32_32x32x16_bf16 v[144:159], a[140:143], v[108:111], v[144:159]
  ds_read_b64_tr_b16 a[182:183], v11 offset:47104
  v_exp_f32 v20, v140
  v_add_f32 v24, v24, v19
  v_cvt_pk_bf16_f32 v37, v18, v19
  v_mfma_f32_32x32x16_bf16 v[144:159], a[144:147], v[112:115], v[144:159]
  ds_read_b64_tr_b16 a[184:185], v12 offset:45056
  v_exp_f32 v21, v141
  v_add_f32 v24, v24, v20
  v_mfma_f32_32x32x16_bf16 v[144:159], a[148:151], v[116:119], v[144:159]
  ds_read_b64_tr_b16 a[186:187], v12 offset:47104
  v_exp_f32 v22, v142
  v_add_f32 v24, v24, v21
  v_cvt_pk_bf16_f32 v38, v20, v21
  v_mfma_f32_32x32x16_bf16 v[144:159], a[152:155], v[120:123], v[144:159]
  ds_read_b64_tr_b16 a[188:189], v13 offset:45056
  v_exp_f32 v23, v143
  v_add_f32 v24, v24, v22
  v_add_f32 v24, v24, v23
  v_mfma_f32_32x32x16_bf16 v[144:159], a[156:159], v[124:127], v[144:159]
  ds_read_b64_tr_b16 a[190:191], v13 offset:47104
  v_cvt_pk_bf16_f32 v39, v22, v23
  v_cmp_nge_f32 vcc, s42, v24
  s_nop 0
  s_cbranch_vccnz FBS_3
RET_3:
  v_add_f32 v26, v26, v24
  s_waitcnt lgkmcnt(14)
  v_mfma_f32_32x32x16_bf16 a[0:15], a[160:163], v[32:35], a[0:15]
  ds_read_b128 a[128:131], v2 offset:8192
  s_waitcnt lgkmcnt(13)
  v_mfma_f32_32x32x16_bf16 a[16:31], a[164:167], v[32:35], a[16:31]
  ds_read_b128 a[132:135], v3 offset:8192
  v_exp_f32 v16, v144
  v_exp_f32 v17, v145
  s_waitcnt lgkmcnt(12)
  v_mfma_f32_32x32x16_bf16 a[32:47], a[168:171], v[32:35], a[32:47]
  ds_read_b128 a[136:139], v4 offset:8192
  v_exp_f32 v18, v146
  v_add_f32 v25, v16, v17
  v_cvt_pk_bf16_f32 v40, v16, v17
  s_waitcnt lgkmcnt(11)
  v_mfma_f32_32x32x16_bf16 a[48:63], a[172:175], v[32:35], a[48:63]
  ds_read_b128 a[140:143], v5 offset:8192
  v_exp_f32 v19, v147
  v_add_f32 v25, v25, v18
  s_waitcnt lgkmcnt(10)
  v_mfma_f32_32x32x16_bf16 a[0:15], a[176:179], v[36:39], a[0:15]
  ds_read_b128 a[144:147], v6 offset:8192
  v_exp_f32 v20, v148
  v_add_f32 v25, v25, v19
  v_cvt_pk_bf16_f32 v41, v18, v19
  s_waitcnt lgkmcnt(9)
  v_mfma_f32_32x32x16_bf16 a[16:31], a[180:183], v[36:39], a[16:31]
  ds_read_b128 a[148:151], v7 offset:8192
  v_exp_f32 v21, v149
  v_add_f32 v25, v25, v20
  v_exp_f32 v22, v150
  s_waitcnt lgkmcnt(8)
  v_mfma_f32_32x32x16_bf16 a[32:47], a[184:187], v[36:39], a[32:47]
  ds_read_b128 a[152:155], v8 offset:8192
  v_add_f32 v25, v25, v21
  v_cvt_pk_bf16_f32 v42, v20, v21
  v_exp_f32 v23, v151
  s_waitcnt lgkmcnt(7)
  v_mfma_f32_32x32x16_bf16 a[48:63], a[188:191], v[36:39], a[48:63]
  ds_read_b128 a[156:159], v9 offset:8192
  v_add_f32 v25, v25, v22
  v_exp_f32 v16, v152
  s_waitcnt lgkmcnt(7)
  v_mfma_f32_32x32x16_bf16 v[128:143], a[128:131], v[64:67], v[160:175]
  v_add_f32 v25, v25, v23
  v_cvt_pk_bf16_f32 v43, v22, v23
  v_exp_f32 v17, v153
  s_waitcnt lgkmcnt(6)
  v_mfma_f32_32x32x16_bf16 v[128:143], a[132:135], v[68:71], v[128:143]
  v_add_f32 v25, v25, v16
  v_exp_f32 v18, v154
  v_add_f32 v25, v25, v17
  s_waitcnt lgkmcnt(5)
  v_mfma_f32_32x32x16_bf16 v[128:143], a[136:139], v[72:75], v[128:143]
  v_cvt_pk_bf16_f32 v44, v16, v17
  v_exp_f32 v19, v155
  v_add_f32 v25, v25, v18
  s_waitcnt lgkmcnt(4)
  v_mfma_f32_32x32x16_bf16 v[128:143], a[140:143], v[76:79], v[128:143]
  v_exp_f32 v20, v156
  v_add_f32 v25, v25, v19
  v_cvt_pk_bf16_f32 v45, v18, v19
  s_waitcnt lgkmcnt(3)
  v_mfma_f32_32x32x16_bf16 v[128:143], a[144:147], v[80:83], v[128:143]
  v_exp_f32 v21, v157
  v_add_f32 v25, v25, v20
  s_waitcnt lgkmcnt(2)
  v_mfma_f32_32x32x16_bf16 v[128:143], a[148:151], v[84:87], v[128:143]
  v_exp_f32 v22, v158
  v_add_f32 v25, v25, v21
  v_cvt_pk_bf16_f32 v46, v20, v21
  s_waitcnt lgkmcnt(1)
  v_mfma_f32_32x32x16_bf16 v[128:143], a[152:155], v[88:91], v[128:143]
  v_exp_f32 v23, v159
  v_add_f32 v25, v25, v22
  v_add_f32 v25, v25, v23
  s_waitcnt lgkmcnt(0)
  v_mfma_f32_32x32x16_bf16 v[128:143], a[156:159], v[92:95], v[128:143]
  s_barrier
  v_cvt_pk_bf16_f32 v47, v22, v23
  v_cmp_nge_f32 vcc, s42, v25
  s_nop 0
  s_cbranch_vccnz FBS_4
RET_4:
  v_add_f32 v27, v27, v25
  v_mfma_f32_32x32x16_bf16 a[64:79], a[160:163], v[40:43], a[64:79]
  ds_read_b64_tr_b16 a[160:161], v10 offset:8192
  v_mfma_f32_32x32x16_bf16 a[80:95], a[164:167], v[40:43], a[80:95]
  ds_read_b64_tr_b16 a[162:163], v10 offset:10240
  v_exp_f32 v16, v128
  v_exp_f32 v17, v129
  v_mfma_f32_32x32x16_bf16 a[96:111], a[168:171], v[40:43], a[96:111]
  ds_read_b64_tr_b16 a[164:165], v11 offset:8192
  v_exp_f32 v18, v130
  v_add_f32 v24, v16, v17
  v_cvt_pk_bf16_f32 v32, v16, v17
  v_mfma_f32_32x32x16_bf16 a[112:127], a[172:175], v[40:43], a[112:127]
  ds_read_b64_tr_b16 a[166:167], v11 offset:10240
  v_exp_f32 v19, v131
  v_add_f32 v24, v24, v18
  v_mfma_f32_32x32x16_bf16 a[64:79], a[176:179], v[44:47], a[64:79]
  ds_read_b64_tr_b16 a[168:169], v12 offset:8192
  v_exp_f32 v20, v132
  v_add_f32 v24, v24, v19
  v_cvt_pk_bf16_f32 v33, v18, v19
  v_mfma_f32_32x32x16_bf16 a[80:95], a[180:183], v[44:47], a[80:95]
  ds_read_b64_tr_b16 a[170:171], v12 offset:10240
  v_exp_f32 v21, v133
  v_add_f32 v24, v24, v20
  v_exp_f32 v22, v134
  v_mfma_f32_32x32x16_bf16 a[96:111], a[184:187], v[44:47], a[96:111]
  ds_read_b64_tr_b16 a[172:173], v13 offset:8192
  v_add_f32 v24, v24, v21
  v_cvt_pk_bf16_f32 v34, v20, v21
  v_exp_f32 v23, v135
  v_mfma_f32_32x32x16_bf16 a[112:127], a[188:191], v[44:47], a[112:127]
  ds_read_b64_tr_b16 a[174:175], v13 offset:10240
  v_add_f32 v24, v24, v22
  v_exp_f32 v16, v136
  v_mfma_f32_32x32x16_bf16 v[144:159], a[128:131], v[96:99], v[176:191]
  ds_read_b64_tr_b16 a[176:177], v10 offset:12288
  v_add_f32 v24, v24, v23
  v_cvt_pk_bf16_f32 v35, v22, v23
  v_exp_f32 v17, v137
  v_mfma_f32_32x32x16_bf16 v[144:159], a[132:135], v[100:103], v[144:159]
  ds_read_b64_tr_b16 a[178:179], v10 offset:14336
  v_add_f32 v24, v24, v16
  v_exp_f32 v18, v138
  v_add_f32 v24, v24, v17
  v_mfma_f32_32x32x16_bf16 v[144:159], a[136:139], v[104:107], v[144:159]
  ds_read_b64_tr_b16 a[180:181], v11 offset:12288
  v_cvt_pk_bf16_f32 v36, v16, v17
  v_exp_f32 v19, v139
  v_add_f32 v24, v24, v18
  v_mfma_f32_32x32x16_bf16 v[144:159], a[140:143], v[108:111], v[144:159]
  ds_read_b64_tr_b16 a[182:183], v11 offset:14336
  v_exp_f32 v20, v140
  v_add_f32 v24, v24, v19
  v_cvt_pk_bf16_f32 v37, v18, v19
  v_mfma_f32_32x32x16_bf16 v[144:159], a[144:147], v[112:115], v[144:159]
  ds_read_b64_tr_b16 a[184:185], v12 offset:12288
  v_exp_f32 v21, v141
  v_add_f32 v24, v24, v20
  v_mfma_f32_32x32x16_bf16 v[144:159], a[148:151], v[116:119], v[144:159]
  ds_read_b64_tr_b16 a[186:187], v12 offset:14336
  v_exp_f32 v22, v142
  v_add_f32 v24, v24, v21
  v_cvt_pk_bf16_f32 v38, v20, v21
  v_mfma_f32_32x32x16_bf16 v[144:159], a[152:155], v[120:123], v[144:159]
  ds_read_b64_tr_b16 a[188:189], v13 offset:12288
  v_exp_f32 v23, v143
  v_add_f32 v24, v24, v22
  v_add_f32 v24, v24, v23
  v_mfma_f32_32x32x16_bf16 v[144:159], a[156:159], v[124:127], v[144:159]
  ds_read_b64_tr_b16 a[190:191], v13 offset:14336
  v_cvt_pk_bf16_f32 v39, v22, v23
  v_cmp_nge_f32 vcc, s42, v24
  s_nop 0
  s_cbranch_vccnz FBS_5
RET_5:
  v_add_f32 v26, v26, v24
  s_waitcnt lgkmcnt(14)
  v_mfma_f32_32x32x16_bf16 a[0:15], a[160:163], v[32:35], a[0:15]
  ds_read_b128 a[128:131], v2 offset:49152
  s_waitcnt lgkmcnt(13)
  v_mfma_f32_32x32x16_bf16 a[16:31], a[164:167], v[32:35], a[16:31]
  ds_read_b128 a[132:135], v3 offset:49152
  v_exp_f32 v16, v144
  v_exp_f32 v17, v145
  s_waitcnt lgkmcnt(12)
  v_mfma_f32_32x32x16_bf16 a[32:47], a[168:171], v[32:35], a[32:47]
  ds_read_b128 a[136:139], v4 offset:49152
  v_exp_f32 v18, v146
  v_add_f32 v25, v16, v17
  v_cvt_pk_bf16_f32 v40, v16, v17
  s_waitcnt lgkmcnt(11)
  v_mfma_f32_32x32x16_bf16 a[48:63], a[172:175], v[32:35], a[48:63]
  ds_read_b128 a[140:143], v5 offset:49152
  v_exp_f32 v19, v147
  v_add_f32 v25, v25, v18
  s_waitcnt lgkmcnt(10)
  v_mfma_f32_32x32x16_bf16 a[0:15], a[176:179], v[36:39], a[0:15]
  ds_read_b128 a[144:147], v6 offset:49152
  v_exp_f32 v20, v148
  v_add_f32 v25, v25, v19
  v_cvt_pk_bf16_f32 v41, v18, v19
  s_waitcnt lgkmcnt(9)
  v_mfma_f32_32x32x16_bf16 a[16:31], a[180:183], v[36:39], a[16:31]
  ds_read_b128 a[148:151], v7 offset:49152
  v_exp_f32 v21, v149
  v_add_f32 v25, v25, v20
  v_exp_f32 v22, v150
  s_waitcnt lgkmcnt(8)
  v_mfma_f32_32x32x16_bf16 a[32:47], a[184:187], v[36:39], a[32:47]
  ds_read_b128 a[152:155], v8 offset:49152
  v_add_f32 v25, v25, v21
  v_cvt_pk_bf16_f32 v42, v20, v21
  v_exp_f32 v23, v151
  s_waitcnt lgkmcnt(7)
  v_mfma_f32_32x32x16_bf16 a[48:63], a[188:191], v[36:39], a[48:63]
  ds_read_b128 a[156:159], v9 offset:49152
  v_add_f32 v25, v25, v22
  v_exp_f32 v16, v152
  s_waitcnt lgkmcnt(7)
  v_mfma_f32_32x32x16_bf16 v[128:143], a[128:131], v[64:67], v[160:175]
  v_add_f32 v25, v25, v23
  v_cvt_pk_bf16_f32 v43, v22, v23
  v_exp_f32 v17, v153
  s_waitcnt lgkmcnt(6)
  v_mfma_f32_32x32x16_bf16 v[128:143], a[132:135], v[68:71], v[128:143]
  s_cmp_eq_u32 s40, 0
  s_cbranch_scc0 V2_3_T_n0
  ds_read_b64_tr_b16 v[192:193], v52
  ds_read_b64_tr_b16 v[194:195], v52 offset:512
  ds_read_b64_tr_b16 v[196:197], v53
  ds_read_b64_tr_b16 v[198:199], v53 offset:512
  ds_read_b64_tr_b16 v[200:201], v52 offset:2048
  ds_read_b64_tr_b16 v[202:203], v52 offset:2560
  ds_read_b64_tr_b16 v[204:205], v53 offset:2048
  ds_read_b64_tr_b16 v[206:207], v53 offset:2560
  ds_read_b64_tr_b16 v[208:209], v52 offset:4096
  ds_read_b64_tr_b16 v[210:211], v52 offset:4608
  ds_read_b64_tr_b16 v[212:213], v53 offset:4096
  ds_read_b64_tr_b16 v[214:215], v53 offset:4608
  ds_read_b64_tr_b16 v[216:217], v52 offset:6144
  ds_read_b64_tr_b16 v[218:219], v52 offset:6656
  ds_read_b64_tr_b16 v[220:221], v53 offset:6144
  ds_read_b64_tr_b16 v[222:223], v53 offset:6656
  s_branch V2_3_T_ret
V2_3_T_n0:
  s_cmp_eq_u32 s40, 1
  s_cbranch_scc0 V2_3_T_n1
  ds_read_b64_tr_b16 v[224:225], v52
  ds_read_b64_tr_b16 v[226:227], v52 offset:512
  ds_read_b64_tr_b16 v[228:229], v53
  ds_read_b64_tr_b16 v[230:231], v53 offset:512
  ds_read_b64_tr_b16 v[232:233], v52 offset:2048
  ds_read_b64_tr_b16 v[234:235], v52 offset:2560
  ds_read_b64_tr_b16 v[236:237], v53 offset:2048
  ds_read_b64_tr_b16 v[238:239], v53 offset:2560
  ds_read_b64_tr_b16 v[240:241], v52 offset:4096
  ds_read_b64_tr_b16 v[242:243], v52 offset:4608
  ds_read_b64_tr_b16 v[244:245], v53 offset:4096
  ds_read_b64_tr_b16 v[246:247], v53 offset:4608
  ds_read_b64_tr_b16 v[248:249], v52 offset:6144
  ds_read_b64_tr_b16 v[250:251], v52 offset:6656
  ds_read_b64_tr_b16 v[252:253], v53 offset:6144
  ds_read_b64_tr_b16 v[254:255], v53 offset:6656
  s_branch V2_3_T_ret
V2_3_T_n1:
  s_cmp_eq_u32 s40, 2
  s_cbranch_scc0 V2_3_T_n2
  ds_read_b64_tr_b16 a[192:193], v52
  ds_read_b64_tr_b16 a[194:195], v52 offset:512
  ds_read_b64_tr_b16 a[196:197], v53
  ds_read_b64_tr_b16 a[198:199], v53 offset:512
  ds_read_b64_tr_b16 a[200:201], v52 offset:2048
  ds_read_b64_tr_b16 a[202:203], v52 offset:2560
  ds_read_b64_tr_b16 a[204:205], v53 offset:2048
  ds_read_b64_tr_b16 a[206:207], v53 offset:2560
  ds_read_b64_tr_b16 a[208:209], v52 offset:4096
  ds_read_b64_tr_b16 a[210:211], v52 offset:4608
  ds_read_b64_tr_b16 a[212:213], v53 offset:4096
  ds_read_b64_tr_b16 a[214:215], v53 offset:4608
  ds_read_b64_tr_b16 a[216:217], v52 offset:6144
  ds_read_b64_tr_b16 a[218:219], v52 offset:6656
  ds_read_b64_tr_b16 a[220:221], v53 offset:6144
  ds_read_b64_tr_b16 a[222:223], v53 offset:6656
  s_branch V2_3_T_ret
V2_3_T_n2:
  ds_read_b64_tr_b16 a[224:225], v52
  ds_read_b64_tr_b16 a[226:227], v52 offset:512
  ds_read_b64_tr_b16 a[228:229], v53
  ds_read_b64_tr_b16 a[230:231], v53 offset:512
  ds_read_b64_tr_b16 a[232:233], v52 offset:2048
  ds_read_b64_tr_b16 a[234:235], v52 offset:2560
  ds_read_b64_tr_b16 a[236:237], v53 offset:2048
  ds_read_b64_tr_b16 a[238:239], v53 offset:2560
  ds_read_b64_tr_b16 a[240:241], v52 offset:4096
  ds_read_b64_tr_b16 a[242:243], v52 offset:4608
  ds_read_b64_tr_b16 a[244:245], v53 offset:4096
  ds_read_b64_tr_b16 a[246:247], v53 offset:4608
  ds_read_b64_tr_b16 a[248:249], v52 offset:6144
  ds_read_b64_tr_b16 a[250:251], v52 offset:6656
  ds_read_b64_tr_b16 a[252:253], v53 offset:6144
  ds_read_b64_tr_b16 a[254:255], v53 offset:6656
V2_3_T_ret:
  v_add_f32 v25, v25, v16
  v_exp_f32 v18, v154
  v_add_f32 v25, v25, v17
  s_waitcnt lgkmcnt(15)
  v_mfma_f32_32x32x16_bf16 v[128:143], a[136:139], v[72:75], v[128:143]
  v_cvt_pk_bf16_f32 v44, v16, v17
  v_exp_f32 v19, v155
  v_add_f32 v25, v25, v18
  s_waitcnt lgkmcnt(15)
  v_mfma_f32_32x32x16_bf16 v[128:143], a[140:143], v[76:79], v[128:143]
  v_exp_f32 v20, v156
  v_add_f32 v25, v25, v19
  v_cvt_pk_bf16_f32 v45, v18, v19
  s_waitcnt lgkmcnt(15)
  v_mfma_f32_32x32x16_bf16 v[128:143], a[144:147], v[80:83], v[128:143]
  v_exp_f32 v21, v157
  v_add_f32 v25, v25, v20
  s_waitcnt lgkmcnt(15)
  v_mfma_f32_32x32x16_bf16 v[128:143], a[148:151], v[84:87], v[128:143]
  v_exp_f32 v22, v158
  v_add_f32 v25, v25, v21
  v_cvt_pk_bf16_f32 v46, v20, v21
  s_waitcnt lgkmcnt(15)
  v_mfma_f32_32x32x16_bf16 v[128:143], a[152:155], v[88:91], v[128:143]
  v_exp_f32 v23, v159
  v_add_f32 v25, v25, v22
  v_add_f32 v25, v25, v23
  s_waitcnt lgkmcnt(15)
  v_mfma_f32_32x32x16_bf16 v[128:143], a[156:159], v[92:95], v[128:143]
  s_waitcnt lgkmcnt(0)
  s_barrier
  v_cvt_pk_bf16_f32 v47, v22, v23
  v_cmp_nge_f32 vcc, s42, v25
  s_nop 0
  s_cbranch_vccnz FBS_6
RET_6:
  v_add_f32 v27, v27, v25
  v_mfma_f32_32x32x16_bf16 a[64:79], a[160:163], v[40:43], a[64:79]
  ds_read_b64_tr_b16 a[160:161], v10 offset:49152
  v_mfma_f32_32x32x16_bf16 a[80:95], a[164:167], v[40:43], a[80:95]
  ds_read_b64_tr_b16 a[162:163], v10 offset:51200
  v_exp_f32 v16, v128
  v_exp_f32 v17, v129
  v_mfma_f32_32x32x16_bf16 a[96:111], a[168:171], v[40:43], a[96:111]
  ds_read_b64_tr_b16 a[164:165], v11 offset:49152
  v_exp_f32 v18, v130
  v_add_f32 v24, v16, v17
  v_cvt_pk_bf16_f32 v32, v16, v17
  v_mfma_f32_32x32x16_bf16 a[112:127], a[172:175], v[40:43], a[112:127]
  ds_read_b64_tr_b16 a[166:167], v11 offset:51200
  v_exp_f32 v19, v131
  v_add_f32 v24, v24, v18
  v_mfma_f32_32x32x16_bf16 a[64:79], a[176:179], v[44:47], a[64:79]
  ds_read_b64_tr_b16 a[168:169], v12 offset:49152
  v_exp_f32 v20, v132
  v_add_f32 v24, v24, v19
  v_cvt_pk_bf16_f32 v33, v18, v19
  v_mfma_f32_32x32x16_bf16 a[80:95], a[180:183], v[44:47], a[80:95]
  ds_read_b64_tr_b16 a[170:171], v12 offset:51200
  v_exp_f32 v21, v133
  v_add_f32 v24, v24, v20
  v_exp_f32 v22, v134
  v_mfma_f32_32x32x16_bf16 a[96:111], a[184:187], v[44:47], a[96:111]
  ds_read_b64_tr_b16 a[172:173], v13 offset:49152
  v_add_f32 v24, v24, v21
  v_cvt_pk_bf16_f32 v34, v20, v21
  v_exp_f32 v23, v135
  v_mfma_f32_32x32x16_bf16 a[112:127], a[188:191], v[44:47], a[112:127]
  ds_read_b64_tr_b16 a[174:175], v13 offset:51200
  v_add_f32 v24, v24, v22
  v_exp_f32 v16, v136
  v_mfma_f32_32x32x16_bf16 v[144:159], a[128:131], v[96:99], v[176:191]
  ds_read_b64_tr_b16 a[176:177], v10 offset:53248
  v_add_f32 v24, v24, v23
  v_cvt_pk_bf16_f32 v35, v22, v23
  v_exp_f32 v17, v137
  v_mfma_f32_32x32x16_bf16 v[144:159], a[132:135], v[100:103], v[144:159]
  ds_read_b64_tr_b16 a[178:179], v10 offset:55296
  v_add_f32 v24, v24, v16
  v_exp_f32 v18, v138
  v_add_f32 v24, v24, v17
  v_mfma_f32_32x32x16_bf16 v[144:159], a[136:139], v[104:107], v[144:159]
  ds_read_b64_tr_b16 a[180:181], v11 offset:53248
  v_cvt_pk_bf16_f32 v36, v16, v17
  v_exp_f32 v19, v139
  v_add_f32 v24, v24, v18
  v_mfma_f32_32x32x16_bf16 v[144:159], a[140:143], v[108:111], v[144:159]
  ds_read_b64_tr_b16 a[182:183], v11 offset:55296
  v_exp_f32 v20, v140
  v_add_f32 v24, v24, v19
  v_cvt_pk_bf16_f32 v37, v18, v19
  v_mfma_f32_32x32x16_bf16 v[144:159], a[144:147], v[112:115], v[144:159]
  ds_read_b64_tr_b16 a[184:185], v12 offset:53248
  v_exp_f32 v21, v141
  v_add_f32 v24, v24, v20
  v_mfma_f32_32x32x16_bf16 v[144:159], a[148:151], v[116:119], v[144:159]
  ds_read_b64_tr_b16 a[186:187], v12 offset:55296
  v_exp_f32 v22, v142
  v_add_f32 v24, v24, v21
  v_cvt_pk_bf16_f32 v38, v20, v21
  v_mfma_f32_32x32x16_bf16 v[144:159], a[152:155], v[120:123], v[144:159]
  ds_read_b64_tr_b16 a[188:189], v13 offset:53248
  v_exp_f32 v23, v143
  v_add_f32 v24, v24, v22
  v_add_f32 v24, v24, v23
  v_mfma_f32_32x32x16_bf16 v[144:159], a[156:159], v[124:127], v[144:159]
  ds_read_b64_tr_b16 a[190:191], v13 offset:55296
  v_cvt_pk_bf16_f32 v39, v22, v23
  v_cmp_nge_f32 vcc, s42, v24
  s_nop 0
  s_cbranch_vccnz FBS_7
RET_7:
  v_add_f32 v26, v26, v24
  s_waitcnt lgkmcnt(14)
  v_mfma_f32_32x32x16_bf16 a[0:15], a[160:163], v[32:35], a[0:15]
  ds_read_b128 a[128:131], v2 offset:16384
  s_waitcnt lgkmcnt(13)
  v_mfma_f32_32x32x16_bf16 a[16:31], a[164:167], v[32:35], a[16:31]
  ds_read_b128 a[132:135], v3 offset:16384
  v_exp_f32 v16, v144
  v_exp_f32 v17, v145
  s_waitcnt lgkmcnt(12)
  v_mfma_f32_32x32x16_bf16 a[32:47], a[168:171], v[32:35], a[32:47]
  ds_read_b128 a[136:139], v4 offset:16384
  v_exp_f32 v18, v146
  v_add_f32 v25, v16, v17
  v_cvt_pk_bf16_f32 v40, v16, v17
  s_waitcnt lgkmcnt(11)
  v_mfma_f32_32x32x16_bf16 a[48:63], a[172:175], v[32:35], a[48:63]
  ds_read_b128 a[140:143], v5 offset:16384
  v_exp_f32 v19, v147
  v_add_f32 v25, v25, v18
  s_waitcnt lgkmcnt(10)
  v_mfma_f32_32x32x16_bf16 a[0:15], a[176:179], v[36:39], a[0:15]
  ds_read_b128 a[144:147], v6 offset:16384
  v_exp_f32 v20, v148
  v_add_f32 v25, v25, v19
  v_cvt_pk_bf16_f32 v41, v18, v19
  s_waitcnt lgkmcnt(9)
  v_mfma_f32_32x32x16_bf16 a[16:31], a[180:183], v[36:39], a[16:31]
  ds_read_b128 a[148:151], v7 offset:16384
  v_exp_f32 v21, v149
  v_add_f32 v25, v25, v20
  v_exp_f32 v22, v150
  s_waitcnt lgkmcnt(8)
  v_mfma_f32_32x32x16_bf16 a[32:47], a[184:187], v[36:39], a[32:47]
  ds_read_b128 a[152:155], v8 offset:16384
  v_add_f32 v25, v25, v21
  v_cvt_pk_bf16_f32 v42, v20, v21
  v_exp_f32 v23, v151
  s_waitcnt lgkmcnt(7)
  v_mfma_f32_32x32x16_bf16 a[48:63], a[188:191], v[36:39], a[48:63]
  ds_read_b128 a[156:159], v9 offset:16384
  v_add_f32 v25, v25, v22
  v_exp_f32 v16, v152
  s_waitcnt lgkmcnt(7)
  v_mfma_f32_32x32x16_bf16 v[128:143], a[128:131], v[64:67], v[160:175]
  v_add_f32 v25, v25, v23
  v_cvt_pk_bf16_f32 v43, v22, v23
  v_exp_f32 v17, v153
  s_waitcnt lgkmcnt(6)
  v_mfma_f32_32x32x16_bf16 v[128:143], a[132:135], v[68:71], v[128:143]
  v_add_f32 v25, v25, v16
  v_exp_f32 v18, v154
  v_add_f32 v25, v25, v17
  s_waitcnt lgkmcnt(5)
  v_mfma_f32_32x32x16_bf16 v[128:143], a[136:139], v[72:75], v[128:143]
  v_cvt_pk_bf16_f32 v44, v16, v17
  v_exp_f32 v19, v155
  v_add_f32 v25, v25, v18
  s_waitcnt lgkmcnt(4)
  v_mfma_f32_32x32x16_bf16 v[128:143], a[140:143], v[76:79], v[128:143]
  v_exp_f32 v20, v156
  v_add_f32 v25, v25, v19
  v_cvt_pk_bf16_f32 v45, v18, v19
  s_waitcnt lgkmcnt(3)
  v_mfma_f32_32x32x16_bf16 v[128:143], a[144:147], v[80:83], v[128:143]
  v_exp_f32 v21, v157
  v_add_f32 v25, v25, v20
  s_waitcnt lgkmcnt(2)
  v_mfma_f32_32x32x16_bf16 v[128:143], a[148:151], v[84:87], v[128:143]
  s_branch PADO_4
PADA_4:
  s_branch HOPRET_g2
PAD_4:
  s_sub_u32 s40, s40, 1
  s_cbranch_scc1 HOPRET_gb
  s_branch PAD_12
PADO_4:
  v_exp_f32 v22, v158
  v_add_f32 v25, v25, v21
  v_cvt_pk_bf16_f32 v46, v20, v21
  s_waitcnt lgkmcnt(1)
  v_mfma_f32_32x32x16_bf16 v[128:143], a[152:155], v[88:91], v[128:143]
  v_exp_f32 v23, v159
  v_add_f32 v25, v25, v22
  v_add_f32 v25, v25, v23
  s_waitcnt lgkmcnt(0)
  v_mfma_f32_32x32x16_bf16 v[128:143], a[156:159], v[92:95], v[128:143]
  s_barrier
  v_cvt_pk_bf16_f32 v47, v22, v23
  v_cmp_nge_f32 vcc, s42, v25
  s_nop 0
  s_cbranch_vccnz FBS_8
RET_8:
  v_add_f32 v27, v27, v25
  v_mfma_f32_32x32x16_bf16 a[64:79], a[160:163], v[40:43], a[64:79]
  ds_read_b64_tr_b16 a[160:161], v10 offset:57344
  v_mfma_f32_32x32x16_bf16 a[80:95], a[164:167], v[40:43], a[80:95]
  ds_read_b64_tr_b16 a[162:163], v10 offset:59392
  v_exp_f32 v16, v128
  v_exp_f32 v17, v129
  v_mfma_f32_32x32x16_bf16 a[96:111], a[168:171], v[40:43], a[96:111]
  ds_read_b64_tr_b16 a[164:165], v11 offset:57344
  v_exp_f32 v18, v130
  v_add_f32 v24, v16, v17
  v_cvt_pk_bf16_f32 v32, v16, v17
  v_mfma_f32_32x32x16_bf16 a[112:127], a[172:175], v[40:43], a[112:127]
  ds_read_b64_tr_b16 a[166:167], v11 offset:59392
  v_exp_f32 v19, v131
  v_add_f32 v24, v24, v18
  v_mfma_f32_32x32x16_bf16 a[64:79], a[176:179], v[44:47], a[64:79]
  ds_read_b64_tr_b16 a[168:169], v12 offset:57344
  v_exp_f32 v20, v132
  v_add_f32 v24, v24, v19
  v_cvt_pk_bf16_f32 v33, v18, v19
  v_mfma_f32_32x32x16_bf16 a[80:95], a[180:183], v[44:47], a[80:95]
  ds_read_b64_tr_b16 a[170:171], v12 offset:59392
  v_exp_f32 v21, v133
  v_add_f32 v24, v24, v20
  v_exp_f32 v22, v134
  v_mfma_f32_32x32x16_bf16 a[96:111], a[184:187], v[44:47], a[96:111]
  ds_read_b64_tr_b16 a[172:173], v13 offset:57344
  v_add_f32 v24, v24, v21
  v_cvt_pk_bf16_f32 v34, v20, v21
  v_exp_f32 v23, v135
  v_mfma_f32_32x32x16_bf16 a[112:127], a[188:191], v[44:47], a[112:127]
  ds_read_b64_tr_b16 a[174:175], v13 offset:59392
  v_add_f32 v24, v24, v22
  v_exp_f32 v16, v136
  v_mfma_f32_32x32x16_bf16 v[144:159], a[128:131], v[96:99], v[176:191]
  ds_read_b64_tr_b16 a[176:177], v10 offset:61440
  v_add_f32 v24, v24, v23
  v_cvt_pk_bf16_f32 v35, v22, v23
  v_exp_f32 v17, v137
  v_mfma_f32_32x32x16_bf16 v[144:159], a[132:135], v[100:103], v[144:159]
  ds_read_b64_tr_b16 a[178:179], v10 offset:63488
  v_add_f32 v24, v24, v16
  v_exp_f32 v18, v138
  v_add_f32 v24, v24, v17
  v_mfma_f32_32x32x16_bf16 v[144:159], a[136:139], v[104:107], v[144:159]
  ds_read_b64_tr_b16 a[180:181], v11 offset:61440
  v_cvt_pk_bf16_f32 v36, v16, v17
  v_exp_f32 v19, v139
  v_add_f32 v24, v24, v18
  v_mfma_f32_32x32x16_bf16 v[144:159], a[140:143], v[108:111], v[144:159]
  ds_read_b64_tr_b16 a[182:183], v11 offset:63488
  v_exp_f32 v20, v140
  v_add_f32 v24, v24, v19
  v_cvt_pk_bf16_f32 v37, v18, v19
  v_mfma_f32_32x32x16_bf16 v[144:159], a[144:147], v[112:115], v[144:159]
  ds_read_b64_tr_b16 a[184:185], v12 offset:61440
  v_exp_f32 v21, v141
  v_add_f32 v24, v24, v20
  v_mfma_f32_32x32x16_bf16 v[144:159], a[148:151], v[116:119], v[144:159]
  ds_read_b64_tr_b16 a[186:187], v12 offset:63488
  v_exp_f32 v22, v142
  v_add_f32 v24, v24, v21
  v_cvt_pk_bf16_f32 v38, v20, v21
  v_mfma_f32_32x32x16_bf16 v[144:159], a[152:155], v[120:123], v[144:159]
  ds_read_b64_tr_b16 a[188:189], v13 offset:61440
  v_exp_f32 v23, v143
  v_add_f32 v24, v24, v22
  v_add_f32 v24, v24, v23
  v_mfma_f32_32x32x16_bf16 v[144:159], a[156:159], v[124:127], v[144:159]
  ds_read_b64_tr_b16 a[190:191], v13 offset:63488
  v_cvt_pk_bf16_f32 v39, v22, v23
  v_cmp_nge_f32 vcc, s42, v24
  s_nop 0
  s_cbranch_vccnz FBS_9
RET_9:
  v_add_f32 v26, v26, v24
  s_waitcnt lgkmcnt(14)
  v_mfma_f32_32x32x16_bf16 a[0:15], a[160:163], v[32:35], a[0:15]
  ds_read_b128 a[128:131], v2 offset:24576
  s_waitcnt lgkmcnt(13)
  v_mfma_f32_32x32x16_bf16 a[16:31], a[164:167], v[32:35], a[16:31]
  ds_read_b128 a[132:135], v3 offset:24576
  v_exp_f32 v16, v144
  v_exp_f32 v17, v145
  s_waitcnt lgkmcnt(12)
  v_mfma_f32_32x32x16_bf16 a[32:47], a[168:171], v[32:35], a[32:47]
  ds_read_b128 a[136:139], v4 offset:24576
  v_exp_f32 v18, v146
  v_add_f32 v25, v16, v17
  v_cvt_pk_bf16_f32 v40, v16, v17
  s_waitcnt lgkmcnt(11)
  v_mfma_f32_32x32x16_bf16 a[48:63], a[172:175], v[32:35], a[48:63]
  ds_read_b128 a[140:143], v5 offset:24576
  v_exp_f32 v19, v147
  v_add_f32 v25, v25, v18
  s_waitcnt lgkmcnt(10)
  v_mfma_f32_32x32x16_bf16 a[0:15], a[176:179], v[36:39], a[0:15]
  ds_read_b128 a[144:147], v6 offset:24576
  v_exp_f32 v20, v148
  v_add_f32 v25, v25, v19
  v_cvt_pk_bf16_f32 v41, v18, v19
  s_waitcnt lgkmcnt(9)
  v_mfma_f32_32x32x16_bf16 a[16:31], a[180:183], v[36:39], a[16:31]
  ds_read_b128 a[148:151], v7 offset:24576
  v_exp_f32 v21, v149
  v_add_f32 v25, v25, v20
  v_exp_f32 v22, v150
  s_waitcnt lgkmcnt(8)
  v_mfma_f32_32x32x16_bf16 a[32:47], a[184:187], v[36:39], a[32:47]
  ds_read_b128 a[152:155], v8 offset:24576
  v_add_f32 v25, v25, v21
  v_cvt_pk_bf16_f32 v42, v20, v21
  v_exp_f32 v23, v151
  s_waitcnt lgkmcnt(7)
  v_mfma_f32_32x32x16_bf16 a[48:63], a[188:191], v[36:39], a[48:63]
  ds_read_b128 a[156:159], v9 offset:24576
  v_add_f32 v25, v25, v22
  v_exp_f32 v16, v152
  s_waitcnt lgkmcnt(7)
  v_mfma_f32_32x32x16_bf16 v[128:143], a[128:131], v[64:67], v[160:175]
  v_add_f32 v25, v25, v23
  v_cvt_pk_bf16_f32 v43, v22, v23
  v_exp_f32 v17, v153
  s_waitcnt lgkmcnt(6)
  v_mfma_f32_32x32x16_bf16 v[128:143], a[132:135], v[68:71], v[128:143]
  v_add_f32 v25, v25, v16
  v_exp_f32 v18, v154
  v_add_f32 v25, v25, v17
  s_waitcnt lgkmcnt(5)
  v_mfma_f32_32x32x16_bf16 v[128:143], a[136:139], v[72:75], v[128:143]
  v_cvt_pk_bf16_f32 v44, v16, v17
  v_exp_f32 v19, v155
  v_add_f32 v25, v25, v18
  s_waitcnt lgkmcnt(4)
  v_mfma_f32_32x32x16_bf16 v[128:143], a[140:143], v[76:79], v[128:143]
  v_exp_f32 v20, v156
  v_add_f32 v25, v25, v19
  v_cvt_pk_bf16_f32 v45, v18, v19
  s_waitcnt lgkmcnt(3)
  v_mfma_f32_32x32x16_bf16 v[128:143], a[144:147], v[80:83], v[128:143]
  v_exp_f32 v21, v157
  v_add_f32 v25, v25, v20
  s_waitcnt lgkmcnt(2)
  v_mfma_f32_32x32x16_bf16 v[128:143], a[148:151], v[84:87], v[128:143]
  v_exp_f32 v22, v158
  v_add_f32 v25, v25, v21
  v_cvt_pk_bf16_f32 v46, v20, v21
  s_waitcnt lgkmcnt(1)
  v_mfma_f32_32x32x16_bf16 v[128:143], a[152:155], v[88:91], v[128:143]
  v_exp_f32 v23, v159
  v_add_f32 v25, v25, v22
  v_add_f32 v25, v25, v23
  s_waitcnt lgkmcnt(0)
  v_mfma_f32_32x32x16_bf16 v[128:143], a[156:159], v[92:95], v[128:143]
  s_barrier
  v_cvt_pk_bf16_f32 v47, v22, v23
  v_cmp_nge_f32 vcc, s42, v25
  s_nop 0
  s_cbranch_vccnz FBS_10
RET_10:
  v_add_f32 v27, v27, v25
  v_mfma_f32_32x32x16_bf16 a[64:79], a[160:163], v[40:43], a[64:79]
  ds_read_b64_tr_b16 a[160:161], v10 offset:16384
  v_mfma_f32_32x32x16_bf16 a[80:95], a[164:167], v[40:43], a[80:95]
  ds_read_b64_tr_b16 a[162:163], v10 offset:18432
  v_exp_f32 v16, v128
  v_exp_f32 v17, v129
  v_mfma_f32_32x32x16_bf16 a[96:111], a[168:171], v[40:43], a[96:111]
  ds_read_b64_tr_b16 a[164:165], v11 offset:16384
  v_exp_f32 v18, v130
  v_add_f32 v24, v16, v17
  v_cvt_pk_bf16_f32 v32, v16, v17
  v_mfma_f32_32x32x16_bf16 a[112:127], a[172:175], v[40:43], a[112:127]
  ds_read_b64_tr_b16 a[166:167], v11 offset:18432
  v_exp_f32 v19, v131
  v_add_f32 v24, v24, v18
  v_mfma_f32_32x32x16_bf16 a[64:79], a[176:179], v[44:47], a[64:79]
  ds_read_b64_tr_b16 a[168:169], v12 offset:16384
  v_exp_f32 v20, v132
  v_add_f32 v24, v24, v19
  v_cvt_pk_bf16_f32 v33, v18, v19
  v_mfma_f32_32x32x16_bf16 a[80:95], a[180:183], v[44:47], a[80:95]
  ds_read_b64_tr_b16 a[170:171], v12 offset:18432
  v_exp_f32 v21, v133
  v_add_f32 v24, v24, v20
  v_exp_f32 v22, v134
  v_mfma_f32_32x32x16_bf16 a[96:111], a[184:187], v[44:47], a[96:111]
  ds_read_b64_tr_b16 a[172:173], v13 offset:16384
  v_add_f32 v24, v24, v21
  v_cvt_pk_bf16_f32 v34, v20, v21
  v_exp_f32 v23, v135
  v_mfma_f32_32x32x16_bf16 a[112:127], a[188:191], v[44:47], a[112:127]
  ds_read_b64_tr_b16 a[174:175], v13 offset:18432
  v_add_f32 v24, v24, v22
  v_exp_f32 v16, v136
  v_mfma_f32_32x32x16_bf16 v[144:159], a[128:131], v[96:99], v[176:191]
  ds_read_b64_tr_b16 a[176:177], v10 offset:20480
  v_add_f32 v24, v24, v23
  v_cvt_pk_bf16_f32 v35, v22, v23
  v_exp_f32 v17, v137
  v_mfma_f32_32x32x16_bf16 v[144:159], a[132:135], v[100:103], v[144:159]
  ds_read_b64_tr_b16 a[178:179], v10 offset:22528
  v_add_f32 v24, v24, v16
  v_exp_f32 v18, v138
  v_add_f32 v24, v24, v17
  v_mfma_f32_32x32x16_bf16 v[144:159], a[136:139], v[104:107], v[144:159]
  ds_read_b64_tr_b16 a[180:181], v11 offset:20480
  v_cvt_pk_bf16_f32 v36, v16, v17
  v_exp_f32 v19, v139
  v_add_f32 v24, v24, v18
  v_mfma_f32_32x32x16_bf16 v[144:159], a[140:143], v[108:111], v[144:159]
  ds_read_b64_tr_b16 a[182:183], v11 offset:22528
  v_exp_f32 v20, v140
  v_add_f32 v24, v24, v19
  v_cvt_pk_bf16_f32 v37, v18, v19
  v_mfma_f32_32x32x16_bf16 v[144:159], a[144:147], v[112:115], v[144:159]
  ds_read_b64_tr_b16 a[184:185], v12 offset:20480
  v_exp_f32 v21, v141
  v_add_f32 v24, v24, v20
  v_mfma_f32_32x32x16_bf16 v[144:159], a[148:151], v[116:119], v[144:159]
  ds_read_b64_tr_b16 a[186:187], v12 offset:22528
  v_exp_f32 v22, v142
  v_add_f32 v24, v24, v21
  v_cvt_pk_bf16_f32 v38, v20, v21
  v_mfma_f32_32x32x16_bf16 v[144:159], a[152:155], v[120:123], v[144:159]
  ds_read_b64_tr_b16 a[188:189], v13 offset:20480
  v_exp_f32 v23, v143
  v_add_f32 v24, v24, v22
  v_add_f32 v24, v24, v23
  v_mfma_f32_32x32x16_bf16 v[144:159], a[156:159], v[124:127], v[144:159]
  ds_read_b64_tr_b16 a[190:191], v13 offset:22528
  v_cvt_pk_bf16_f32 v39, v22, v23
  v_cmp_nge_f32 vcc, s42, v24
  s_nop 0
  s_cbranch_vccnz FBS_11
RET_11:
  v_add_f32 v26, v26, v24
  s_waitcnt lgkmcnt(14)
  v_mfma_f32_32x32x16_bf16 a[0:15], a[160:163], v[32:35], a[0:15]
  ds_read_b128 a[128:131], v2 offset:57344
  s_waitcnt lgkmcnt(13)
  v_mfma_f32_32x32x16_bf16 a[16:31], a[164:167], v[32:35], a[16:31]
  ds_read_b128 a[132:135], v3 offset:57344
  v_exp_f32 v16, v144
  v_exp_f32 v17, v145
  s_waitcnt lgkmcnt(12)
  v_mfma_f32_32x32x16_bf16 a[32:47], a[168:171], v[32:35], a[32:47]
  ds_read_b128 a[136:139], v4 offset:57344
  v_exp_f32 v18, v146
  v_add_f32 v25, v16, v17
  v_cvt_pk_bf16_f32 v40, v16, v17
  s_waitcnt lgkmcnt(11)
  v_mfma_f32_32x32x16_bf16 a[48:63], a[172:175], v[32:35], a[48:63]
  ds_read_b128 a[140:143], v5 offset:57344
  v_exp_f32 v19, v147
  v_add_f32 v25, v25, v18
  s_waitcnt lgkmcnt(10)
  v_mfma_f32_32x32x16_bf16 a[0:15], a[176:179], v[36:39], a[0:15]
  ds_read_b128 a[144:147], v6 offset:57344
  v_exp_f32 v20, v148
  v_add_f32 v25, v25, v19
  v_cvt_pk_bf16_f32 v41, v18, v19
  s_waitcnt lgkmcnt(9)
  v_mfma_f32_32x32x16_bf16 a[16:31], a[180:183], v[36:39], a[16:31]
  ds_read_b128 a[148:151], v7 offset:57344
  v_exp_f32 v21, v149
  v_add_f32 v25, v25, v20
  v_exp_f32 v22, v150
  s_waitcnt lgkmcnt(8)
  v_mfma_f32_32x32x16_bf16 a[32:47], a[184:187], v[36:39], a[32:47]
  ds_read_b128 a[152:155], v8 offset:57344
  v_add_f32 v25, v25, v21
  v_cvt_pk_bf16_f32 v42, v20, v21
  v_exp_f32 v23, v151
  s_waitcnt lgkmcnt(7)
  v_mfma_f32_32x32x16_bf16 a[48:63], a[188:191], v[36:39], a[48:63]
  ds_read_b128 a[156:159], v9 offset:57344
  v_add_f32 v25, v25, v22
  v_exp_f32 v16, v152
  s_waitcnt lgkmcnt(7)
  v_mfma_f32_32x32x16_bf16 v[128:143], a[128:131], v[64:67], v[160:175]
  v_add_f32 v25, v25, v23
  v_cvt_pk_bf16_f32 v43, v22, v23
  v_exp_f32 v17, v153
  s_waitcnt lgkmcnt(6)
  v_mfma_f32_32x32x16_bf16 v[128:143], a[132:135], v[68:71], v[128:143]
  v_add_f32 v25, v25, v16
  v_exp_f32 v18, v154
  v_add_f32 v25, v25, v17
  s_waitcnt lgkmcnt(5)
  v_mfma_f32_32x32x16_bf16 v[128:143], a[136:139], v[72:75], v[128:143]
  v_cvt_pk_bf16_f32 v44, v16, v17
  v_exp_f32 v19, v155
  v_add_f32 v25, v25, v18
  s_waitcnt lgkmcnt(4)
  v_mfma_f32_32x32x16_bf16 v[128:143], a[140:143], v[76:79], v[128:143]
  v_exp_f32 v20, v156
  v_add_f32 v25, v25, v19
  v_cvt_pk_bf16_f32 v45, v18, v19
  s_waitcnt lgkmcnt(3)
  v_mfma_f32_32x32x16_bf16 v[128:143], a[144:147], v[80:83], v[128:143]
  v_exp_f32 v21, v157
  v_add_f32 v25, v25, v20
  s_waitcnt lgkmcnt(2)
  v_mfma_f32_32x32x16_bf16 v[128:143], a[148:151], v[84:87], v[128:143]
  v_exp_f32 v22, v158
  v_add_f32 v25, v25, v21
  v_cvt_pk_bf16_f32 v46, v20, v21
  s_waitcnt lgkmcnt(1)
  v_mfma_f32_32x32x16_bf16 v[128:143], a[152:155], v[88:91], v[128:143]
  v_exp_f32 v23, v159
  v_add_f32 v25, v25, v22
  v_add_f32 v25, v25, v23
  s_waitcnt lgkmcnt(0)
  v_mfma_f32_32x32x16_bf16 v[128:143], a[156:159], v[92:95], v[128:143]
  s_barrier
  v_cvt_pk_bf16_f32 v47, v22, v23
  v_cmp_nge_f32 vcc, s42, v25
  s_nop 0
  s_cbranch_vccnz FBS_12
RET_12:
  v_add_f32 v27, v27, v25
  v_mfma_f32_32x32x16_bf16 a[64:79], a[160:163], v[40:43], a[64:79]
  ds_read_b64_tr_b16 a[160:161], v10 offset:24576
  v_mfma_f32_32x32x16_bf16 a[80:95], a[164:167], v[40:43], a[80:95]
  ds_read_b64_tr_b16 a[162:163], v10 offset:26624
  v_exp_f32 v16, v128
  v_exp_f32 v17, v129
  v_mfma_f32_32x32x16_bf16 a[96:111], a[168:171], v[40:43], a[96:111]
  ds_read_b64_tr_b16 a[164:165], v11 offset:24576
  v_exp_f32 v18, v130
  v_add_f32 v24, v16, v17
  v_cvt_pk_bf16_f32 v32, v16, v17
  v_mfma_f32_32x32x16_bf16 a[112:127], a[172:175], v[40:43], a[112:127]
  ds_read_b64_tr_b16 a[166:167], v11 offset:26624
  v_exp_f32 v19, v131
  v_add_f32 v24, v24, v18
  v_mfma_f32_32x32x16_bf16 a[64:79], a[176:179], v[44:47], a[64:79]
  ds_read_b64_tr_b16 a[168:169], v12 offset:24576
  v_exp_f32 v20, v132
  v_add_f32 v24, v24, v19
  v_cvt_pk_bf16_f32 v33, v18, v19
  v_mfma_f32_32x32x16_bf16 a[80:95], a[180:183], v[44:47], a[80:95]
  ds_read_b64_tr_b16 a[170:171], v12 offset:26624
  v_exp_f32 v21, v133
  v_add_f32 v24, v24, v20
  v_exp_f32 v22, v134
  v_mfma_f32_32x32x16_bf16 a[96:111], a[184:187], v[44:47], a[96:111]
  ds_read_b64_tr_b16 a[172:173], v13 offset:24576
  v_add_f32 v24, v24, v21
  v_cvt_pk_bf16_f32 v34, v20, v21
  v_exp_f32 v23, v135
  v_mfma_f32_32x32x16_bf16 a[112:127], a[188:191], v[44:47], a[112:127]
  ds_read_b64_tr_b16 a[174:175], v13 offset:26624
  v_add_f32 v24, v24, v22
  v_exp_f32 v16, v136
  v_mfma_f32_32x32x16_bf16 v[144:159], a[128:131], v[96:99], v[176:191]
  ds_read_b64_tr_b16 a[176:177], v10 offset:28672
  v_add_f32 v24, v24, v23
  v_cvt_pk_bf16_f32 v35, v22, v23
  v_exp_f32 v17, v137
  v_mfma_f32_32x32x16_bf16 v[144:159], a[132:135], v[100:103], v[144:159]
  ds_read_b64_tr_b16 a[178:179], v10 offset:30720
  v_add_f32 v24, v24, v16
  v_exp_f32 v18, v138
  v_add_f32 v24, v24, v17
  v_mfma_f32_32x32x16_bf16 v[144:159], a[136:139], v[104:107], v[144:159]
  ds_read_b64_tr_b16 a[180:181], v11 offset:28672
  v_cvt_pk_bf16_f32 v36, v16, v17
  v_exp_f32 v19, v139
  v_add_f32 v24, v24, v18
  v_mfma_f32_32x32x16_bf16 v[144:159], a[140:143], v[108:111], v[144:159]
  ds_read_b64_tr_b16 a[182:183], v11 offset:30720
  v_exp_f32 v20, v140
  v_add_f32 v24, v24, v19
  v_cvt_pk_bf16_f32 v37, v18, v19
  v_mfma_f32_32x32x16_bf16 v[144:159], a[144:147], v[112:115], v[144:159]
  ds_read_b64_tr_b16 a[184:185], v12 offset:28672
  v_exp_f32 v21, v141
  v_add_f32 v24, v24, v20
  v_mfma_f32_32x32x16_bf16 v[144:159], a[148:151], v[116:119], v[144:159]
  ds_read_b64_tr_b16 a[186:187], v12 offset:30720
  v_exp_f32 v22, v142
  v_add_f32 v24, v24, v21
  v_cvt_pk_bf16_f32 v38, v20, v21
  v_mfma_f32_32x32x16_bf16 v[144:159], a[152:155], v[120:123], v[144:159]
  ds_read_b64_tr_b16 a[188:189], v13 offset:28672
  v_exp_f32 v23, v143
  v_add_f32 v24, v24, v22
  v_add_f32 v24, v24, v23
  v_mfma_f32_32x32x16_bf16 v[144:159], a[156:159], v[124:127], v[144:159]
  ds_read_b64_tr_b16 a[190:191], v13 offset:30720
  v_cvt_pk_bf16_f32 v39, v22, v23
  v_cmp_nge_f32 vcc, s42, v24
  s_nop 0
  s_cbranch_vccnz FBS_13
RET_13:
  v_add_f32 v26, v26, v24
  s_cmp_eq_u32 s40, 3
  s_cbranch_scc1 A_FIN2
  s_waitcnt lgkmcnt(14)
  v_mfma_f32_32x32x16_bf16 a[0:15], a[160:163], v[32:35], a[0:15]
  ds_read_b128 a[128:131], v2 offset:32768
  s_waitcnt lgkmcnt(13)
  v_mfma_f32_32x32x16_bf16 a[16:31], a[164:167], v[32:35], a[16:31]
  ds_read_b128 a[132:135], v3 offset:32768
  v_exp_f32 v16, v144
  v_exp_f32 v17, v145
  s_waitcnt lgkmcnt(12)
  v_mfma_f32_32x32x16_bf16 a[32:47], a[168:171], v[32:35], a[32:47]
  ds_read_b128 a[136:139], v4 offset:32768
  v_exp_f32 v18, v146
  v_add_f32 v25, v16, v17
  v_cvt_pk_bf16_f32 v40, v16, v17
  s_waitcnt lgkmcnt(11)
  v_mfma_f32_32x32x16_bf16 a[48:63], a[172:175], v[32:35], a[48:63]
  ds_read_b128 a[140:143], v5 offset:32768
  v_exp_f32 v19, v147
  v_add_f32 v25, v25, v18
  s_waitcnt lgkmcnt(10)
  v_mfma_f32_32x32x16_bf16 a[0:15], a[176:179], v[36:39], a[0:15]
  ds_read_b128 a[144:147], v6 offset:32768
  v_exp_f32 v20, v148
  v_add_f32 v25, v25, v19
  v_cvt_pk_bf16_f32 v41, v18, v19
  s_waitcnt lgkmcnt(9)
  v_mfma_f32_32x32x16_bf16 a[16:31], a[180:183], v[36:39], a[16:31]
  ds_read_b128 a[148:151], v7 offset:32768
  v_exp_f32 v21, v149
  v_add_f32 v25, v25, v20
  v_exp_f32 v22, v150
  s_waitcnt lgkmcnt(8)
  v_mfma_f32_32x32x16_bf16 a[32:47], a[184:187], v[36:39], a[32:47]
  ds_read_b128 a[152:155], v8 offset:32768
  v_add_f32 v25, v25, v21
  v_cvt_pk_bf16_f32 v42, v20, v21
  v_exp_f32 v23, v151
  s_waitcnt lgkmcnt(7)
  v_mfma_f32_32x32x16_bf16 a[48:63], a[188:191], v[36:39], a[48:63]
  ds_read_b128 a[156:159], v9 offset:32768
  v_add_f32 v25, v25, v22
  v_exp_f32 v16, v152
  s_waitcnt lgkmcnt(7)
  v_mfma_f32_32x32x16_bf16 v[128:143], a[128:131], v[64:67], v[160:175]
  v_add_f32 v25, v25, v23
  v_cvt_pk_bf16_f32 v43, v22, v23
  v_exp_f32 v17, v153
  s_waitcnt lgkmcnt(6)
  v_mfma_f32_32x32x16_bf16 v[128:143], a[132:135], v[68:71], v[128:143]
  v_add_f32 v25, v25, v16
  v_exp_f32 v18, v154
  v_add_f32 v25, v25, v17
  s_waitcnt lgkmcnt(5)
  v_mfma_f32_32x32x16_bf16 v[128:143], a[136:139], v[72:75], v[128:143]
  v_cvt_pk_bf16_f32 v44, v16, v17
  v_exp_f32 v19, v155
  v_add_f32 v25, v25, v18
  s_waitcnt lgkmcnt(4)
  v_mfma_f32_32x32x16_bf16 v[128:143], a[140:143], v[76:79], v[128:143]
  v_exp_f32 v20, v156
  v_add_f32 v25, v25, v19
  v_cvt_pk_bf16_f32 v45, v18, v19
  s_waitcnt lgkmcnt(3)
  v_mfma_f32_32x32x16_bf16 v[128:143], a[144:147], v[80:83], v[128:143]
  v_exp_f32 v21, v157
  v_add_f32 v25, v25, v20
  s_waitcnt lgkmcnt(2)
  v_mfma_f32_32x32x16_bf16 v[128:143], a[148:151], v[84:87], v[128:143]
  v_exp_f32 v22, v158
  v_add_f32 v25, v25, v21
  v_cvt_pk_bf16_f32 v46, v20, v21
  s_waitcnt lgkmcnt(1)
  v_mfma_f32_32x32x16_bf16 v[128:143], a[152:155], v[88:91], v[128:143]
  v_exp_f32 v23, v159
  v_add_f32 v25, v25, v22
  v_add_f32 v25, v25, v23
  s_waitcnt lgkmcnt(0)
  v_mfma_f32_32x32x16_bf16 v[128:143], a[156:159], v[92:95], v[128:143]
  s_barrier
  v_cvt_pk_bf16_f32 v47, v22, v23
  v_cmp_nge_f32 vcc, s42, v25
  s_nop 0
  s_cbranch_vccnz FBS_14
RET_14:
  v_add_f32 v27, v27, v25
  v_mfma_f32_32x32x16_bf16 a[64:79], a[160:163], v[40:43], a[64:79]
  ds_read_b64_tr_b16 a[160:161], v10
  v_mfma_f32_32x32x16_bf16 a[80:95], a[164:167], v[40:43], a[80:95]
  ds_read_b64_tr_b16 a[162:163], v10 offset:2048
  v_exp_f32 v16, v128
  v_exp_f32 v17, v129
  v_mfma_f32_32x32x16_bf16 a[96:111], a[168:171], v[40:43], a[96:111]
  ds_read_b64_tr_b16 a[164:165], v11
  v_exp_f32 v18, v130
  v_add_f32 v24, v16, v17
  v_cvt_pk_bf16_f32 v32, v16, v17
  v_mfma_f32_32x32x16_bf16 a[112:127], a[172:175], v[40:43], a[112:127]
  ds_read_b64_tr_b16 a[166:167], v11 offset:2048
  v_exp_f32 v19, v131
  v_add_f32 v24, v24, v18
  v_mfma_f32_32x32x16_bf16 a[64:79], a[176:179], v[44:47], a[64:79]
  ds_read_b64_tr_b16 a[168:169], v12
  v_exp_f32 v20, v132
  v_add_f32 v24, v24, v19
  v_cvt_pk_bf16_f32 v33, v18, v19
  v_mfma_f32_32x32x16_bf16 a[80:95], a[180:183], v[44:47], a[80:95]
  ds_read_b64_tr_b16 a[170:171], v12 offset:2048
  v_exp_f32 v21, v133
  v_add_f32 v24, v24, v20
  v_exp_f32 v22, v134
  v_mfma_f32_32x32x16_bf16 a[96:111], a[184:187], v[44:47], a[96:111]
  ds_read_b64_tr_b16 a[172:173], v13
  v_add_f32 v24, v24, v21
  v_cvt_pk_bf16_f32 v34, v20, v21
  v_exp_f32 v23, v135
  v_mfma_f32_32x32x16_bf16 a[112:127], a[188:191], v[44:47], a[112:127]
  ds_read_b64_tr_b16 a[174:175], v13 offset:2048
  v_add_f32 v24, v24, v22
  v_exp_f32 v16, v136
  v_mfma_f32_32x32x16_bf16 v[144:159], a[128:131], v[96:99], v[176:191]
  ds_read_b64_tr_b16 a[176:177], v10 offset:4096
  v_add_f32 v24, v24, v23
  v_cvt_pk_bf16_f32 v35, v22, v23
  v_exp_f32 v17, v137
  v_mfma_f32_32x32x16_bf16 v[144:159], a[132:135], v[100:103], v[144:159]
  ds_read_b64_tr_b16 a[178:179], v10 offset:6144
  v_add_f32 v24, v24, v16
  v_exp_f32 v18, v138
  v_add_f32 v24, v24, v17
  v_mfma_f32_32x32x16_bf16 v[144:159], a[136:139], v[104:107], v[144:159]
  ds_read_b64_tr_b16 a[180:181], v11 offset:4096
  v_cvt_pk_bf16_f32 v36, v16, v17
  v_exp_f32 v19, v139
  v_add_f32 v24, v24, v18
  v_mfma_f32_32x32x16_bf16 v[144:159], a[140:143], v[108:111], v[144:159]
  ds_read_b64_tr_b16 a[182:183], v11 offset:6144
  v_exp_f32 v20, v140
  v_add_f32 v24, v24, v19
  v_cvt_pk_bf16_f32 v37, v18, v19
  v_mfma_f32_32x32x16_bf16 v[144:159], a[144:147], v[112:115], v[144:159]
  ds_read_b64_tr_b16 a[184:185], v12 offset:4096
  v_exp_f32 v21, v141
  v_add_f32 v24, v24, v20
  v_mfma_f32_32x32x16_bf16 v[144:159], a[148:151], v[116:119], v[144:159]
  ds_read_b64_tr_b16 a[186:187], v12 offset:6144
  v_exp_f32 v22, v142
  v_add_f32 v24, v24, v21
  v_cvt_pk_bf16_f32 v38, v20, v21
  v_mfma_f32_32x32x16_bf16 v[144:159], a[152:155], v[120:123], v[144:159]
  ds_read_b64_tr_b16 a[188:189], v13 offset:4096
  v_exp_f32 v23, v143
  v_add_f32 v24, v24, v22
  v_add_f32 v24, v24, v23
  v_mfma_f32_32x32x16_bf16 v[144:159], a[156:159], v[124:127], v[144:159]
  ds_read_b64_tr_b16 a[190:191], v13 offset:6144
  v_cvt_pk_bf16_f32 v39, v22, v23
  v_cmp_nge_f32 vcc, s42, v24
  s_nop 0
  s_cbranch_vccnz FBS_15
RET_15:
  v_add_f32 v26, v26, v24
  s_add_u32 s40, s40, 1
  s_branch A_LOOP2
A_FIN2:
  s_waitcnt lgkmcnt(0)
  s_barrier
  v_lshlrev_b32 v14, 4, v0
  v_add_u32 v15, 0x1000, v14
  v_mfma_f32_32x32x16_bf16 a[0:15], a[160:163], v[32:35], a[0:15]
  v_mfma_f32_32x32x16_bf16 a[16:31], a[164:167], v[32:35], a[16:31]
  v_exp_f32 v16, v144
  v_exp_f32 v17, v145
  v_exp_f32 v18, v146
  v_add_f32 v25, v16, v17
  v_cvt_pk_bf16_f32 v40, v16, v17
  v_mfma_f32_32x32x16_bf16 a[32:47], a[168:171], v[32:35], a[32:47]
  v_exp_f32 v19, v147
  v_add_f32 v25, v25, v18
  v_exp_f32 v20, v148
  v_add_f32 v25, v25, v19
  v_cvt_pk_bf16_f32 v41, v18, v19
  v_exp_f32 v21, v149
  v_mfma_f32_32x32x16_bf16 a[48:63], a[172:175], v[32:35], a[48:63]
  v_add_f32 v25, v25, v20
  v_exp_f32 v22, v150
  v_add_f32 v25, v25, v21
  v_cvt_pk_bf16_f32 v42, v20, v21
  v_exp_f32 v23, v151
  v_add_f32 v25, v25, v22
  v_mfma_f32_32x32x16_bf16 a[0:15], a[176:179], v[36:39], a[0:15]
  v_exp_f32 v16, v152
  v_add_f32 v25, v25, v23
  v_cvt_pk_bf16_f32 v43, v22, v23
  v_exp_f32 v17, v153
  v_add_f32 v25, v25, v16
  v_exp_f32 v18, v154
  v_mfma_f32_32x32x16_bf16 a[16:31], a[180:183], v[36:39], a[16:31]
  v_add_f32 v25, v25, v17
  v_cvt_pk_bf16_f32 v44, v16, v17
  v_exp_f32 v19, v155
  v_add_f32 v25, v25, v18
  v_exp_f32 v20, v156
  v_mfma_f32_32x32x16_bf16 a[32:47], a[184:187], v[36:39], a[32:47]
  v_add_f32 v25, v25, v19
  v_cvt_pk_bf16_f32 v45, v18, v19
  v_exp_f32 v21, v157
  v_add_f32 v25, v25, v20
  v_exp_f32 v22, v158
  v_add_f32 v25, v25, v21
  v_cvt_pk_bf16_f32 v46, v20, v21
  v_mfma_f32_32x32x16_bf16 a[48:63], a[188:191], v[36:39], a[48:63]
  v_exp_f32 v23, v159
  v_add_f32 v25, v25, v22
  v_add_f32 v25, v25, v23
  v_cvt_pk_bf16_f32 v47, v22, v23
  v_cmp_nge_f32 vcc, s42, v25
  s_nop 0
  s_cbranch_vccnz FBS_16
RET_16:
  v_add_f32 v27, v27, v25
  v_mfma_f32_32x32x16_bf16 a[64:79], a[160:163], v[40:43], a[64:79]
  v_mov_b32 v29, v26
  v_mov_b32 v28, v26
  s_nop 1
  v_permlane32_swap_b32 v28, v29
  v_add_f32 v28, v28, v29
  v_rcp_f32 v28, v28
  v_mfma_f32_32x32x16_bf16 a[80:95], a[164:167], v[40:43], a[80:95]
  s_lshl_b32 s44, s28, 19
  v_accvgpr_read_b32 v128, a0
  v_accvgpr_read_b32 v129, a1
  v_accvgpr_read_b32 v130, a2
  v_mfma_f32_32x32x16_bf16 a[96:111], a[168:171], v[40:43], a[96:111]
  v_accvgpr_read_b32 v131, a3
  v_accvgpr_read_b32 v132, a4
  v_accvgpr_read_b32 v133, a5
  v_accvgpr_read_b32 v134, a6
  v_accvgpr_read_b32 v135, a7
  v_mfma_f32_32x32x16_bf16 a[112:127], a[172:175], v[40:43], a[112:127]
  v_pk_mul_f32 v[128:129], v[128:129], v[28:29] op_sel_hi:[1,0]
  v_pk_mul_f32 v[130:131], v[130:131], v[28:29] op_sel_hi:[1,0]
  v_pk_mul_f32 v[132:133], v[132:133], v[28:29] op_sel_hi:[1,0]
  v_pk_mul_f32 v[134:135], v[134:135], v[28:29] op_sel_hi:[1,0]
  v_cvt_pk_bf16_f32 v160, v128, v129
  v_mfma_f32_32x32x16_bf16 a[64:79], a[176:179], v[44:47], a[64:79]
  v_cvt_pk_bf16_f32 v161, v130, v131
  v_cvt_pk_bf16_f32 v162, v132, v133
  v_cvt_pk_bf16_f32 v163, v134, v135
  buffer_store_dwordx4 v[160:163], v14, s[24:27], s44 offen sc1
  v_accvgpr_read_b32 v136, a8
  v_accvgpr_read_b32 v137, a9
  v_mfma_f32_32x32x16_bf16 a[80:95], a[180:183], v[44:47], a[80:95]
  v_accvgpr_read_b32 v138, a10
  v_accvgpr_read_b32 v139, a11
  v_accvgpr_read_b32 v140, a12
  v_accvgpr_read_b32 v141, a13
  v_accvgpr_read_b32 v142, a14
  v_mfma_f32_32x32x16_bf16 a[96:111], a[184:187], v[44:47], a[96:111]
  v_accvgpr_read_b32 v143, a15
  v_pk_mul_f32 v[136:137], v[136:137], v[28:29] op_sel_hi:[1,0]
  v_pk_mul_f32 v[138:139], v[138:139], v[28:29] op_sel_hi:[1,0]
  v_pk_mul_f32 v[140:141], v[140:141], v[28:29] op_sel_hi:[1,0]
  v_pk_mul_f32 v[142:143], v[142:143], v[28:29] op_sel_hi:[1,0]
  v_mfma_f32_32x32x16_bf16 a[112:127], a[188:191], v[44:47], a[112:127]
  v_cvt_pk_bf16_f32 v164, v136, v137
  v_cvt_pk_bf16_f32 v165, v138, v139
  v_cvt_pk_bf16_f32 v166, v140, v141
  v_cvt_pk_bf16_f32 v167, v142, v143
  buffer_store_dwordx4 v[164:167], v14, s[24:27], s44 offen offset:1024 sc1
  v_accvgpr_read_b32 v128, a16
  v_accvgpr_read_b32 v129, a17
  v_accvgpr_read_b32 v130, a18
  v_accvgpr_read_b32 v131, a19
  v_accvgpr_read_b32 v132, a20
  v_accvgpr_read_b32 v133, a21
  v_accvgpr_read_b32 v134, a22
  v_accvgpr_read_b32 v135, a23
  v_pk_mul_f32 v[128:129], v[128:129], v[28:29] op_sel_hi:[1,0]
  v_pk_mul_f32 v[130:131], v[130:131], v[28:29] op_sel_hi:[1,0]
  v_pk_mul_f32 v[132:133], v[132:133], v[28:29] op_sel_hi:[1,0]
  v_pk_mul_f32 v[134:135], v[134:135], v[28:29] op_sel_hi:[1,0]
  s_branch PADO_5
PADA_5:
  s_branch HOPRET_g2
PAD_5:
  s_sub_u32 s40, s40, 1
  s_cbranch_scc1 HOPRET_gb
  s_branch PAD_14
PADO_5:
  v_cvt_pk_bf16_f32 v168, v128, v129
  v_cvt_pk_bf16_f32 v169, v130, v131
  v_cvt_pk_bf16_f32 v170, v132, v133
  v_cvt_pk_bf16_f32 v171, v134, v135
  buffer_store_dwordx4 v[168:171], v14, s[24:27], s44 offen offset:2048 sc1
  v_accvgpr_read_b32 v136, a24
  v_accvgpr_read_b32 v137, a25
  v_accvgpr_read_b32 v138, a26
  v_accvgpr_read_b32 v139, a27
  v_accvgpr_read_b32 v140, a28
  v_accvgpr_read_b32 v141, a29
  v_accvgpr_read_b32 v142, a30
  v_accvgpr_read_b32 v143, a31
  v_pk_mul_f32 v[136:137], v[136:137], v[28:29] op_sel_hi:[1,0]
  v_pk_mul_f32 v[138:139], v[138:139], v[28:29] op_sel_hi:[1,0]
  v_pk_mul_f32 v[140:141], v[140:141], v[28:29] op_sel_hi:[1,0]
  v_pk_mul_f32 v[142:143], v[142:143], v[28:29] op_sel_hi:[1,0]
  v_cvt_pk_bf16_f32 v172, v136, v137
  v_cvt_pk_bf16_f32 v173, v138, v139
  v_cvt_pk_bf16_f32 v174, v140, v141
  v_cvt_pk_bf16_f32 v175, v142, v143
  buffer_store_dwordx4 v[172:175], v14, s[24:27], s44 offen offset:3072 sc1
  v_accvgpr_read_b32 v128, a32
  v_accvgpr_read_b32 v129, a33
  v_accvgpr_read_b32 v130, a34
  v_accvgpr_read_b32 v131, a35
  v_accvgpr_read_b32 v132, a36
  v_accvgpr_read_b32 v133, a37
  v_accvgpr_read_b32 v134, a38
  v_accvgpr_read_b32 v135, a39
  v_pk_mul_f32 v[128:129], v[128:129], v[28:29] op_sel_hi:[1,0]
  v_pk_mul_f32 v[130:131], v[130:131], v[28:29] op_sel_hi:[1,0]
  v_pk_mul_f32 v[132:133], v[132:133], v[28:29] op_sel_hi:[1,0]
  v_pk_mul_f32 v[134:135], v[134:135], v[28:29] op_sel_hi:[1,0]
  v_cvt_pk_bf16_f32 v160, v128, v129
  v_cvt_pk_bf16_f32 v161, v130, v131
  v_cvt_pk_bf16_f32 v162, v132, v133
  v_cvt_pk_bf16_f32 v163, v134, v135
  buffer_store_dwordx4 v[160:163], v15, s[24:27], s44 offen sc1
  v_accvgpr_read_b32 v136, a40
  v_accvgpr_read_b32 v137, a41
  v_accvgpr_read_b32 v138, a42
  v_accvgpr_read_b32 v139, a43
  v_accvgpr_read_b32 v140, a44
  v_accvgpr_read_b32 v141, a45
  v_accvgpr_read_b32 v142, a46
  v_accvgpr_read_b32 v143, a47
  v_pk_mul_f32 v[136:137], v[136:137], v[28:29] op_sel_hi:[1,0]
  v_pk_mul_f32 v[138:139], v[138:139], v[28:29] op_sel_hi:[1,0]
  v_pk_mul_f32 v[140:141], v[140:141], v[28:29] op_sel_hi:[1,0]
  v_pk_mul_f32 v[142:143], v[142:143], v[28:29] op_sel_hi:[1,0]
  v_cvt_pk_bf16_f32 v164, v136, v137
  v_cvt_pk_bf16_f32 v165, v138, v139
  v_cvt_pk_bf16_f32 v166, v140, v141
  v_cvt_pk_bf16_f32 v167, v142, v143
  buffer_store_dwordx4 v[164:167], v15, s[24:27], s44 offen offset:1024 sc1
  v_accvgpr_read_b32 v128, a48
  v_accvgpr_read_b32 v129, a49
  v_accvgpr_read_b32 v130, a50
  v_accvgpr_read_b32 v131, a51
  v_accvgpr_read_b32 v132, a52
  v_accvgpr_read_b32 v133, a53
  v_accvgpr_read_b32 v134, a54
  v_accvgpr_read_b32 v135, a55
  v_pk_mul_f32 v[128:129], v[128:129], v[28:29] op_sel_hi:[1,0]
  v_pk_mul_f32 v[130:131], v[130:131], v[28:29] op_sel_hi:[1,0]
  v_pk_mul_f32 v[132:133], v[132:133], v[28:29] op_sel_hi:[1,0]
  v_pk_mul_f32 v[134:135], v[134:135], v[28:29] op_sel_hi:[1,0]
  v_cvt_pk_bf16_f32 v168, v128, v129
  v_cvt_pk_bf16_f32 v169, v130, v131
  v_cvt_pk_bf16_f32 v170, v132, v133
  v_cvt_pk_bf16_f32 v171, v134, v135
  buffer_store_dwordx4 v[168:171], v15, s[24:27], s44 offen offset:2048 sc1
  v_accvgpr_read_b32 v136, a56
  v_accvgpr_read_b32 v137, a57
  v_accvgpr_read_b32 v138, a58
  v_accvgpr_read_b32 v139, a59
  v_accvgpr_read_b32 v140, a60
  v_accvgpr_read_b32 v141, a61
  v_accvgpr_read_b32 v142, a62
  v_accvgpr_read_b32 v143, a63
  v_pk_mul_f32 v[136:137], v[136:137], v[28:29] op_sel_hi:[1,0]
  v_pk_mul_f32 v[138:139], v[138:139], v[28:29] op_sel_hi:[1,0]
  v_pk_mul_f32 v[140:141], v[140:141], v[28:29] op_sel_hi:[1,0]
  v_pk_mul_f32 v[142:143], v[142:143], v[28:29] op_sel_hi:[1,0]
  v_cvt_pk_bf16_f32 v172, v136, v137
  v_cvt_pk_bf16_f32 v173, v138, v139
  v_cvt_pk_bf16_f32 v174, v140, v141
  v_cvt_pk_bf16_f32 v175, v142, v143
  buffer_store_dwordx4 v[172:175], v15, s[24:27], s44 offen offset:3072 sc1
  v_mov_b32 v29, v27
  v_mov_b32 v28, v27
  s_nop 1
  v_permlane32_swap_b32 v28, v29
  v_add_f32 v28, v28, v29
  v_rcp_f32 v28, v28
  s_add_u32 s44, s44, 0x40000
  v_accvgpr_read_b32 v144, a64
  v_accvgpr_read_b32 v145, a65
  v_accvgpr_read_b32 v146, a66
  v_accvgpr_read_b32 v147, a67
  v_accvgpr_read_b32 v148, a68
  v_accvgpr_read_b32 v149, a69
  v_accvgpr_read_b32 v150, a70
  v_accvgpr_read_b32 v151, a71
  v_pk_mul_f32 v[144:145], v[144:145], v[28:29] op_sel_hi:[1,0]
  v_pk_mul_f32 v[146:147], v[146:147], v[28:29] op_sel_hi:[1,0]
  v_pk_mul_f32 v[148:149], v[148:149], v[28:29] op_sel_hi:[1,0]
  v_pk_mul_f32 v[150:151], v[150:151], v[28:29] op_sel_hi:[1,0]
  v_cvt_pk_bf16_f32 v176, v144, v145
  v_cvt_pk_bf16_f32 v177, v146, v147
  v_cvt_pk_bf16_f32 v178, v148, v149
  v_cvt_pk_bf16_f32 v179, v150, v151
  buffer_store_dwordx4 v[176:179], v14, s[24:27], s44 offen sc1
  v_accvgpr_read_b32 v152, a72
  v_accvgpr_read_b32 v153, a73
  v_accvgpr_read_b32 v154, a74
  v_accvgpr_read_b32 v155, a75
  v_accvgpr_read_b32 v156, a76
  v_accvgpr_read_b32 v157, a77
  v_accvgpr_read_b32 v158, a78
  v_accvgpr_read_b32 v159, a79
  v_pk_mul_f32 v[152:153], v[152:153], v[28:29] op_sel_hi:[1,0]
  v_pk_mul_f32 v[154:155], v[154:155], v[28:29] op_sel_hi:[1,0]
  v_pk_mul_f32 v[156:157], v[156:157], v[28:29] op_sel_hi:[1,0]
  v_pk_mul_f32 v[158:159], v[158:159], v[28:29] op_sel_hi:[1,0]
  v_cvt_pk_bf16_f32 v180, v152, v153
  v_cvt_pk_bf16_f32 v181, v154, v155
  v_cvt_pk_bf16_f32 v182, v156, v157
  v_cvt_pk_bf16_f32 v183, v158, v159
  buffer_store_dwordx4 v[180:183], v14, s[24:27], s44 offen offset:1024 sc1
  v_accvgpr_read_b32 v144, a80
  v_accvgpr_read_b32 v145, a81
  v_accvgpr_read_b32 v146, a82
  v_accvgpr_read_b32 v147, a83
  v_accvgpr_read_b32 v148, a84
  v_accvgpr_read_b32 v149, a85
  v_accvgpr_read_b32 v150, a86
  v_accvgpr_read_b32 v151, a87
  v_pk_mul_f32 v[144:145], v[144:145], v[28:29] op_sel_hi:[1,0]
  v_pk_mul_f32 v[146:147], v[146:147], v[28:29] op_sel_hi:[1,0]
  v_pk_mul_f32 v[148:149], v[148:149], v[28:29] op_sel_hi:[1,0]
  v_pk_mul_f32 v[150:151], v[150:151], v[28:29] op_sel_hi:[1,0]
  v_cvt_pk_bf16_f32 v184, v144, v145
  v_cvt_pk_bf16_f32 v185, v146, v147
  v_cvt_pk_bf16_f32 v186, v148, v149
  v_cvt_pk_bf16_f32 v187, v150, v151
  buffer_store_dwordx4 v[184:187], v14, s[24:27], s44 offen offset:2048 sc1
  v_accvgpr_read_b32 v152, a88
  v_accvgpr_read_b32 v153, a89
  v_accvgpr_read_b32 v154, a90
  v_accvgpr_read_b32 v155, a91
  v_accvgpr_read_b32 v156, a92
  v_accvgpr_read_b32 v157, a93
  v_accvgpr_read_b32 v158, a94
  v_accvgpr_read_b32 v159, a95
  v_pk_mul_f32 v[152:153], v[152:153], v[28:29] op_sel_hi:[1,0]
  v_pk_mul_f32 v[154:155], v[154:155], v[28:29] op_sel_hi:[1,0]
  v_pk_mul_f32 v[156:157], v[156:157], v[28:29] op_sel_hi:[1,0]
  v_pk_mul_f32 v[158:159], v[158:159], v[28:29] op_sel_hi:[1,0]
  v_cvt_pk_bf16_f32 v188, v152, v153
  v_cvt_pk_bf16_f32 v189, v154, v155
  v_cvt_pk_bf16_f32 v190, v156, v157
  v_cvt_pk_bf16_f32 v191, v158, v159
  buffer_store_dwordx4 v[188:191], v14, s[24:27], s44 offen offset:3072 sc1
  v_accvgpr_read_b32 v144, a96
  v_accvgpr_read_b32 v145, a97
  v_accvgpr_read_b32 v146, a98
  v_accvgpr_read_b32 v147, a99
  v_accvgpr_read_b32 v148, a100
  v_accvgpr_read_b32 v149, a101
  v_accvgpr_read_b32 v150, a102
  v_accvgpr_read_b32 v151, a103
  v_pk_mul_f32 v[144:145], v[144:145], v[28:29] op_sel_hi:[1,0]
  v_pk_mul_f32 v[146:147], v[146:147], v[28:29] op_sel_hi:[1,0]
  v_pk_mul_f32 v[148:149], v[148:149], v[28:29] op_sel_hi:[1,0]
  v_pk_mul_f32 v[150:151], v[150:151], v[28:29] op_sel_hi:[1,0]
  v_cvt_pk_bf16_f32 v176, v144, v145
  v_cvt_pk_bf16_f32 v177, v146, v147
  v_cvt_pk_bf16_f32 v178, v148, v149
  v_cvt_pk_bf16_f32 v179, v150, v151
  buffer_store_dwordx4 v[176:179], v15, s[24:27], s44 offen sc1
  v_accvgpr_read_b32 v152, a104
  v_accvgpr_read_b32 v153, a105
  v_accvgpr_read_b32 v154, a106
  v_accvgpr_read_b32 v155, a107
  v_accvgpr_read_b32 v156, a108
  v_accvgpr_read_b32 v157, a109
  v_accvgpr_read_b32 v158, a110
  v_accvgpr_read_b32 v159, a111
  v_pk_mul_f32 v[152:153], v[152:153], v[28:29] op_sel_hi:[1,0]
  v_pk_mul_f32 v[154:155], v[154:155], v[28:29] op_sel_hi:[1,0]
  v_pk_mul_f32 v[156:157], v[156:157], v[28:29] op_sel_hi:[1,0]
  v_pk_mul_f32 v[158:159], v[158:159], v[28:29] op_sel_hi:[1,0]
  v_cvt_pk_bf16_f32 v180, v152, v153
  v_cvt_pk_bf16_f32 v181, v154, v155
  v_cvt_pk_bf16_f32 v182, v156, v157
  v_cvt_pk_bf16_f32 v183, v158, v159
  buffer_store_dwordx4 v[180:183], v15, s[24:27], s44 offen offset:1024 sc1
  v_accvgpr_read_b32 v144, a112
  v_accvgpr_read_b32 v145, a113
  v_accvgpr_read_b32 v146, a114
  v_accvgpr_read_b32 v147, a115
  v_accvgpr_read_b32 v148, a116
  v_accvgpr_read_b32 v149, a117
  v_accvgpr_read_b32 v150, a118
  v_accvgpr_read_b32 v151, a119
  v_pk_mul_f32 v[144:145], v[144:145], v[28:29] op_sel_hi:[1,0]
  v_pk_mul_f32 v[146:147], v[146:147], v[28:29] op_sel_hi:[1,0]
  v_pk_mul_f32 v[148:149], v[148:149], v[28:29] op_sel_hi:[1,0]
  v_pk_mul_f32 v[150:151], v[150:151], v[28:29] op_sel_hi:[1,0]
  v_cvt_pk_bf16_f32 v184, v144, v145
  v_cvt_pk_bf16_f32 v185, v146, v147
  v_cvt_pk_bf16_f32 v186, v148, v149
  v_cvt_pk_bf16_f32 v187, v150, v151
  buffer_store_dwordx4 v[184:187], v15, s[24:27], s44 offen offset:2048 sc1
  v_accvgpr_read_b32 v152, a120
  v_accvgpr_read_b32 v153, a121
  v_accvgpr_read_b32 v154, a122
  v_accvgpr_read_b32 v155, a123
  v_accvgpr_read_b32 v156, a124
  v_accvgpr_read_b32 v157, a125
  v_accvgpr_read_b32 v158, a126
  v_accvgpr_read_b32 v159, a127
  v_pk_mul_f32 v[152:153], v[152:153], v[28:29] op_sel_hi:[1,0]
  v_pk_mul_f32 v[154:155], v[154:155], v[28:29] op_sel_hi:[1,0]
  v_pk_mul_f32 v[156:157], v[156:157], v[28:29] op_sel_hi:[1,0]
  v_pk_mul_f32 v[158:159], v[158:159], v[28:29] op_sel_hi:[1,0]
  v_cvt_pk_bf16_f32 v188, v152, v153
  v_cvt_pk_bf16_f32 v189, v154, v155
  v_cvt_pk_bf16_f32 v190, v156, v157
  v_cvt_pk_bf16_f32 v191, v158, v159
  buffer_store_dwordx4 v[188:191], v15, s[24:27], s44 offen offset:3072 sc1
  v_add_u32 v2, s60, v50
  v_add_u32 v3, s60, v51
  v_add_u32 v4, s61, v50
  v_add_u32 v5, s61, v51
  v_add_u32 v6, s62, v50
  v_add_u32 v7, s62, v51
  v_add_u32 v8, s63, v50
  v_add_u32 v9, s63, v51
  v_add_u32 v10, s64, v50
  v_add_u32 v11, s64, v51
  v_mov_b32 v12, v48
  v_mov_b32 v13, v49
  s_barrier
  ds_read_b64_tr_b16 v[64:65], v2
  ds_read_b64_tr_b16 v[66:67], v2 offset:512
  ds_read_b64_tr_b16 v[68:69], v3
  ds_read_b64_tr_b16 v[70:71], v3 offset:512
  ds_read_b64_tr_b16 v[72:73], v2 offset:2048
  ds_read_b64_tr_b16 v[74:75], v2 offset:2560
  ds_read_b64_tr_b16 v[76:77], v3 offset:2048
  ds_read_b64_tr_b16 v[78:79], v3 offset:2560
  ds_read_b64_tr_b16 v[80:81], v2 offset:4096
  ds_read_b64_tr_b16 v[82:83], v2 offset:4608
  ds_read_b64_tr_b16 v[84:85], v3 offset:4096
  ds_read_b64_tr_b16 v[86:87], v3 offset:4608
  ds_read_b64_tr_b16 v[88:89], v2 offset:6144
  ds_read_b64_tr_b16 v[90:91], v2 offset:6656
  ds_read_b64_tr_b16 v[92:93], v3 offset:6144
  ds_read_b64_tr_b16 v[94:95], v3 offset:6656
  ds_read_b64_tr_b16 v[96:97], v4
  ds_read_b64_tr_b16 v[98:99], v4 offset:512
  ds_read_b64_tr_b16 v[100:101], v5
  ds_read_b64_tr_b16 v[102:103], v5 offset:512
  ds_read_b64_tr_b16 v[104:105], v4 offset:2048
  ds_read_b64_tr_b16 v[106:107], v4 offset:2560
  ds_read_b64_tr_b16 v[108:109], v5 offset:2048
  ds_read_b64_tr_b16 v[110:111], v5 offset:2560
  ds_read_b64_tr_b16 v[112:113], v4 offset:4096
  ds_read_b64_tr_b16 v[114:115], v4 offset:4608
  ds_read_b64_tr_b16 v[116:117], v5 offset:4096
  ds_read_b64_tr_b16 v[118:119], v5 offset:4608
  ds_read_b64_tr_b16 v[120:121], v4 offset:6144
  ds_read_b64_tr_b16 v[122:123], v4 offset:6656
  ds_read_b64_tr_b16 v[124:125], v5 offset:6144
  ds_read_b64_tr_b16 v[126:127], v5 offset:6656
  ds_read_b64_tr_b16 a[128:129], v6
  ds_read_b64_tr_b16 a[130:131], v6 offset:512
  ds_read_b64_tr_b16 a[132:133], v7
  ds_read_b64_tr_b16 a[134:135], v7 offset:512
  ds_read_b64_tr_b16 a[136:137], v6 offset:2048
  ds_read_b64_tr_b16 a[138:139], v6 offset:2560
  ds_read_b64_tr_b16 a[140:141], v7 offset:2048
  ds_read_b64_tr_b16 a[142:143], v7 offset:2560
  ds_read_b64_tr_b16 a[144:145], v6 offset:4096
  ds_read_b64_tr_b16 a[146:147], v6 offset:4608
  ds_read_b64_tr_b16 a[148:149], v7 offset:4096
  ds_read_b64_tr_b16 a[150:151], v7 offset:4608
  ds_read_b64_tr_b16 a[152:153], v6 offset:6144
  ds_read_b64_tr_b16 a[154:155], v6 offset:6656
  ds_read_b64_tr_b16 a[156:157], v7 offset:6144
  ds_read_b64_tr_b16 a[158:159], v7 offset:6656
  ds_read_b64_tr_b16 a[160:161], v8
  ds_read_b64_tr_b16 a[162:163], v8 offset:512
  ds_read_b64_tr_b16 a[164:165], v9
  ds_read_b64_tr_b16 a[166:167], v9 offset:512
  ds_read_b64_tr_b16 a[168:169], v8 offset:2048
  ds_read_b64_tr_b16 a[170:171], v8 offset:2560
  ds_read_b64_tr_b16 a[172:173], v9 offset:2048
  ds_read_b64_tr_b16 a[174:175], v9 offset:2560
  ds_read_b64_tr_b16 a[176:177], v8 offset:4096
  ds_read_b64_tr_b16 a[178:179], v8 offset:4608
  ds_read_b64_tr_b16 a[180:181], v9 offset:4096
  ds_read_b64_tr_b16 a[182:183], v9 offset:4608
  ds_read_b64_tr_b16 a[184:185], v8 offset:6144
  ds_read_b64_tr_b16 a[186:187], v8 offset:6656
  ds_read_b64_tr_b16 a[188:189], v9 offset:6144
  ds_read_b64_tr_b16 a[190:191], v9 offset:6656
  ds_read_b64_tr_b16 v[32:33], v10
  ds_read_b64_tr_b16 v[34:35], v10 offset:512
  ds_read_b64_tr_b16 v[36:37], v11
  ds_read_b64_tr_b16 v[38:39], v11 offset:512
  ds_read_b64_tr_b16 v[40:41], v10 offset:2048
  ds_read_b64_tr_b16 v[42:43], v10 offset:2560
  ds_read_b64_tr_b16 v[44:45], v11 offset:2048
  ds_read_b64_tr_b16 v[46:47], v11 offset:2560
  ds_read_b64_tr_b16 v[48:49], v10 offset:4096
  ds_read_b64_tr_b16 v[50:51], v10 offset:4608
  ds_read_b64_tr_b16 v[52:53], v11 offset:4096
  ds_read_b64_tr_b16 v[54:55], v11 offset:4608
  ds_read_b64_tr_b16 v[56:57], v10 offset:6144
  ds_read_b64_tr_b16 v[58:59], v10 offset:6656
  ds_read_b64_tr_b16 v[60:61], v11 offset:6144
  ds_read_b64_tr_b16 v[62:63], v11 offset:6656
  s_add_u32 m0, s60, 0
  s_add_u32 s66, s65, 0xa2000
  s_waitcnt lgkmcnt(15)
  buffer_load_dwordx4 v12, s[48:51], s66 offen lds
  buffer_load_dwordx4 v13, s[48:51], s66 offen offset:1024 lds
  s_add_u32 m0, s60, 0x800
  s_add_u32 s66, s65, 0xa6800
  buffer_load_dwordx4 v12, s[48:51], s66 offen lds
  buffer_load_dwordx4 v13, s[48:51], s66 offen offset:1024 lds
  s_add_u32 m0, s60, 0x1000
  s_add_u32 s66, s65, 0xab000
  buffer_load_dwordx4 v12, s[48:51], s66 offen lds
  buffer_load_dwordx4 v13, s[48:51], s66 offen offset:1024 lds
  s_add_u32 m0, s60, 0x1800
  s_add_u32 s66, s65, 0xaf800
  buffer_load_dwordx4 v12, s[48:51], s66 offen lds
  buffer_load_dwordx4 v13, s[48:51], s66 offen offset:1024 lds
  s_add_u32 m0, s61, 0
  s_add_u32 s66, s65, 0xb4000
  s_waitcnt lgkmcnt(15)
  buffer_load_dwordx4 v12, s[48:51], s66 offen lds
  buffer_load_dwordx4 v13, s[48:51], s66 offen offset:1024 lds
  s_add_u32 m0, s61, 0x800
  s_add_u32 s66, s65, 0xb8800
  buffer_load_dwordx4 v12, s[48:51], s66 offen lds
  buffer_load_dwordx4 v13, s[48:51], s66 offen offset:1024 lds
  s_add_u32 m0, s61, 0x1000
  s_add_u32 s66, s65, 0xbd000
  buffer_load_dwordx4 v12, s[48:51], s66 offen lds
  buffer_load_dwordx4 v13, s[48:51], s66 offen offset:1024 lds
  s_add_u32 m0, s61, 0x1800
  s_add_u32 s66, s65, 0xc1800
  buffer_load_dwordx4 v12, s[48:51], s66 offen lds
  buffer_load_dwordx4 v13, s[48:51], s66 offen offset:1024 lds
  s_add_u32 m0, s62, 0
  s_add_u32 s66, s65, 0xc6000
  s_waitcnt lgkmcnt(15)
  buffer_load_dwordx4 v12, s[48:51], s66 offen lds
  buffer_load_dwordx4 v13, s[48:51], s66 offen offset:1024 lds
  s_add_u32 m0, s62, 0x800
  s_add_u32 s66, s65, 0xca800
  buffer_load_dwordx4 v12, s[48:51], s66 offen lds
  buffer_load_dwordx4 v13, s[48:51], s66 offen offset:1024 lds
  s_add_u32 m0, s62, 0x1000
  s_add_u32 s66, s65, 0xcf000
  buffer_load_dwordx4 v12, s[48:51], s66 offen lds
  buffer_load_dwordx4 v13, s[48:51], s66 offen offset:1024 lds
  s_add_u32 m0, s62, 0x1800
  s_add_u32 s66, s65, 0xd3800
  buffer_load_dwordx4 v12, s[48:51], s66 offen lds
  buffer_load_dwordx4 v13, s[48:51], s66 offen offset:1024 lds
  s_waitcnt vmcnt(24)
  s_waitcnt lgkmcnt(0)
  s_barrier
  s_branch F_TAIL
A_W3:
  v_lshrrev_b32 v28, 3, v0
  v_mul_u32_u24 v28, 0x480, v28
  v_and_b32 v29, 7, v0
  v_lshrrev_b32 v30, 4, v0
  v_xor_b32 v29, v29, v30
  v_xor_b32 v30, 4, v29
  v_lshl_add_u32 v29, v29, 4, v28
  v_lshl_add_u32 v30, v30, 4, v28
  v_add_u32 v64, 0x36000, v29
  v_add_u32 v65, 0x38000, v30
  v_add_u32 v66, 0x3a000, v29
  v_add_u32 v67, 0x3c000, v30
  v_lshrrev_b32 v28, 4, v0
  v_and_b32 v29, 15, v0
  v_lshlrev_b32 v30, 2, v28
  v_xor_b32 v29, v29, v30
  v_lshlrev_b32 v29, 4, v29
  v_lshl_add_u32 v29, v28, 13, v29
  v_add_u32 v72, 0, v29
  v_add_u32 v73, 0x7c00, v29
  v_add_u32 v74, 0xf800, v29
  v_add_u32 v75, 0x17400, v29
  v_add_u32 v76, 0x20000, v29
  v_add_u32 v77, 0x27c00, v29
  v_add_u32 v78, 0x2f800, v29
  v_add_u32 v79, 0x37400, v29
  s_mul_i32 s31, s29, 0x3f000
  s_lshl_b32 s32, s30, 8
  s_sub_u32 s22, 0x480000, s32
  s_mov_b32 s23, 0x20000
  s_mov_b32 s18, 0x3f000
  s_mov_b32 s19, 0x20000
  s_and_b32 s33, s30, 7
  s_mul_i32 s33, s33, 1
  s_and_b32 s34, s29, 3
  s_mul_i32 s34, s34, 2
  s_add_u32 s33, s33, s34
  s_sub_u32 s34, s33, 9
  s_cmp_ge_u32 s33, 9
  s_cselect_b32 s33, s34, s33
  s_lshl_b32 s38, s33, 7
  s_lshl_b32 s39, s33, 19
  s_waitcnt lgkmcnt(0)
  s_add_u32 s20, s6, s32
  s_addc_u32 s21, s7, 0
  s_add_u32 s16, s4, s31
  s_addc_u32 s17, s5, 0
  s_mov_b32 m0, 0xe000
  s_nop 0
  buffer_load_dwordx4 v72, s[20:23], s39 offen lds
  buffer_load_dwordx4 v73, s[20:23], s39 offen offset:1024 lds
  buffer_load_dwordx4 v74, s[20:23], s39 offen offset:2048 lds
  buffer_load_dwordx4 v75, s[20:23], s39 offen offset:3072 lds
  s_mov_b32 m0, 0xf000
  s_nop 0
  buffer_load_dwordx4 v76, s[20:23], s39 offen lds
  buffer_load_dwordx4 v77, s[20:23], s39 offen offset:1024 lds
  buffer_load_dwordx4 v78, s[20:23], s39 offen offset:2048 lds
  buffer_load_dwordx4 v79, s[20:23], s39 offen offset:3072 lds
  s_add_u32 s39, s39, 0x40000
  s_cmp_eq_u32 s39, 4718592
  s_cselect_b32 s39, 0, s39
  s_mov_b32 m0, 0x1a000
  s_nop 0
  buffer_load_dwordx4 v64, s[16:19], s38 offen lds
  buffer_load_dwordx4 v65, s[16:19], s38 offen offset:1024 lds
  buffer_load_dwordx4 v66, s[16:19], s38 offen offset:2048 lds
  buffer_load_dwordx4 v67, s[16:19], s38 offen offset:3072 lds
  s_add_u32 s38, s38, 0x80
  s_cmp_eq_u32 s38, 1152
  s_cselect_b32 s38, 0, s38
  s_mov_b32 m0, 0x16000
  s_nop 0
  buffer_load_dwordx4 v72, s[20:23], s39 offen lds
  buffer_load_dwordx4 v73, s[20:23], s39 offen offset:1024 lds
  buffer_load_dwordx4 v74, s[20:23], s39 offen offset:2048 lds
  buffer_load_dwordx4 v75, s[20:23], s39 offen offset:3072 lds
  s_mov_b32 m0, 0x17000
  s_nop 0
  buffer_load_dwordx4 v76, s[20:23], s39 offen lds
  buffer_load_dwordx4 v77, s[20:23], s39 offen offset:1024 lds
  buffer_load_dwordx4 v78, s[20:23], s39 offen offset:2048 lds
  buffer_load_dwordx4 v79, s[20:23], s39 offen offset:3072 lds
  s_add_u32 s39, s39, 0x40000
  s_cmp_eq_u32 s39, 4718592
  s_cselect_b32 s39, 0, s39
  s_lshl_b32 s31, s29, 5
  s_add_u32 s31, s31, s30
  s_lshr_b32 s32, s31, 14
  s_lshl_b32 s31, s31, 18
  s_add_u32 s12, s10, s31
  s_addc_u32 s13, s11, s32
  s_add_u32 s8, s8, s31
  s_addc_u32 s9, s9, s32
  s_mov_b32 s10, 0x40000
  s_mov_b32 s11, 0x20000
  s_mov_b32 s14, 0x40000
  s_mov_b32 s15, 0x20000
  s_mul_i32 s31, s29, 0x1c0000
  s_lshl_b32 s32, s30, 13
  s_add_u32 s31, s31, s32
  s_add_u32 s24, s46, s31
  s_addc_u32 s25, s47, 0
  s_sub_u32 s26, 0xe00000, s31
  s_mov_b32 s27, 0x20000
  s_mul_i32 s31, s2, 0x4800
  s_add_u32 s4, s44, s31
  s_addc_u32 s5, s45, 0
  s_mov_b32 s6, 0x4800
  s_mov_b32 s7, 0x20000
  s_mov_b32 s42, 0x44800000
  s_mov_b32 s43, 0x3e0293ee
  v_and_b32 v1, 31, v0
  v_lshrrev_b32 v14, 5, v0
  v_and_b32 v15, 3, v1
  v_lshrrev_b32 v28, 3, v1
  v_lshl_or_b32 v15, v28, 2, v15
  v_xor_b32 v15, v15, v14
  v_lshlrev_b32 v28, 8, v1
  v_xor_b32 v29, 0, v15
  v_lshl_add_u32 v2, v29, 4, v28
  v_xor_b32 v29, 2, v15
  v_lshl_add_u32 v3, v29, 4, v28
  v_xor_b32 v29, 4, v15
  v_lshl_add_u32 v4, v29, 4, v28
  v_xor_b32 v29, 6, v15
  v_lshl_add_u32 v5, v29, 4, v28
  v_xor_b32 v29, 8, v15
  v_lshl_add_u32 v6, v29, 4, v28
  v_xor_b32 v29, 10, v15
  v_lshl_add_u32 v7, v29, 4, v28
  v_xor_b32 v29, 12, v15
  v_lshl_add_u32 v8, v29, 4, v28
  v_xor_b32 v29, 14, v15
  v_lshl_add_u32 v9, v29, 4, v28
  v_and_b32 v28, 1, v0
  v_lshlrev_b32 v28, 1, v28
  v_bfe_u32 v29, v0, 1, 1
  v_or_b32 v28, v28, v29
  v_lshlrev_b32 v28, 3, v28
  v_bfe_u32 v29, v0, 4, 1
  v_lshl_or_b32 v28, v29, 5, v28
  v_bfe_u32 v29, v0, 2, 2
  v_lshl_add_u32 v30, v14, 2, v29
  v_lshl_add_u32 v30, v30, 8, v28
  v_add_u32 v30, 0x10000, v30
  v_lshl_add_u32 v31, v14, 3, v29
  v_lshl_add_u32 v31, v31, 8, v28
  v_add_u32 v31, 0x8000, v31
  v_xor_b32 v15, 0, v29
  v_lshl_add_u32 v10, v15, 6, v30
  v_lshl_add_u32 v48, v15, 6, v31
  v_xor_b32 v15, 1, v29
  v_lshl_add_u32 v11, v15, 6, v30
  v_lshl_add_u32 v49, v15, 6, v31
  v_xor_b32 v15, 2, v29
  v_lshl_add_u32 v12, v15, 6, v30
  v_lshl_add_u32 v50, v15, 6, v31
  v_xor_b32 v15, 3, v29
  v_lshl_add_u32 v13, v15, 6, v30
  v_lshl_add_u32 v51, v15, 6, v31
  v_bfe_u32 v15, v1, 1, 3
  v_xor_b32 v15, v15, v14
  v_lshlrev_b32 v28, 7, v1
  v_xor_b32 v29, 0, v15
  v_lshl_add_u32 v52, v29, 4, v28
  v_xor_b32 v29, 2, v15
  v_lshl_add_u32 v53, v29, 4, v28
  v_xor_b32 v29, 4, v15
  v_lshl_add_u32 v54, v29, 4, v28
  v_xor_b32 v29, 6, v15
  v_lshl_add_u32 v55, v29, 4, v28
  v_add_u32 v32, 0x1a000, v52
  v_add_u32 v33, 0x1a000, v53
  v_add_u32 v34, 0x1a000, v54
  v_add_u32 v35, 0x1a000, v55
  v_add_u32 v36, 0x1e000, v52
  v_add_u32 v37, 0x1e000, v53
  v_add_u32 v38, 0x1e000, v54
  v_add_u32 v39, 0x1e000, v55
  v_add_u32 v40, 0x26000, v52
  v_add_u32 v41, 0x26000, v53
  s_branch PADO_6
  s_nop 0
PAD_6:
  s_nop 0
  s_nop 0
  s_endpgm
PADO_6:
  v_add_u32 v42, 0x26000, v54
  v_add_u32 v43, 0x26000, v55
  v_lshrrev_b32 v28, 4, v0
  v_and_b32 v29, 15, v0
  v_lshlrev_b32 v30, 8, v28
  v_or_b32 v31, 0, v28
  v_xor_b32 v31, v31, v29
  v_lshl_add_u32 v56, v31, 4, v30
  v_or_b32 v31, 4, v28
  v_xor_b32 v31, v31, v29
  v_lshl_add_u32 v57, v31, 4, v30
  v_or_b32 v31, 8, v28
  v_xor_b32 v31, v31, v29
  v_lshl_add_u32 v58, v31, 4, v30
  v_add_u32 v58, 0x1000, v58
  v_or_b32 v31, 12, v28
  v_xor_b32 v31, v31, v29
  v_lshl_add_u32 v59, v31, 4, v30
  v_add_u32 v59, 0x1000, v59
  v_lshlrev_b32 v31, 2, v28
  v_xor_b32 v31, v31, v29
  v_lshl_add_u32 v60, v31, 4, v30
  v_add_u32 v61, 0x1000, v60
  s_bfe_u32 s31, s2, 0x20001
  s_and_b32 s32, s2, 1
  s_lshl_b32 s32, s32, 2
  s_add_u32 s31, s31, s32
  s_lshr_b32 s32, s2, 3
  s_lshl_b32 s31, s31, 5
  s_add_u32 s72, s31, s32
  s_mul_i32 s32, s72, 57
  s_lshr_b32 s32, s32, 9
  s_mul_i32 s33, s32, 9
  s_sub_u32 s33, s72, s33
  s_lshl_b32 s33, s33, 7
  s_add_u32 s48, s44, s33
  s_addc_u32 s49, s45, 0
  s_sub_u32 s50, 0x480000, s33
  s_mov_b32 s51, 0x20000
  s_lshl_b32 s31, s32, 19
  s_add_u32 s31, s31, 0x30000
  s_add_u32 s52, s46, s31
  s_addc_u32 s53, s47, 0
  s_sub_u32 s54, 0xe00000, s31
  s_mov_b32 s55, 0x20000
  s_mul_i32 s31, s32, 0x12000
  s_add_u32 s31, s31, s33
  s_add_u32 s56, s68, s31
  s_addc_u32 s57, s69, 0
  s_sub_u32 s58, 0x1f8000, s31
  s_mov_b32 s59, 0x20000
  s_mov_b32 s60, 0x26000
  s_mov_b32 s61, 0x2000
  s_mov_b32 s62, 0x12000
  s_mov_b32 s63, 0xe000
  s_mov_b32 s64, 0x16000
  s_mov_b32 s65, 0x360000
  s_mov_b32 s46, 0x12000
  s_lshl_b32 s31, s32, 1
  s_mul_i32 s45, s31, 37
  s_lshr_b32 s45, s45, 8
  s_lshl_b32 s45, s45, 5
  s_add_u32 s31, s31, 1
  s_mul_i32 s35, s31, 37
  s_lshr_b32 s35, s35, 8
  s_lshl_b32 s35, s35, 5
  s_mov_b32 m0, 0x8000
  s_nop 0
  buffer_load_dwordx4 v72, s[20:23], s39 offen lds
  buffer_load_dwordx4 v73, s[20:23], s39 offen offset:1024 lds
  buffer_load_dwordx4 v74, s[20:23], s39 offen offset:2048 lds
  buffer_load_dwordx4 v75, s[20:23], s39 offen offset:3072 lds
  s_mov_b32 m0, 0x9000
  s_nop 0
  buffer_load_dwordx4 v76, s[20:23], s39 offen lds
  buffer_load_dwordx4 v77, s[20:23], s39 offen offset:1024 lds
  buffer_load_dwordx4 v78, s[20:23], s39 offen offset:2048 lds
  buffer_load_dwordx4 v79, s[20:23], s39 offen offset:3072 lds
  s_add_u32 s39, s39, 0x40000
  s_cmp_eq_u32 s39, 4718592
  s_cselect_b32 s39, 0, s39
  s_mov_b32 m0, 0x1e000
  s_nop 0
  buffer_load_dwordx4 v64, s[16:19], s38 offen lds
  buffer_load_dwordx4 v65, s[16:19], s38 offen offset:1024 lds
  buffer_load_dwordx4 v66, s[16:19], s38 offen offset:2048 lds
  buffer_load_dwordx4 v67, s[16:19], s38 offen offset:3072 lds
  s_add_u32 s38, s38, 0x80
  s_cmp_eq_u32 s38, 1152
  s_cselect_b32 s38, 0, s38
  s_mov_b32 m0, 0x10000
  s_nop 0
  buffer_load_dwordx4 v72, s[20:23], s39 offen lds
  buffer_load_dwordx4 v73, s[20:23], s39 offen offset:1024 lds
  buffer_load_dwordx4 v74, s[20:23], s39 offen offset:2048 lds
  buffer_load_dwordx4 v75, s[20:23], s39 offen offset:3072 lds
  s_mov_b32 m0, 0x11000
  s_nop 0
  buffer_load_dwordx4 v76, s[20:23], s39 offen lds
  buffer_load_dwordx4 v77, s[20:23], s39 offen offset:1024 lds
  buffer_load_dwordx4 v78, s[20:23], s39 offen offset:2048 lds
  buffer_load_dwordx4 v79, s[20:23], s39 offen offset:3072 lds
  s_add_u32 s39, s39, 0x40000
  s_cmp_eq_u32 s39, 4718592
  s_cselect_b32 s39, 0, s39
  s_mov_b32 m0, 0xa000
  s_nop 0
  buffer_load_dwordx4 v72, s[20:23], s39 offen lds
  buffer_load_dwordx4 v73, s[20:23], s39 offen offset:1024 lds
  buffer_load_dwordx4 v74, s[20:23], s39 offen offset:2048 lds
  buffer_load_dwordx4 v75, s[20:23], s39 offen offset:3072 lds
  s_mov_b32 m0, 0xb000
  s_nop 0
  buffer_load_dwordx4 v76, s[20:23], s39 offen lds
  buffer_load_dwordx4 v77, s[20:23], s39 offen offset:1024 lds
  buffer_load_dwordx4 v78, s[20:23], s39 offen offset:2048 lds
  buffer_load_dwordx4 v79, s[20:23], s39 offen offset:3072 lds
  s_add_u32 s39, s39, 0x40000
  s_cmp_eq_u32 s39, 4718592
  s_cselect_b32 s39, 0, s39
  s_waitcnt vmcnt(40)
  s_barrier
  ds_read_b64_tr_b16 a[128:129], v48 offset:24576
  ds_read_b64_tr_b16 a[130:131], v48 offset:25600
  ds_read_b64_tr_b16 a[132:133], v49 offset:24576
  ds_read_b64_tr_b16 a[134:135], v49 offset:25600
  ds_read_b64_tr_b16 a[136:137], v50 offset:24576
  ds_read_b64_tr_b16 a[138:139], v50 offset:25600
  ds_read_b64_tr_b16 a[140:141], v51 offset:24576
  ds_read_b64_tr_b16 a[142:143], v51 offset:25600
  ds_read_b64_tr_b16 a[144:145], v48 offset:28672
  ds_read_b64_tr_b16 a[146:147], v48 offset:29696
  ds_read_b64_tr_b16 a[148:149], v49 offset:28672
  ds_read_b64_tr_b16 a[150:151], v49 offset:29696
  ds_read_b64_tr_b16 a[152:153], v50 offset:28672
  ds_read_b64_tr_b16 a[154:155], v50 offset:29696
  ds_read_b64_tr_b16 a[156:157], v51 offset:28672
  ds_read_b64_tr_b16 a[158:159], v51 offset:29696
  s_waitcnt vmcnt(36)
  ds_read_b128 a[192:195], v32
  ds_read_b128 a[196:199], v33
  ds_read_b128 a[200:203], v34
  ds_read_b128 a[204:207], v35
  s_waitcnt vmcnt(28) lgkmcnt(0)
  s_barrier
  v_mfma_f32_32x32x16_bf16 v[128:143], a[128:131], a[192:195], 0
  ds_read_b64_tr_b16 a[160:161], v48 offset:57344
  ds_read_b64_tr_b16 a[162:163], v48 offset:58368
  s_mov_b32 m0, 0x12000
  s_nop 0
  buffer_load_dwordx4 v72, s[20:23], s39 offen lds
  buffer_load_dwordx4 v73, s[20:23], s39 offen offset:1024 lds
  v_mfma_f32_32x32x16_bf16 v[144:159], a[132:135], a[192:195], 0
  ds_read_b64_tr_b16 a[164:165], v49 offset:57344
  ds_read_b64_tr_b16 a[166:167], v49 offset:58368
  buffer_load_dwordx4 v74, s[20:23], s39 offen offset:2048 lds
  v_accvgpr_write_b32 a0, 0
  v_mfma_f32_32x32x16_bf16 v[160:175], a[136:139], a[192:195], 0
  ds_read_b64_tr_b16 a[168:169], v50 offset:57344
  ds_read_b64_tr_b16 a[170:171], v50 offset:58368
  buffer_load_dwordx4 v75, s[20:23], s39 offen offset:3072 lds
  s_mov_b32 m0, 0x13000
  s_nop 0
  buffer_load_dwordx4 v76, s[20:23], s39 offen lds
  v_mfma_f32_32x32x16_bf16 v[176:191], a[140:143], a[192:195], 0
  ds_read_b64_tr_b16 a[172:173], v51 offset:57344
  ds_read_b64_tr_b16 a[174:175], v51 offset:58368
  buffer_load_dwordx4 v77, s[20:23], s39 offen offset:1024 lds
  buffer_load_dwordx4 v78, s[20:23], s39 offen offset:2048 lds
  v_accvgpr_write_b32 a1, 0
  v_mfma_f32_32x32x16_bf16 v[128:143], a[144:147], a[196:199], v[128:143]
  ds_read_b64_tr_b16 a[176:177], v48 offset:61440
  ds_read_b64_tr_b16 a[178:179], v48 offset:62464
  buffer_load_dwordx4 v79, s[20:23], s39 offen offset:3072 lds
  s_add_u32 s39, s39, 0x40000
  s_cmp_eq_u32 s39, 4718592
  v_mfma_f32_32x32x16_bf16 v[144:159], a[148:151], a[196:199], v[144:159]
  ds_read_b64_tr_b16 a[180:181], v49 offset:61440
  ds_read_b64_tr_b16 a[182:183], v49 offset:62464
  s_cselect_b32 s39, 0, s39
  s_mov_b32 m0, 0x26000
  s_nop 0
  buffer_load_dwordx4 v64, s[16:19], s38 offen lds
  v_accvgpr_write_b32 a2, 0
  v_mfma_f32_32x32x16_bf16 v[160:175], a[152:155], a[196:199], v[160:175]
  ds_read_b64_tr_b16 a[184:185], v50 offset:61440
  ds_read_b64_tr_b16 a[186:187], v50 offset:62464
  buffer_load_dwordx4 v65, s[16:19], s38 offen offset:1024 lds
  buffer_load_dwordx4 v66, s[16:19], s38 offen offset:2048 lds
  v_mfma_f32_32x32x16_bf16 v[176:191], a[156:159], a[196:199], v[176:191]
  ds_read_b64_tr_b16 a[188:189], v51 offset:61440
  ds_read_b64_tr_b16 a[190:191], v51 offset:62464
  buffer_load_dwordx4 v67, s[16:19], s38 offen offset:3072 lds
  s_add_u32 s38, s38, 0x80
  s_cmp_eq_u32 s38, 1152
  s_cselect_b32 s38, 0, s38
  v_accvgpr_write_b32 a3, 0
  s_waitcnt vmcnt(32) lgkmcnt(0)
  s_barrier
  v_mfma_f32_32x32x16_bf16 v[128:143], a[160:163], a[200:203], v[128:143]
  ds_read_b64_tr_b16 a[128:129], v48
  ds_read_b64_tr_b16 a[130:131], v48 offset:1024
  s_mov_b32 m0, 0xc000
  s_nop 0
  buffer_load_dwordx4 v72, s[20:23], s39 offen lds
  buffer_load_dwordx4 v73, s[20:23], s39 offen offset:1024 lds
  v_mfma_f32_32x32x16_bf16 v[144:159], a[164:167], a[200:203], v[144:159]
  ds_read_b64_tr_b16 a[132:133], v49
  ds_read_b64_tr_b16 a[134:135], v49 offset:1024
  buffer_load_dwordx4 v74, s[20:23], s39 offen offset:2048 lds
  v_accvgpr_write_b32 a4, 0
  v_mfma_f32_32x32x16_bf16 v[160:175], a[168:171], a[200:203], v[160:175]
  ds_read_b64_tr_b16 a[136:137], v50
  ds_read_b64_tr_b16 a[138:139], v50 offset:1024
  buffer_load_dwordx4 v75, s[20:23], s39 offen offset:3072 lds
  s_mov_b32 m0, 0xd000
  s_nop 0
  buffer_load_dwordx4 v76, s[20:23], s39 offen lds
  v_mfma_f32_32x32x16_bf16 v[176:191], a[172:175], a[200:203], v[176:191]
  ds_read_b64_tr_b16 a[140:141], v51
  ds_read_b64_tr_b16 a[142:143], v51 offset:1024
  buffer_load_dwordx4 v77, s[20:23], s39 offen offset:1024 lds
  buffer_load_dwordx4 v78, s[20:23], s39 offen offset:2048 lds
  s_waitcnt vmcnt(35)
  ds_read_b128 a[224:227], v36
  v_accvgpr_write_b32 a5, 0
  v_mfma_f32_32x32x16_bf16 v[128:143], a[176:179], a[204:207], v[128:143]
  ds_read_b64_tr_b16 a[144:145], v48 offset:4096
  ds_read_b64_tr_b16 a[146:147], v48 offset:5120
  buffer_load_dwordx4 v79, s[20:23], s39 offen offset:3072 lds
  s_add_u32 s39, s39, 0x40000
  s_cmp_eq_u32 s39, 4718592
  ds_read_b128 a[228:231], v37
  v_mfma_f32_32x32x16_bf16 v[144:159], a[180:183], a[204:207], v[144:159]
  ds_read_b64_tr_b16 a[148:149], v49 offset:4096
  ds_read_b64_tr_b16 a[150:151], v49 offset:5120
  s_cselect_b32 s39, 0, s39
  s_mov_b32 m0, 0x1a000
  s_nop 0
  buffer_load_dwordx4 v64, s[16:19], s38 offen lds
  v_accvgpr_write_b32 a6, 0
  v_mfma_f32_32x32x16_bf16 v[160:175], a[184:187], a[204:207], v[160:175]
  ds_read_b64_tr_b16 a[152:153], v50 offset:4096
  ds_read_b64_tr_b16 a[154:155], v50 offset:5120
  buffer_load_dwordx4 v65, s[16:19], s38 offen offset:1024 lds
  buffer_load_dwordx4 v66, s[16:19], s38 offen offset:2048 lds
  ds_read_b128 a[232:235], v38
  v_mfma_f32_32x32x16_bf16 v[176:191], a[188:191], a[204:207], v[176:191]
  ds_read_b64_tr_b16 a[156:157], v51 offset:4096
  ds_read_b64_tr_b16 a[158:159], v51 offset:5120
  buffer_load_dwordx4 v67, s[16:19], s38 offen offset:3072 lds
  s_add_u32 s38, s38, 0x80
  s_cmp_eq_u32 s38, 1152
  s_cselect_b32 s38, 0, s38
  ds_read_b128 a[236:239], v39
  v_accvgpr_write_b32 a7, 0
  s_waitcnt vmcnt(32) lgkmcnt(0)
  s_barrier
  v_mfma_f32_32x32x16_bf16 v[128:143], a[128:131], a[224:227], v[128:143]
  ds_read_b64_tr_b16 a[160:161], v48 offset:32768
  ds_read_b64_tr_b16 a[162:163], v48 offset:33792
  s_mov_b32 m0, 0x14000
  s_nop 0
  buffer_load_dwordx4 v72, s[20:23], s39 offen lds
  buffer_load_dwordx4 v73, s[20:23], s39 offen offset:1024 lds
  v_mfma_f32_32x32x16_bf16 v[144:159], a[132:135], a[224:227], v[144:159]
  ds_read_b64_tr_b16 a[164:165], v49 offset:32768
  ds_read_b64_tr_b16 a[166:167], v49 offset:33792
  buffer_load_dwordx4 v74, s[20:23], s39 offen offset:2048 lds
  buffer_load_dwordx4 v75, s[20:23], s39 offen offset:3072 lds
  s_mov_b32 m0, 0x15000
  v_accvgpr_write_b32 a8, 0
  v_mfma_f32_32x32x16_bf16 v[160:175], a[136:139], a[224:227], v[160:175]
  ds_read_b64_tr_b16 a[168:169], v50 offset:32768
  ds_read_b64_tr_b16 a[170:171], v50 offset:33792
  buffer_load_dwordx4 v76, s[20:23], s39 offen lds
  buffer_load_dwordx4 v77, s[20:23], s39 offen offset:1024 lds
  v_mfma_f32_32x32x16_bf16 v[176:191], a[140:143], a[224:227], v[176:191]
  ds_read_b64_tr_b16 a[172:173], v51 offset:32768
  ds_read_b64_tr_b16 a[174:175], v51 offset:33792
  buffer_load_dwordx4 v78, s[20:23], s39 offen offset:2048 lds
  buffer_load_dwordx4 v79, s[20:23], s39 offen offset:3072 lds
  s_add_u32 s39, s39, 0x40000
  s_cmp_eq_u32 s39, 4718592
  s_cselect_b32 s39, 0, s39
  v_accvgpr_write_b32 a9, 0
  v_mfma_f32_32x32x16_bf16 v[128:143], a[144:147], a[228:231], v[128:143]
  ds_read_b64_tr_b16 a[176:177], v48 offset:36864
  ds_read_b64_tr_b16 a[178:179], v48 offset:37888
  s_mov_b32 m0, 0xe000
  s_nop 0
  buffer_load_dwordx4 v72, s[20:23], s39 offen lds
  buffer_load_dwordx4 v73, s[20:23], s39 offen offset:1024 lds
  v_mfma_f32_32x32x16_bf16 v[144:159], a[148:151], a[228:231], v[144:159]
  ds_read_b64_tr_b16 a[180:181], v49 offset:36864
  ds_read_b64_tr_b16 a[182:183], v49 offset:37888
  buffer_load_dwordx4 v74, s[20:23], s39 offen offset:2048 lds
  buffer_load_dwordx4 v75, s[20:23], s39 offen offset:3072 lds
  s_mov_b32 m0, 0xf000
  v_accvgpr_write_b32 a10, 0
  v_mfma_f32_32x32x16_bf16 v[160:175], a[152:155], a[228:231], v[160:175]
  ds_read_b64_tr_b16 a[184:185], v50 offset:36864
  ds_read_b64_tr_b16 a[186:187], v50 offset:37888
  buffer_load_dwordx4 v76, s[20:23], s39 offen lds
  buffer_load_dwordx4 v77, s[20:23], s39 offen offset:1024 lds
  v_mfma_f32_32x32x16_bf16 v[176:191], a[156:159], a[228:231], v[176:191]
  ds_read_b64_tr_b16 a[188:189], v51 offset:36864
  ds_read_b64_tr_b16 a[190:191], v51 offset:37888
  buffer_load_dwordx4 v78, s[20:23], s39 offen offset:2048 lds
  buffer_load_dwordx4 v79, s[20:23], s39 offen offset:3072 lds
  s_add_u32 s39, s39, 0x40000
  s_cmp_eq_u32 s39, 4718592
  s_cselect_b32 s39, 0, s39
  v_accvgpr_write_b32 a11, 0
  s_waitcnt vmcnt(40) lgkmcnt(0)
  s_barrier
  v_mfma_f32_32x32x16_bf16 v[128:143], a[160:163], a[232:235], v[128:143]
  ds_read_b64_tr_b16 a[128:129], v48 offset:8192
  ds_read_b64_tr_b16 a[130:131], v48 offset:9216
  s_mov_b32 m0, 0x16000
  s_nop 0
  buffer_load_dwordx4 v72, s[20:23], s39 offen lds
  buffer_load_dwordx4 v73, s[20:23], s39 offen offset:1024 lds
  buffer_load_dwordx4 v74, s[20:23], s39 offen offset:2048 lds
  v_mfma_f32_32x32x16_bf16 v[144:159], a[164:167], a[232:235], v[144:159]
  ds_read_b64_tr_b16 a[132:133], v49 offset:8192
  ds_read_b64_tr_b16 a[134:135], v49 offset:9216
  buffer_load_dwordx4 v75, s[20:23], s39 offen offset:3072 lds
  s_mov_b32 m0, 0x17000
  s_nop 0
  buffer_load_dwordx4 v76, s[20:23], s39 offen lds
  v_accvgpr_write_b32 a12, 0
  v_mfma_f32_32x32x16_bf16 v[160:175], a[168:171], a[232:235], v[160:175]
  ds_read_b64_tr_b16 a[136:137], v50 offset:8192
  ds_read_b64_tr_b16 a[138:139], v50 offset:9216
  buffer_load_dwordx4 v77, s[20:23], s39 offen offset:1024 lds
  buffer_load_dwordx4 v78, s[20:23], s39 offen offset:2048 lds
  buffer_load_dwordx4 v79, s[20:23], s39 offen offset:3072 lds
  s_add_u32 s39, s39, 0x40000
  v_mfma_f32_32x32x16_bf16 v[176:191], a[172:175], a[232:235], v[176:191]
  ds_read_b64_tr_b16 a[140:141], v51 offset:8192
  ds_read_b64_tr_b16 a[142:143], v51 offset:9216
  s_cmp_eq_u32 s39, 4718592
  s_cselect_b32 s39, 0, s39
  s_mov_b32 m0, 0x8000
  s_nop 0
  buffer_load_dwordx4 v72, s[20:23], s39 offen lds
  buffer_load_dwordx4 v73, s[20:23], s39 offen offset:1024 lds
  s_waitcnt vmcnt(38)
  ds_read_b128 a[192:195], v40
  v_accvgpr_write_b32 a13, 0
  v_mfma_f32_32x32x16_bf16 v[128:143], a[176:179], a[236:239], v[128:143]
  ds_read_b64_tr_b16 a[144:145], v48 offset:12288
  ds_read_b64_tr_b16 a[146:147], v48 offset:13312
  buffer_load_dwordx4 v74, s[20:23], s39 offen offset:2048 lds
  buffer_load_dwordx4 v75, s[20:23], s39 offen offset:3072 lds
  s_mov_b32 m0, 0x9000
  s_nop 0
  buffer_load_dwordx4 v76, s[20:23], s39 offen lds
  ds_read_b128 a[196:199], v41
  v_mfma_f32_32x32x16_bf16 v[144:159], a[180:183], a[236:239], v[144:159]
  ds_read_b64_tr_b16 a[148:149], v49 offset:12288
  ds_read_b64_tr_b16 a[150:151], v49 offset:13312
  buffer_load_dwordx4 v77, s[20:23], s39 offen offset:1024 lds
  buffer_load_dwordx4 v78, s[20:23], s39 offen offset:2048 lds
  buffer_load_dwordx4 v79, s[20:23], s39 offen offset:3072 lds
  v_accvgpr_write_b32 a14, 0
  v_mfma_f32_32x32x16_bf16 v[160:175], a[184:187], a[236:239], v[160:175]
  ds_read_b64_tr_b16 a[152:153], v50 offset:12288
  ds_read_b64_tr_b16 a[154:155], v50 offset:13312
  s_add_u32 s39, s39, 0x40000
  s_cmp_eq_u32 s39, 4718592
  s_cselect_b32 s39, 0, s39
  s_mov_b32 m0, 0x1e000
  s_nop 0
  buffer_load_dwordx4 v64, s[16:19], s38 offen lds
  buffer_load_dwordx4 v65, s[16:19], s38 offen offset:1024 lds
  ds_read_b128 a[200:203], v42
  v_mfma_f32_32x32x16_bf16 v[176:191], a[188:191], a[236:239], v[176:191]
  ds_read_b64_tr_b16 a[156:157], v51 offset:12288
  ds_read_b64_tr_b16 a[158:159], v51 offset:13312
  buffer_load_dwordx4 v66, s[16:19], s38 offen offset:2048 lds
  buffer_load_dwordx4 v67, s[16:19], s38 offen offset:3072 lds
  s_add_u32 s38, s38, 0x80
  s_cmp_eq_u32 s38, 1152
  s_cselect_b32 s38, 0, s38
  ds_read_b128 a[204:207], v43
  v_accvgpr_write_b32 a15, 0
  s_waitcnt lgkmcnt(0)
  s_barrier
  v_mfma_f32_32x32x16_bf16 v[128:143], a[128:131], a[192:195], v[128:143]
  ds_read_b64_tr_b16 a[160:161], v48 offset:40960
  ds_read_b64_tr_b16 a[162:163], v48 offset:41984
  s_mov_b32 m0, 0x10000
  s_nop 0
  buffer_load_dwordx4 v72, s[20:23], s39 offen lds
  buffer_load_dwordx4 v73, s[20:23], s39 offen offset:1024 lds
  v_mfma_f32_32x32x16_bf16 v[144:159], a[132:135], a[192:195], v[144:159]
  ds_read_b64_tr_b16 a[164:165], v49 offset:40960
  ds_read_b64_tr_b16 a[166:167], v49 offset:41984
  buffer_load_dwordx4 v74, s[20:23], s39 offen offset:2048 lds
  v_accvgpr_write_b32 a16, 0
  v_mfma_f32_32x32x16_bf16 v[160:175], a[136:139], a[192:195], v[160:175]
  ds_read_b64_tr_b16 a[168:169], v50 offset:40960
  ds_read_b64_tr_b16 a[170:171], v50 offset:41984
  buffer_load_dwordx4 v75, s[20:23], s39 offen offset:3072 lds
  s_mov_b32 m0, 0x11000
  s_nop 0
  buffer_load_dwordx4 v76, s[20:23], s39 offen lds
  v_mfma_f32_32x32x16_bf16 v[176:191], a[140:143], a[192:195], v[176:191]
  ds_read_b64_tr_b16 a[172:173], v51 offset:40960
  ds_read_b64_tr_b16 a[174:175], v51 offset:41984
  buffer_load_dwordx4 v77, s[20:23], s39 offen offset:1024 lds
  buffer_load_dwordx4 v78, s[20:23], s39 offen offset:2048 lds
  v_accvgpr_write_b32 a17, 0
  v_mfma_f32_32x32x16_bf16 v[128:143], a[144:147], a[196:199], v[128:143]
  ds_read_b64_tr_b16 a[176:177], v48 offset:45056
  ds_read_b64_tr_b16 a[178:179], v48 offset:46080
  buffer_load_dwordx4 v79, s[20:23], s39 offen offset:3072 lds
  s_add_u32 s39, s39, 0x40000
  s_cmp_eq_u32 s39, 4718592
  v_mfma_f32_32x32x16_bf16 v[144:159], a[148:151], a[196:199], v[144:159]
  ds_read_b64_tr_b16 a[180:181], v49 offset:45056
  ds_read_b64_tr_b16 a[182:183], v49 offset:46080
  s_cselect_b32 s39, 0, s39
  s_mov_b32 m0, 0x26000
  s_nop 0
  buffer_load_dwordx4 v64, s[16:19], s38 offen lds
  v_accvgpr_write_b32 a18, 0
  v_mfma_f32_32x32x16_bf16 v[160:175], a[152:155], a[196:199], v[160:175]
  ds_read_b64_tr_b16 a[184:185], v50 offset:45056
  ds_read_b64_tr_b16 a[186:187], v50 offset:46080
  buffer_load_dwordx4 v65, s[16:19], s38 offen offset:1024 lds
  buffer_load_dwordx4 v66, s[16:19], s38 offen offset:2048 lds
  v_mfma_f32_32x32x16_bf16 v[176:191], a[156:159], a[196:199], v[176:191]
  ds_read_b64_tr_b16 a[188:189], v51 offset:45056
  ds_read_b64_tr_b16 a[190:191], v51 offset:46080
  buffer_load_dwordx4 v67, s[16:19], s38 offen offset:3072 lds
  s_add_u32 s38, s38, 0x80
  s_cmp_eq_u32 s38, 1152
  s_cselect_b32 s38, 0, s38
  v_accvgpr_write_b32 a19, 0
  s_waitcnt vmcnt(52) lgkmcnt(0)
  s_barrier
  v_mfma_f32_32x32x16_bf16 v[128:143], a[160:163], a[200:203], v[128:143]
  ds_read_b64_tr_b16 a[128:129], v48 offset:16384
  ds_read_b64_tr_b16 a[130:131], v48 offset:17408
  s_mov_b32 m0, 0xa000
  s_nop 0
  buffer_load_dwordx4 v72, s[20:23], s39 offen lds
  buffer_load_dwordx4 v73, s[20:23], s39 offen offset:1024 lds
  v_mfma_f32_32x32x16_bf16 v[144:159], a[164:167], a[200:203], v[144:159]
  ds_read_b64_tr_b16 a[132:133], v49 offset:16384
  ds_read_b64_tr_b16 a[134:135], v49 offset:17408
  buffer_load_dwordx4 v74, s[20:23], s39 offen offset:2048 lds
  buffer_load_dwordx4 v75, s[20:23], s39 offen offset:3072 lds
  s_mov_b32 m0, 0xb000
  v_accvgpr_write_b32 a20, 0
  v_mfma_f32_32x32x16_bf16 v[160:175], a[168:171], a[200:203], v[160:175]
  ds_read_b64_tr_b16 a[136:137], v50 offset:16384
  ds_read_b64_tr_b16 a[138:139], v50 offset:17408
  buffer_load_dwordx4 v76, s[20:23], s39 offen lds
  buffer_load_dwordx4 v77, s[20:23], s39 offen offset:1024 lds
  v_mfma_f32_32x32x16_bf16 v[176:191], a[172:175], a[200:203], v[176:191]
  ds_read_b64_tr_b16 a[140:141], v51 offset:16384
  ds_read_b64_tr_b16 a[142:143], v51 offset:17408
  buffer_load_dwordx4 v78, s[20:23], s39 offen offset:2048 lds
  buffer_load_dwordx4 v79, s[20:23], s39 offen offset:3072 lds
  s_add_u32 s39, s39, 0x40000
  s_cmp_eq_u32 s39, 4718592
  s_cselect_b32 s39, 0, s39
  s_waitcnt vmcnt(56)
  ds_read_b128 a[224:227], v32
  v_accvgpr_write_b32 a21, 0
  v_mfma_f32_32x32x16_bf16 v[128:143], a[176:179], a[204:207], v[128:143]
  ds_read_b64_tr_b16 a[144:145], v48 offset:20480
  ds_read_b64_tr_b16 a[146:147], v48 offset:21504
  s_mov_b32 m0, 0x12000
  s_nop 0
  buffer_load_dwordx4 v72, s[20:23], s39 offen lds
  buffer_load_dwordx4 v73, s[20:23], s39 offen offset:1024 lds
  ds_read_b128 a[228:231], v33
  v_mfma_f32_32x32x16_bf16 v[144:159], a[180:183], a[204:207], v[144:159]
  ds_read_b64_tr_b16 a[148:149], v49 offset:20480
  ds_read_b64_tr_b16 a[150:151], v49 offset:21504
  buffer_load_dwordx4 v74, s[20:23], s39 offen offset:2048 lds
  buffer_load_dwordx4 v75, s[20:23], s39 offen offset:3072 lds
  s_mov_b32 m0, 0x13000
  v_accvgpr_write_b32 a22, 0
  v_mfma_f32_32x32x16_bf16 v[160:175], a[184:187], a[204:207], v[160:175]
  ds_read_b64_tr_b16 a[152:153], v50 offset:20480
  ds_read_b64_tr_b16 a[154:155], v50 offset:21504
  buffer_load_dwordx4 v76, s[20:23], s39 offen lds
  buffer_load_dwordx4 v77, s[20:23], s39 offen offset:1024 lds
  ds_read_b128 a[232:235], v34
  v_mfma_f32_32x32x16_bf16 v[176:191], a[188:191], a[204:207], v[176:191]
  ds_read_b64_tr_b16 a[156:157], v51 offset:20480
  ds_read_b64_tr_b16 a[158:159], v51 offset:21504
  buffer_load_dwordx4 v78, s[20:23], s39 offen offset:2048 lds
  buffer_load_dwordx4 v79, s[20:23], s39 offen offset:3072 lds
  s_add_u32 s39, s39, 0x40000
  s_cmp_eq_u32 s39, 4718592
  s_cselect_b32 s39, 0, s39
  ds_read_b128 a[236:239], v35
  v_accvgpr_write_b32 a23, 0
  s_waitcnt vmcnt(56) lgkmcnt(0)
  s_barrier
  v_mfma_f32_32x32x16_bf16 v[128:143], a[128:131], a[224:227], v[128:143]
  ds_read_b64_tr_b16 a[160:161], v48 offset:49152
  ds_read_b64_tr_b16 a[162:163], v48 offset:50176
  s_mov_b32 m0, 0xc000
  s_nop 0
  buffer_load_dwordx4 v72, s[20:23], s39 offen lds
  buffer_load_dwordx4 v73, s[20:23], s39 offen offset:1024 lds
  v_mfma_f32_32x32x16_bf16 v[144:159], a[132:135], a[224:227], v[144:159]
  ds_read_b64_tr_b16 a[164:165], v49 offset:49152
  ds_read_b64_tr_b16 a[166:167], v49 offset:50176
  buffer_load_dwordx4 v74, s[20:23], s39 offen offset:2048 lds
  v_accvgpr_write_b32 a24, 0
  v_mfma_f32_32x32x16_bf16 v[160:175], a[136:139], a[224:227], v[160:175]
  ds_read_b64_tr_b16 a[168:169], v50 offset:49152
  ds_read_b64_tr_b16 a[170:171], v50 offset:50176
  buffer_load_dwordx4 v75, s[20:23], s39 offen offset:3072 lds
  s_mov_b32 m0, 0xd000
  s_nop 0
  buffer_load_dwordx4 v76, s[20:23], s39 offen lds
  v_mfma_f32_32x32x16_bf16 v[176:191], a[140:143], a[224:227], v[176:191]
  ds_read_b64_tr_b16 a[172:173], v51 offset:49152
  ds_read_b64_tr_b16 a[174:175], v51 offset:50176
  buffer_load_dwordx4 v77, s[20:23], s39 offen offset:1024 lds
  buffer_load_dwordx4 v78, s[20:23], s39 offen offset:2048 lds
  v_accvgpr_write_b32 a25, 0
  v_mfma_f32_32x32x16_bf16 v[128:143], a[144:147], a[228:231], v[128:143]
  ds_read_b64_tr_b16 a[176:177], v48 offset:53248
  ds_read_b64_tr_b16 a[178:179], v48 offset:54272
  buffer_load_dwordx4 v79, s[20:23], s39 offen offset:3072 lds
  s_add_u32 s39, s39, 0x40000
  s_cmp_eq_u32 s39, 4718592
  v_mfma_f32_32x32x16_bf16 v[144:159], a[148:151], a[228:231], v[144:159]
  ds_read_b64_tr_b16 a[180:181], v49 offset:53248
  ds_read_b64_tr_b16 a[182:183], v49 offset:54272
  s_cselect_b32 s39, 0, s39
  s_mov_b32 m0, 0x1a000
  s_nop 0
  buffer_load_dwordx4 v64, s[16:19], s38 offen lds
  v_accvgpr_write_b32 a26, 0
  v_mfma_f32_32x32x16_bf16 v[160:175], a[152:155], a[228:231], v[160:175]
  ds_read_b64_tr_b16 a[184:185], v50 offset:53248
  ds_read_b64_tr_b16 a[186:187], v50 offset:54272
  buffer_load_dwordx4 v65, s[16:19], s38 offen offset:1024 lds
  buffer_load_dwordx4 v66, s[16:19], s38 offen offset:2048 lds
  v_mfma_f32_32x32x16_bf16 v[176:191], a[156:159], a[228:231], v[176:191]
  ds_read_b64_tr_b16 a[188:189], v51 offset:53248
  ds_read_b64_tr_b16 a[190:191], v51 offset:54272
  buffer_load_dwordx4 v67, s[16:19], s38 offen offset:3072 lds
  s_add_u32 s38, s38, 0x80
  s_cmp_eq_u32 s38, 1152
  s_cselect_b32 s38, 0, s38
  v_accvgpr_write_b32 a27, 0
  s_waitcnt vmcnt(60) lgkmcnt(0)
  s_barrier
  v_mfma_f32_32x32x16_bf16 v[128:143], a[160:163], a[232:235], v[128:143]
  ds_read_b64_tr_b16 a[128:129], v48 offset:24576
  ds_read_b64_tr_b16 a[130:131], v48 offset:25600
  s_branch PADO_7
PADA_7:
  s_branch HOPRET_g2
PAD_7:
  s_sub_u32 s40, s40, 1
  s_cbranch_scc1 HOPRET_gb
  s_branch PAD_3
PADO_7:
  s_mov_b32 m0, 0x14000
  s_nop 0
  buffer_load_dwordx4 v72, s[20:23], s39 offen lds
  v_mfma_f32_32x32x16_bf16 v[144:159], a[164:167], a[232:235], v[144:159]
  ds_read_b64_tr_b16 a[132:133], v49 offset:24576
  ds_read_b64_tr_b16 a[134:135], v49 offset:25600
  buffer_load_dwordx4 v73, s[20:23], s39 offen offset:1024 lds
  v_accvgpr_write_b32 a28, 0
  v_mfma_f32_32x32x16_bf16 v[160:175], a[168:171], a[232:235], v[160:175]
  ds_read_b64_tr_b16 a[136:137], v50 offset:24576
  ds_read_b64_tr_b16 a[138:139], v50 offset:25600
  buffer_load_dwordx4 v74, s[20:23], s39 offen offset:2048 lds
  v_mfma_f32_32x32x16_bf16 v[176:191], a[172:175], a[232:235], v[176:191]
  ds_read_b64_tr_b16 a[140:141], v51 offset:24576
  ds_read_b64_tr_b16 a[142:143], v51 offset:25600
  buffer_load_dwordx4 v75, s[20:23], s39 offen offset:3072 lds
  s_mov_b32 m0, 0x15000
  s_waitcnt vmcnt(44)
  ds_read_b128 a[192:195], v36
  v_accvgpr_write_b32 a29, 0
  v_mfma_f32_32x32x16_bf16 v[128:143], a[176:179], a[236:239], v[128:143]
  ds_read_b64_tr_b16 a[144:145], v48 offset:28672
  ds_read_b64_tr_b16 a[146:147], v48 offset:29696
  buffer_load_dwordx4 v76, s[20:23], s39 offen lds
  ds_read_b128 a[196:199], v37
  v_mfma_f32_32x32x16_bf16 v[144:159], a[180:183], a[236:239], v[144:159]
  ds_read_b64_tr_b16 a[148:149], v49 offset:28672
  ds_read_b64_tr_b16 a[150:151], v49 offset:29696
  buffer_load_dwordx4 v77, s[20:23], s39 offen offset:1024 lds
  v_accvgpr_write_b32 a30, 0
  v_mfma_f32_32x32x16_bf16 v[160:175], a[184:187], a[236:239], v[160:175]
  ds_read_b64_tr_b16 a[152:153], v50 offset:28672
  ds_read_b64_tr_b16 a[154:155], v50 offset:29696
  buffer_load_dwordx4 v78, s[20:23], s39 offen offset:2048 lds
  buffer_load_dwordx4 v79, s[20:23], s39 offen offset:3072 lds
  ds_read_b128 a[200:203], v38
  v_mfma_f32_32x32x16_bf16 v[176:191], a[188:191], a[236:239], v[176:191]
  ds_read_b64_tr_b16 a[156:157], v51 offset:28672
  ds_read_b64_tr_b16 a[158:159], v51 offset:29696
  s_add_u32 s39, s39, 0x40000
  s_cmp_eq_u32 s39, 4718592
  s_cselect_b32 s39, 0, s39
  ds_read_b128 a[204:207], v39
  v_accvgpr_write_b32 a31, 0
  s_waitcnt lgkmcnt(0)
  s_barrier
  v_mfma_f32_32x32x16_bf16 v[128:143], a[128:131], a[192:195], v[128:143]
  ds_read_b64_tr_b16 a[160:161], v48 offset:57344
  ds_read_b64_tr_b16 a[162:163], v48 offset:58368
  s_mov_b32 m0, 0xe000
  s_nop 0
  buffer_load_dwordx4 v72, s[20:23], s39 offen lds
  buffer_load_dwordx4 v73, s[20:23], s39 offen offset:1024 lds
  v_mfma_f32_32x32x16_bf16 v[144:159], a[132:135], a[192:195], v[144:159]
  ds_read_b64_tr_b16 a[164:165], v49 offset:57344
  ds_read_b64_tr_b16 a[166:167], v49 offset:58368
  buffer_load_dwordx4 v74, s[20:23], s39 offen offset:2048 lds
  buffer_load_dwordx4 v75, s[20:23], s39 offen offset:3072 lds
  v_accvgpr_write_b32 a32, 0
  v_mfma_f32_32x32x16_bf16 v[160:175], a[136:139], a[192:195], v[160:175]
  ds_read_b64_tr_b16 a[168:169], v50 offset:57344
  ds_read_b64_tr_b16 a[170:171], v50 offset:58368
  s_mov_b32 m0, 0xf000
  s_nop 0
  buffer_load_dwordx4 v76, s[20:23], s39 offen lds
  v_mfma_f32_32x32x16_bf16 v[176:191], a[140:143], a[192:195], v[176:191]
  ds_read_b64_tr_b16 a[172:173], v51 offset:57344
  ds_read_b64_tr_b16 a[174:175], v51 offset:58368
  buffer_load_dwordx4 v77, s[20:23], s39 offen offset:1024 lds
  buffer_load_dwordx4 v78, s[20:23], s39 offen offset:2048 lds
  v_accvgpr_write_b32 a33, 0
  v_mfma_f32_32x32x16_bf16 v[128:143], a[144:147], a[196:199], v[128:143]
  ds_read_b64_tr_b16 a[176:177], v48 offset:61440
  ds_read_b64_tr_b16 a[178:179], v48 offset:62464
  buffer_load_dwordx4 v79, s[20:23], s39 offen offset:3072 lds
  s_add_u32 s39, s39, 0x40000
  s_cmp_eq_u32 s39, 4718592
  s_cselect_b32 s39, 0, s39
  s_mov_b32 m0, 0x1e000
  v_mfma_f32_32x32x16_bf16 v[144:159], a[148:151], a[196:199], v[144:159]
  ds_read_b64_tr_b16 a[180:181], v49 offset:61440
  ds_read_b64_tr_b16 a[182:183], v49 offset:62464
  buffer_load_dwordx4 v64, s[16:19], s38 offen lds
  buffer_load_dwordx4 v65, s[16:19], s38 offen offset:1024 lds
  v_accvgpr_write_b32 a34, 0
  v_mfma_f32_32x32x16_bf16 v[160:175], a[152:155], a[196:199], v[160:175]
  ds_read_b64_tr_b16 a[184:185], v50 offset:61440
  ds_read_b64_tr_b16 a[186:187], v50 offset:62464
  buffer_load_dwordx4 v66, s[16:19], s38 offen offset:2048 lds
  buffer_load_dwordx4 v67, s[16:19], s38 offen offset:3072 lds
  s_add_u32 s38, s38, 0x80
  v_mfma_f32_32x32x16_bf16 v[176:191], a[156:159], a[196:199], v[176:191]
  ds_read_b64_tr_b16 a[188:189], v51 offset:61440
  ds_read_b64_tr_b16 a[190:191], v51 offset:62464
  s_cmp_eq_u32 s38, 1152
  s_cselect_b32 s38, 0, s38
  v_lshlrev_b32 v62, 4, v0
  v_add_u32 v62, 0, v62
  buffer_load_dwordx4 v[96:99], v62, s[4:7], 0 offen
  v_lshlrev_b32 v62, 4, v0
  v_add_u32 v62, 0x400, v62
  buffer_load_dwordx4 v[100:103], v62, s[4:7], 0 offen
  v_accvgpr_write_b32 a35, 0
  s_waitcnt lgkmcnt(0)
  s_barrier
  v_mfma_f32_32x32x16_bf16 v[128:143], a[160:163], a[200:203], v[128:143]
  ds_read_b64_tr_b16 a[128:129], v48
  ds_read_b64_tr_b16 a[130:131], v48 offset:1024
  s_mov_b32 m0, 0x16000
  s_nop 0
  buffer_load_dwordx4 v72, s[20:23], s39 offen lds
  v_mfma_f32_32x32x16_bf16 v[144:159], a[164:167], a[200:203], v[144:159]
  ds_read_b64_tr_b16 a[132:133], v49
  ds_read_b64_tr_b16 a[134:135], v49 offset:1024
  buffer_load_dwordx4 v73, s[20:23], s39 offen offset:1024 lds
  v_accvgpr_write_b32 a36, 0
  v_mfma_f32_32x32x16_bf16 v[160:175], a[168:171], a[200:203], v[160:175]
  ds_read_b64_tr_b16 a[136:137], v50
  ds_read_b64_tr_b16 a[138:139], v50 offset:1024
  buffer_load_dwordx4 v74, s[20:23], s39 offen offset:2048 lds
  buffer_load_dwordx4 v75, s[20:23], s39 offen offset:3072 lds
  v_mfma_f32_32x32x16_bf16 v[176:191], a[172:175], a[200:203], v[176:191]
  ds_read_b64_tr_b16 a[140:141], v51
  ds_read_b64_tr_b16 a[142:143], v51 offset:1024
  s_mov_b32 m0, 0x17000
  s_nop 0
  buffer_load_dwordx4 v76, s[20:23], s39 offen lds
  s_waitcnt vmcnt(55)
  ds_read_b128 a[224:227], v40
  v_accvgpr_write_b32 a37, 0
  v_mfma_f32_32x32x16_bf16 v[128:143], a[176:179], a[204:207], v[128:143]
  ds_read_b64_tr_b16 a[144:145], v48 offset:4096
  ds_read_b64_tr_b16 a[146:147], v48 offset:5120
  buffer_load_dwordx4 v77, s[20:23], s39 offen offset:1024 lds
  ds_read_b128 a[228:231], v41
  v_mfma_f32_32x32x16_bf16 v[144:159], a[180:183], a[204:207], v[144:159]
  ds_read_b64_tr_b16 a[148:149], v49 offset:4096
  ds_read_b64_tr_b16 a[150:151], v49 offset:5120
  buffer_load_dwordx4 v78, s[20:23], s39 offen offset:2048 lds
  buffer_load_dwordx4 v79, s[20:23], s39 offen offset:3072 lds
  v_accvgpr_write_b32 a38, 0
  v_mfma_f32_32x32x16_bf16 v[160:175], a[184:187], a[204:207], v[160:175]
  ds_read_b64_tr_b16 a[152:153], v50 offset:4096
  ds_read_b64_tr_b16 a[154:155], v50 offset:5120
  s_add_u32 s39, s39, 0x40000
  s_cmp_eq_u32 s39, 4718592
  s_cselect_b32 s39, 0, s39
  v_lshlrev_b32 v62, 4, v0
  ds_read_b128 a[232:235], v42
  v_mfma_f32_32x32x16_bf16 v[176:191], a[188:191], a[204:207], v[176:191]
  ds_read_b64_tr_b16 a[156:157], v51 offset:4096
  ds_read_b64_tr_b16 a[158:159], v51 offset:5120
  v_add_u32 v62, 0x800, v62
  buffer_load_dwordx4 v[104:107], v62, s[4:7], 0 offen
  v_lshlrev_b32 v62, 4, v0
  v_add_u32 v62, 0xc00, v62
  buffer_load_dwordx4 v[108:111], v62, s[4:7], 0 offen
  ds_read_b128 a[236:239], v43
  v_accvgpr_write_b32 a39, 0
  s_waitcnt lgkmcnt(0)
  s_barrier
  v_mfma_f32_32x32x16_bf16 v[128:143], a[128:131], a[224:227], v[128:143]
  ds_read_b64_tr_b16 a[160:161], v48 offset:32768
  ds_read_b64_tr_b16 a[162:163], v48 offset:33792
  s_mov_b32 m0, 0x26000
  s_nop 0
  buffer_load_dwordx4 v64, s[16:19], s38 offen lds
  v_mfma_f32_32x32x16_bf16 v[144:159], a[132:135], a[224:227], v[144:159]
  ds_read_b64_tr_b16 a[164:165], v49 offset:32768
  ds_read_b64_tr_b16 a[166:167], v49 offset:33792
  buffer_load_dwordx4 v65, s[16:19], s38 offen offset:1024 lds
  buffer_load_dwordx4 v66, s[16:19], s38 offen offset:2048 lds
  v_accvgpr_write_b32 a40, 0
  v_mfma_f32_32x32x16_bf16 v[160:175], a[136:139], a[224:227], v[160:175]
  ds_read_b64_tr_b16 a[168:169], v50 offset:32768
  ds_read_b64_tr_b16 a[170:171], v50 offset:33792
  buffer_load_dwordx4 v67, s[16:19], s38 offen offset:3072 lds
  v_mfma_f32_32x32x16_bf16 v[176:191], a[140:143], a[224:227], v[176:191]
  ds_read_b64_tr_b16 a[172:173], v51 offset:32768
  ds_read_b64_tr_b16 a[174:175], v51 offset:33792
  s_add_u32 s38, s38, 0x80
  s_cmp_eq_u32 s38, 1152
  s_cselect_b32 s38, 0, s38
  s_mov_b32 s36, 0
  s_mov_b32 m0, 0x8000
  v_accvgpr_write_b32 a41, 0
  v_mfma_f32_32x32x16_bf16 v[128:143], a[144:147], a[228:231], v[128:143]
  ds_read_b64_tr_b16 a[176:177], v48 offset:36864
  ds_read_b64_tr_b16 a[178:179], v48 offset:37888
  buffer_load_dwordx4 v56, s[8:11], s36 offen nt lds
  buffer_load_dwordx4 v56, s[8:11], s36 offen offset:1024 nt lds
  buffer_load_dwordx4 v57, s[8:11], s36 offen offset:2048 nt lds
  v_mfma_f32_32x32x16_bf16 v[144:159], a[148:151], a[228:231], v[144:159]
  ds_read_b64_tr_b16 a[180:181], v49 offset:36864
  ds_read_b64_tr_b16 a[182:183], v49 offset:37888
  buffer_load_dwordx4 v57, s[8:11], s36 offen offset:3072 nt lds
  s_mov_b32 m0, 0x9000
  s_nop 0
  buffer_load_dwordx4 v58, s[8:11], s36 offen nt lds
  v_accvgpr_write_b32 a42, 0
  v_mfma_f32_32x32x16_bf16 v[160:175], a[152:155], a[228:231], v[160:175]
  ds_read_b64_tr_b16 a[184:185], v50 offset:36864
  ds_read_b64_tr_b16 a[186:187], v50 offset:37888
  buffer_load_dwordx4 v58, s[8:11], s36 offen offset:1024 nt lds
  buffer_load_dwordx4 v59, s[8:11], s36 offen offset:2048 nt lds
  buffer_load_dwordx4 v59, s[8:11], s36 offen offset:3072 nt lds
  v_mfma_f32_32x32x16_bf16 v[176:191], a[156:159], a[228:231], v[176:191]
  ds_read_b64_tr_b16 a[188:189], v51 offset:36864
  ds_read_b64_tr_b16 a[190:191], v51 offset:37888
  v_lshlrev_b32 v62, 4, v0
  v_add_u32 v62, 0x1000, v62
  buffer_load_dwordx4 v[112:115], v62, s[4:7], 0 offen
  v_lshlrev_b32 v62, 4, v0
  v_add_u32 v62, 0x1400, v62
  buffer_load_dwordx4 v[116:119], v62, s[4:7], 0 offen
  v_accvgpr_write_b32 a43, 0
  s_waitcnt vmcnt(63) lgkmcnt(0)
  s_barrier
  v_mfma_f32_32x32x16_bf16 v[128:143], a[160:163], a[232:235], v[128:143]
  ds_read_b64_tr_b16 a[128:129], v48 offset:8192
  ds_read_b64_tr_b16 a[130:131], v48 offset:9216
  s_mov_b32 s37, 0
  s_mov_b32 m0, 0x10000
  s_nop 0
  buffer_load_dwordx4 v60, s[12:15], s37 offen nt lds
  v_mfma_f32_32x32x16_bf16 v[144:159], a[164:167], a[232:235], v[144:159]
  ds_read_b64_tr_b16 a[132:133], v49 offset:8192
  ds_read_b64_tr_b16 a[134:135], v49 offset:9216
  buffer_load_dwordx4 v60, s[12:15], s37 offen offset:1024 nt lds
  v_accvgpr_write_b32 a44, 0
  v_mfma_f32_32x32x16_bf16 v[160:175], a[168:171], a[232:235], v[160:175]
  ds_read_b64_tr_b16 a[136:137], v50 offset:8192
  ds_read_b64_tr_b16 a[138:139], v50 offset:9216
  buffer_load_dwordx4 v60, s[12:15], s37 offen offset:2048 nt lds
  buffer_load_dwordx4 v60, s[12:15], s37 offen offset:3072 nt lds
  v_mfma_f32_32x32x16_bf16 v[176:191], a[172:175], a[232:235], v[176:191]
  ds_read_b64_tr_b16 a[140:141], v51 offset:8192
  ds_read_b64_tr_b16 a[142:143], v51 offset:9216
  s_mov_b32 m0, 0x11000
  s_nop 0
  buffer_load_dwordx4 v61, s[12:15], s37 offen nt lds
  s_waitcnt vmcnt(51)
  ds_read_b128 a[192:195], v32
  v_accvgpr_write_b32 a45, 0
  v_mfma_f32_32x32x16_bf16 v[128:143], a[176:179], a[236:239], v[128:143]
  ds_read_b64_tr_b16 a[144:145], v48 offset:12288
  ds_read_b64_tr_b16 a[146:147], v48 offset:13312
  buffer_load_dwordx4 v61, s[12:15], s37 offen offset:1024 nt lds
  ds_read_b128 a[196:199], v33
  v_mfma_f32_32x32x16_bf16 v[144:159], a[180:183], a[236:239], v[144:159]
  ds_read_b64_tr_b16 a[148:149], v49 offset:12288
  ds_read_b64_tr_b16 a[150:151], v49 offset:13312
  buffer_load_dwordx4 v61, s[12:15], s37 offen offset:2048 nt lds
  buffer_load_dwordx4 v61, s[12:15], s37 offen offset:3072 nt lds
  v_accvgpr_write_b32 a46, 0
  v_mfma_f32_32x32x16_bf16 v[160:175], a[184:187], a[236:239], v[160:175]
  ds_read_b64_tr_b16 a[152:153], v50 offset:12288
  ds_read_b64_tr_b16 a[154:155], v50 offset:13312
  v_lshlrev_b32 v62, 4, v0
  v_add_u32 v62, 0x1800, v62
  buffer_load_dwordx4 v[120:123], v62, s[4:7], 0 offen
  ds_read_b128 a[200:203], v34
  v_mfma_f32_32x32x16_bf16 v[176:191], a[188:191], a[236:239], v[176:191]
  ds_read_b64_tr_b16 a[156:157], v51 offset:12288
  ds_read_b64_tr_b16 a[158:159], v51 offset:13312
  v_lshlrev_b32 v62, 4, v0
  v_add_u32 v62, 0x1c00, v62
  buffer_load_dwordx4 v[124:127], v62, s[4:7], 0 offen
  ds_read_b128 a[204:207], v35
  v_accvgpr_write_b32 a47, 0
  s_waitcnt lgkmcnt(0)
  s_barrier
  v_mfma_f32_32x32x16_bf16 v[128:143], a[128:131], a[192:195], v[128:143]
  ds_read_b64_tr_b16 a[160:161], v48 offset:40960
  ds_read_b64_tr_b16 a[162:163], v48 offset:41984
  s_mov_b32 s36, 0x2000
  s_mov_b32 m0, 0xa000
  s_nop 0
  buffer_load_dwordx4 v56, s[8:11], s36 offen nt lds
  v_mfma_f32_32x32x16_bf16 v[144:159], a[132:135], a[192:195], v[144:159]
  ds_read_b64_tr_b16 a[164:165], v49 offset:40960
  ds_read_b64_tr_b16 a[166:167], v49 offset:41984
  buffer_load_dwordx4 v56, s[8:11], s36 offen offset:1024 nt lds
  v_accvgpr_write_b32 a48, 0
  v_mfma_f32_32x32x16_bf16 v[160:175], a[136:139], a[192:195], v[160:175]
  ds_read_b64_tr_b16 a[168:169], v50 offset:40960
  ds_read_b64_tr_b16 a[170:171], v50 offset:41984
  buffer_load_dwordx4 v57, s[8:11], s36 offen offset:2048 nt lds
  buffer_load_dwordx4 v57, s[8:11], s36 offen offset:3072 nt lds
  v_mfma_f32_32x32x16_bf16 v[176:191], a[140:143], a[192:195], v[176:191]
  ds_read_b64_tr_b16 a[172:173], v51 offset:40960
  ds_read_b64_tr_b16 a[174:175], v51 offset:41984
  s_mov_b32 m0, 0xb000
  s_nop 0
  buffer_load_dwordx4 v58, s[8:11], s36 offen nt lds
  v_accvgpr_write_b32 a49, 0
  v_mfma_f32_32x32x16_bf16 v[128:143], a[144:147], a[196:199], v[128:143]
  ds_read_b64_tr_b16 a[176:177], v48 offset:45056
  ds_read_b64_tr_b16 a[178:179], v48 offset:46080
  buffer_load_dwordx4 v58, s[8:11], s36 offen offset:1024 nt lds
  v_mfma_f32_32x32x16_bf16 v[144:159], a[148:151], a[196:199], v[144:159]
  ds_read_b64_tr_b16 a[180:181], v49 offset:45056
  ds_read_b64_tr_b16 a[182:183], v49 offset:46080
  buffer_load_dwordx4 v59, s[8:11], s36 offen offset:2048 nt lds
  buffer_load_dwordx4 v59, s[8:11], s36 offen offset:3072 nt lds
  v_accvgpr_write_b32 a50, 0
  v_mfma_f32_32x32x16_bf16 v[160:175], a[152:155], a[196:199], v[160:175]
  ds_read_b64_tr_b16 a[184:185], v50 offset:45056
  ds_read_b64_tr_b16 a[186:187], v50 offset:46080
  v_lshlrev_b32 v62, 4, v0
  v_add_u32 v62, 0x2000, v62
  s_waitcnt vmcnt(43)
  buffer_load_dwordx4 v[96:99], v62, s[4:7], 0 offen
  v_mfma_f32_32x32x16_bf16 v[176:191], a[156:159], a[196:199], v[176:191]
  ds_read_b64_tr_b16 a[188:189], v51 offset:45056
  ds_read_b64_tr_b16 a[190:191], v51 offset:46080
  v_lshlrev_b32 v62, 4, v0
  v_add_u32 v62, 0x2400, v62
  s_waitcnt vmcnt(43)
  buffer_load_dwordx4 v[100:103], v62, s[4:7], 0 offen
  v_accvgpr_write_b32 a51, 0
  s_waitcnt lgkmcnt(0)
  s_barrier
  v_mfma_f32_32x32x16_bf16 v[128:143], a[160:163], a[200:203], v[128:143]
  ds_read_b64_tr_b16 a[128:129], v48 offset:16384
  ds_read_b64_tr_b16 a[130:131], v48 offset:17408
  s_mov_b32 s37, 0x2000
  s_mov_b32 m0, 0x18000
  s_nop 0
  buffer_load_dwordx4 v60, s[12:15], s37 offen nt lds
  v_mfma_f32_32x32x16_bf16 v[144:159], a[164:167], a[200:203], v[144:159]
  ds_read_b64_tr_b16 a[132:133], v49 offset:16384
  ds_read_b64_tr_b16 a[134:135], v49 offset:17408
  buffer_load_dwordx4 v60, s[12:15], s37 offen offset:1024 nt lds
  v_accvgpr_write_b32 a52, 0
  v_mfma_f32_32x32x16_bf16 v[160:175], a[168:171], a[200:203], v[160:175]
  ds_read_b64_tr_b16 a[136:137], v50 offset:16384
  ds_read_b64_tr_b16 a[138:139], v50 offset:17408
  buffer_load_dwordx4 v60, s[12:15], s37 offen offset:2048 nt lds
  buffer_load_dwordx4 v60, s[12:15], s37 offen offset:3072 nt lds
  v_mfma_f32_32x32x16_bf16 v[176:191], a[172:175], a[200:203], v[176:191]
  ds_read_b64_tr_b16 a[140:141], v51 offset:16384
  ds_read_b64_tr_b16 a[142:143], v51 offset:17408
  s_mov_b32 m0, 0x19000
  s_nop 0
  buffer_load_dwordx4 v61, s[12:15], s37 offen nt lds
  ds_read_b128 a[224:227], v36
  v_accvgpr_write_b32 a53, 0
  v_mfma_f32_32x32x16_bf16 v[128:143], a[176:179], a[204:207], v[128:143]
  ds_read_b64_tr_b16 a[144:145], v48 offset:20480
  ds_read_b64_tr_b16 a[146:147], v48 offset:21504
  buffer_load_dwordx4 v61, s[12:15], s37 offen offset:1024 nt lds
  ds_read_b128 a[228:231], v37
  v_mfma_f32_32x32x16_bf16 v[144:159], a[180:183], a[204:207], v[144:159]
  ds_read_b64_tr_b16 a[148:149], v49 offset:20480
  ds_read_b64_tr_b16 a[150:151], v49 offset:21504
  buffer_load_dwordx4 v61, s[12:15], s37 offen offset:2048 nt lds
  buffer_load_dwordx4 v61, s[12:15], s37 offen offset:3072 nt lds
  v_accvgpr_write_b32 a54, 0
  v_mfma_f32_32x32x16_bf16 v[160:175], a[184:187], a[204:207], v[160:175]
  ds_read_b64_tr_b16 a[152:153], v50 offset:20480
  ds_read_b64_tr_b16 a[154:155], v50 offset:21504
  v_lshlrev_b32 v62, 4, v0
  v_add_u32 v62, 0x2800, v62
  s_waitcnt vmcnt(43)
  buffer_load_dwordx4 v[104:107], v62, s[4:7], 0 offen
  ds_read_b128 a[232:235], v38
  v_mfma_f32_32x32x16_bf16 v[176:191], a[188:191], a[204:207], v[176:191]
  ds_read_b64_tr_b16 a[156:157], v51 offset:20480
  ds_read_b64_tr_b16 a[158:159], v51 offset:21504
  v_lshlrev_b32 v62, 4, v0
  v_add_u32 v62, 0x2c00, v62
  s_waitcnt vmcnt(43)
  buffer_load_dwordx4 v[108:111], v62, s[4:7], 0 offen
  ds_read_b128 a[236:239], v39
  v_accvgpr_write_b32 a55, 0
  s_waitcnt lgkmcnt(0)
  s_barrier
  v_mfma_f32_32x32x16_bf16 v[128:143], a[128:131], a[224:227], v[128:143]
  ds_read_b64_tr_b16 a[160:161], v48 offset:49152
  ds_read_b64_tr_b16 a[162:163], v48 offset:50176
  s_mov_b32 s36, 0x4000
  s_mov_b32 m0, 0
  s_nop 0
  buffer_load_dwordx4 v56, s[8:11], s36 offen nt lds
  v_mfma_f32_32x32x16_bf16 v[144:159], a[132:135], a[224:227], v[144:159]
  ds_read_b64_tr_b16 a[164:165], v49 offset:49152
  ds_read_b64_tr_b16 a[166:167], v49 offset:50176
  buffer_load_dwordx4 v56, s[8:11], s36 offen offset:1024 nt lds
  v_accvgpr_write_b32 a56, 0
  v_mfma_f32_32x32x16_bf16 v[160:175], a[136:139], a[224:227], v[160:175]
  ds_read_b64_tr_b16 a[168:169], v50 offset:49152
  ds_read_b64_tr_b16 a[170:171], v50 offset:50176
  buffer_load_dwordx4 v57, s[8:11], s36 offen offset:2048 nt lds
  buffer_load_dwordx4 v57, s[8:11], s36 offen offset:3072 nt lds
  v_mfma_f32_32x32x16_bf16 v[176:191], a[140:143], a[224:227], v[176:191]
  ds_read_b64_tr_b16 a[172:173], v51 offset:49152
  ds_read_b64_tr_b16 a[174:175], v51 offset:50176
  s_mov_b32 m0, 0x1000
  s_nop 0
  buffer_load_dwordx4 v58, s[8:11], s36 offen nt lds
  v_accvgpr_write_b32 a57, 0
  v_mfma_f32_32x32x16_bf16 v[128:143], a[144:147], a[228:231], v[128:143]
  ds_read_b64_tr_b16 a[176:177], v48 offset:53248
  ds_read_b64_tr_b16 a[178:179], v48 offset:54272
  buffer_load_dwordx4 v58, s[8:11], s36 offen offset:1024 nt lds
  v_mfma_f32_32x32x16_bf16 v[144:159], a[148:151], a[228:231], v[144:159]
  ds_read_b64_tr_b16 a[180:181], v49 offset:53248
  ds_read_b64_tr_b16 a[182:183], v49 offset:54272
  buffer_load_dwordx4 v59, s[8:11], s36 offen offset:2048 nt lds
  buffer_load_dwordx4 v59, s[8:11], s36 offen offset:3072 nt lds
  v_accvgpr_write_b32 a58, 0
  v_mfma_f32_32x32x16_bf16 v[160:175], a[152:155], a[228:231], v[160:175]
  ds_read_b64_tr_b16 a[184:185], v50 offset:53248
  ds_read_b64_tr_b16 a[186:187], v50 offset:54272
  v_lshlrev_b32 v62, 4, v0
  v_add_u32 v62, 0x3000, v62
  s_waitcnt vmcnt(39)
  buffer_load_dwordx4 v[112:115], v62, s[4:7], 0 offen
  v_mfma_f32_32x32x16_bf16 v[176:191], a[156:159], a[228:231], v[176:191]
  ds_read_b64_tr_b16 a[188:189], v51 offset:53248
  ds_read_b64_tr_b16 a[190:191], v51 offset:54272
  v_lshlrev_b32 v62, 4, v0
  v_add_u32 v62, 0x3400, v62
  s_waitcnt vmcnt(39)
  buffer_load_dwordx4 v[116:119], v62, s[4:7], 0 offen
  v_accvgpr_write_b32 a59, 0
  s_waitcnt lgkmcnt(0)
  s_barrier
  v_mfma_f32_32x32x16_bf16 v[128:143], a[160:163], a[232:235], v[128:143]
  ds_read_b64_tr_b16 a[128:129], v48 offset:24576
  ds_read_b64_tr_b16 a[130:131], v48 offset:25600
  s_mov_b32 s37, 0x4000
  s_mov_b32 m0, 0x1a000
  s_nop 0
  buffer_load_dwordx4 v60, s[12:15], s37 offen nt lds
  v_mfma_f32_32x32x16_bf16 v[144:159], a[164:167], a[232:235], v[144:159]
  ds_read_b64_tr_b16 a[132:133], v49 offset:24576
  ds_read_b64_tr_b16 a[134:135], v49 offset:25600
  buffer_load_dwordx4 v60, s[12:15], s37 offen offset:1024 nt lds
  v_accvgpr_write_b32 a60, 0
  v_mfma_f32_32x32x16_bf16 v[160:175], a[168:171], a[232:235], v[160:175]
  ds_read_b64_tr_b16 a[136:137], v50 offset:24576
  ds_read_b64_tr_b16 a[138:139], v50 offset:25600
  buffer_load_dwordx4 v60, s[12:15], s37 offen offset:2048 nt lds
  buffer_load_dwordx4 v60, s[12:15], s37 offen offset:3072 nt lds
  v_mfma_f32_32x32x16_bf16 v[176:191], a[172:175], a[232:235], v[176:191]
  ds_read_b64_tr_b16 a[140:141], v51 offset:24576
  ds_read_b64_tr_b16 a[142:143], v51 offset:25600
  s_mov_b32 m0, 0x1b000
  s_nop 0
  buffer_load_dwordx4 v61, s[12:15], s37 offen nt lds
  ds_read_b128 a[192:195], v40
  v_accvgpr_write_b32 a61, 0
  v_mfma_f32_32x32x16_bf16 v[128:143], a[176:179], a[236:239], v[128:143]
  ds_read_b64_tr_b16 a[144:145], v48 offset:28672
  ds_read_b64_tr_b16 a[146:147], v48 offset:29696
  buffer_load_dwordx4 v61, s[12:15], s37 offen offset:1024 nt lds
  ds_read_b128 a[196:199], v41
  v_mfma_f32_32x32x16_bf16 v[144:159], a[180:183], a[236:239], v[144:159]
  ds_read_b64_tr_b16 a[148:149], v49 offset:28672
  ds_read_b64_tr_b16 a[150:151], v49 offset:29696
  buffer_load_dwordx4 v61, s[12:15], s37 offen offset:2048 nt lds
  buffer_load_dwordx4 v61, s[12:15], s37 offen offset:3072 nt lds
  v_accvgpr_write_b32 a62, 0
  v_mfma_f32_32x32x16_bf16 v[160:175], a[184:187], a[236:239], v[160:175]
  ds_read_b64_tr_b16 a[152:153], v50 offset:28672
  ds_read_b64_tr_b16 a[154:155], v50 offset:29696
  v_lshlrev_b32 v62, 4, v0
  v_add_u32 v62, 0x3800, v62
  s_waitcnt vmcnt(39)
  buffer_load_dwordx4 v[120:123], v62, s[4:7], 0 offen
  ds_read_b128 a[200:203], v42
  v_mfma_f32_32x32x16_bf16 v[176:191], a[188:191], a[236:239], v[176:191]
  ds_read_b64_tr_b16 a[156:157], v51 offset:28672
  ds_read_b64_tr_b16 a[158:159], v51 offset:29696
  v_lshlrev_b32 v62, 4, v0
  v_add_u32 v62, 0x3c00, v62
  s_waitcnt vmcnt(39)
  buffer_load_dwordx4 v[124:127], v62, s[4:7], 0 offen
  ds_read_b128 a[204:207], v43
  v_accvgpr_write_b32 a63, 0
  s_waitcnt lgkmcnt(0)
  s_barrier
  v_mfma_f32_32x32x16_bf16 v[128:143], a[128:131], a[192:195], v[128:143]
  ds_read_b64_tr_b16 a[160:161], v48 offset:57344
  ds_read_b64_tr_b16 a[162:163], v48 offset:58368
  s_mov_b32 s36, 0x6000
  s_mov_b32 m0, 0x2000
  s_nop 0
  buffer_load_dwordx4 v56, s[8:11], s36 offen nt lds
  v_mfma_f32_32x32x16_bf16 v[144:159], a[132:135], a[192:195], v[144:159]
  ds_read_b64_tr_b16 a[164:165], v49 offset:57344
  ds_read_b64_tr_b16 a[166:167], v49 offset:58368
  buffer_load_dwordx4 v56, s[8:11], s36 offen offset:1024 nt lds
  v_mfma_f32_32x32x16_bf16 v[160:175], a[136:139], a[192:195], v[160:175]
  ds_read_b64_tr_b16 a[168:169], v50 offset:57344
  ds_read_b64_tr_b16 a[170:171], v50 offset:58368
  buffer_load_dwordx4 v57, s[8:11], s36 offen offset:2048 nt lds
  buffer_load_dwordx4 v57, s[8:11], s36 offen offset:3072 nt lds
  v_mfma_f32_32x32x16_bf16 v[176:191], a[140:143], a[192:195], v[176:191]
  ds_read_b64_tr_b16 a[172:173], v51 offset:57344
  ds_read_b64_tr_b16 a[174:175], v51 offset:58368
  s_mov_b32 m0, 0x3000
  s_nop 0
  buffer_load_dwordx4 v58, s[8:11], s36 offen nt lds
  v_mfma_f32_32x32x16_bf16 v[128:143], a[144:147], a[196:199], v[128:143]
  ds_read_b64_tr_b16 a[176:177], v48 offset:61440
  ds_read_b64_tr_b16 a[178:179], v48 offset:62464
  buffer_load_dwordx4 v58, s[8:11], s36 offen offset:1024 nt lds
  v_mfma_f32_32x32x16_bf16 v[144:159], a[148:151], a[196:199], v[144:159]
  ds_read_b64_tr_b16 a[180:181], v49 offset:61440
  ds_read_b64_tr_b16 a[182:183], v49 offset:62464
  buffer_load_dwordx4 v59, s[8:11], s36 offen offset:2048 nt lds
  buffer_load_dwordx4 v59, s[8:11], s36 offen offset:3072 nt lds
  v_mfma_f32_32x32x16_bf16 v[160:175], a[152:155], a[196:199], v[160:175]
  ds_read_b64_tr_b16 a[184:185], v50 offset:61440
  ds_read_b64_tr_b16 a[186:187], v50 offset:62464
  v_lshlrev_b32 v62, 4, v0
  v_add_u32 v62, 0x4000, v62
  s_waitcnt vmcnt(39)
  buffer_load_dwordx4 v[96:99], v62, s[4:7], 0 offen
  v_mfma_f32_32x32x16_bf16 v[176:191], a[156:159], a[196:199], v[176:191]
  ds_read_b64_tr_b16 a[188:189], v51 offset:61440
  ds_read_b64_tr_b16 a[190:191], v51 offset:62464
  v_lshlrev_b32 v62, 4, v0
  v_add_u32 v62, 0x4400, v62
  s_waitcnt vmcnt(39)
  buffer_load_dwordx4 v[100:103], v62, s[4:7], 0 offen
  s_waitcnt lgkmcnt(0)
  s_barrier
  v_mfma_f32_32x32x16_bf16 v[128:143], a[160:163], a[200:203], v[128:143]
  ds_read_b128 a[128:131], v2 offset:32768
  ds_read_b128 a[132:135], v3 offset:32768
  s_mov_b32 s37, 0x6000
  s_mov_b32 m0, 0x12000
  s_nop 0
  buffer_load_dwordx4 v60, s[12:15], s37 offen nt lds
  v_mfma_f32_32x32x16_bf16 v[144:159], a[164:167], a[200:203], v[144:159]
  ds_read_b128 a[136:139], v4 offset:32768
  ds_read_b128 a[140:143], v5 offset:32768
  buffer_load_dwordx4 v60, s[12:15], s37 offen offset:1024 nt lds
  buffer_load_dwordx4 v60, s[12:15], s37 offen offset:2048 nt lds
  buffer_load_dwordx4 v60, s[12:15], s37 offen offset:3072 nt lds
  v_mfma_f32_32x32x16_bf16 v[160:175], a[168:171], a[200:203], v[160:175]
  ds_read_b128 a[144:147], v6 offset:32768
  ds_read_b128 a[148:151], v7 offset:32768
  s_mov_b32 m0, 0x13000
  s_nop 0
  buffer_load_dwordx4 v61, s[12:15], s37 offen nt lds
  s_branch PADO_8
PADA_8:
  s_branch HOPRET_g2
PAD_8:
  s_sub_u32 s40, s40, 1
  s_cbranch_scc1 HOPRET_gb
  s_branch PAD_4
PADO_8:
  buffer_load_dwordx4 v61, s[12:15], s37 offen offset:1024 nt lds
  v_mfma_f32_32x32x16_bf16 v[176:191], a[172:175], a[200:203], v[176:191]
  ds_read_b128 a[152:155], v8 offset:32768
  ds_read_b128 a[156:159], v9 offset:32768
  buffer_load_dwordx4 v61, s[12:15], s37 offen offset:2048 nt lds
  buffer_load_dwordx4 v61, s[12:15], s37 offen offset:3072 nt lds
  v_mfma_f32_32x32x16_bf16 v[128:143], a[176:179], a[204:207], v[128:143]
  s_mov_b32 s36, 0x8000
  s_mov_b32 m0, 0xc000
  s_nop 0
  buffer_load_dwordx4 v56, s[8:11], s36 offen nt lds
  v_mfma_f32_32x32x16_bf16 v[144:159], a[180:183], a[204:207], v[144:159]
  buffer_load_dwordx4 v56, s[8:11], s36 offen offset:1024 nt lds
  buffer_load_dwordx4 v57, s[8:11], s36 offen offset:2048 nt lds
  buffer_load_dwordx4 v57, s[8:11], s36 offen offset:3072 nt lds
  v_mfma_f32_32x32x16_bf16 v[160:175], a[184:187], a[204:207], v[160:175]
  s_mov_b32 m0, 0xd000
  s_nop 0
  buffer_load_dwordx4 v58, s[8:11], s36 offen nt lds
  buffer_load_dwordx4 v58, s[8:11], s36 offen offset:1024 nt lds
  v_mfma_f32_32x32x16_bf16 v[176:191], a[188:191], a[204:207], v[176:191]
  buffer_load_dwordx4 v59, s[8:11], s36 offen offset:2048 nt lds
  buffer_load_dwordx4 v59, s[8:11], s36 offen offset:3072 nt lds
  v_pk_mul_f32 v[128:129], v[128:129], s[42:43] op_sel:[0,1] op_sel_hi:[1,1]
  v_pk_mul_f32 v[130:131], v[130:131], s[42:43] op_sel:[0,1] op_sel_hi:[1,1]
  v_pk_mul_f32 v[132:133], v[132:133], s[42:43] op_sel:[0,1] op_sel_hi:[1,1]
  v_pk_mul_f32 v[134:135], v[134:135], s[42:43] op_sel:[0,1] op_sel_hi:[1,1]
  v_cvt_pk_bf16_f32 v64, v128, v129
  v_cvt_pk_bf16_f32 v65, v130, v131
  v_cvt_pk_bf16_f32 v66, v132, v133
  v_cvt_pk_bf16_f32 v67, v134, v135
  v_pk_mul_f32 v[136:137], v[136:137], s[42:43] op_sel:[0,1] op_sel_hi:[1,1]
  v_pk_mul_f32 v[138:139], v[138:139], s[42:43] op_sel:[0,1] op_sel_hi:[1,1]
  v_pk_mul_f32 v[140:141], v[140:141], s[42:43] op_sel:[0,1] op_sel_hi:[1,1]
  v_pk_mul_f32 v[142:143], v[142:143], s[42:43] op_sel:[0,1] op_sel_hi:[1,1]
  v_cvt_pk_bf16_f32 v68, v136, v137
  v_cvt_pk_bf16_f32 v69, v138, v139
  v_cvt_pk_bf16_f32 v70, v140, v141
  v_cvt_pk_bf16_f32 v71, v142, v143
  v_pk_mul_f32 v[144:145], v[144:145], s[42:43] op_sel:[0,1] op_sel_hi:[1,1]
  v_pk_mul_f32 v[146:147], v[146:147], s[42:43] op_sel:[0,1] op_sel_hi:[1,1]
  v_pk_mul_f32 v[148:149], v[148:149], s[42:43] op_sel:[0,1] op_sel_hi:[1,1]
  v_pk_mul_f32 v[150:151], v[150:151], s[42:43] op_sel:[0,1] op_sel_hi:[1,1]
  v_cvt_pk_bf16_f32 v72, v144, v145
  v_cvt_pk_bf16_f32 v73, v146, v147
  v_cvt_pk_bf16_f32 v74, v148, v149
  v_cvt_pk_bf16_f32 v75, v150, v151
  v_pk_mul_f32 v[152:153], v[152:153], s[42:43] op_sel:[0,1] op_sel_hi:[1,1]
  v_pk_mul_f32 v[154:155], v[154:155], s[42:43] op_sel:[0,1] op_sel_hi:[1,1]
  v_pk_mul_f32 v[156:157], v[156:157], s[42:43] op_sel:[0,1] op_sel_hi:[1,1]
  v_pk_mul_f32 v[158:159], v[158:159], s[42:43] op_sel:[0,1] op_sel_hi:[1,1]
  v_cvt_pk_bf16_f32 v76, v152, v153
  v_cvt_pk_bf16_f32 v77, v154, v155
  v_cvt_pk_bf16_f32 v78, v156, v157
  v_cvt_pk_bf16_f32 v79, v158, v159
  v_pk_mul_f32 v[160:161], v[160:161], s[42:43] op_sel:[0,1] op_sel_hi:[1,1]
  v_pk_mul_f32 v[162:163], v[162:163], s[42:43] op_sel:[0,1] op_sel_hi:[1,1]
  v_pk_mul_f32 v[164:165], v[164:165], s[42:43] op_sel:[0,1] op_sel_hi:[1,1]
  v_pk_mul_f32 v[166:167], v[166:167], s[42:43] op_sel:[0,1] op_sel_hi:[1,1]
  v_cvt_pk_bf16_f32 v80, v160, v161
  v_cvt_pk_bf16_f32 v81, v162, v163
  v_cvt_pk_bf16_f32 v82, v164, v165
  v_cvt_pk_bf16_f32 v83, v166, v167
  v_pk_mul_f32 v[168:169], v[168:169], s[42:43] op_sel:[0,1] op_sel_hi:[1,1]
  v_pk_mul_f32 v[170:171], v[170:171], s[42:43] op_sel:[0,1] op_sel_hi:[1,1]
  v_pk_mul_f32 v[172:173], v[172:173], s[42:43] op_sel:[0,1] op_sel_hi:[1,1]
  v_pk_mul_f32 v[174:175], v[174:175], s[42:43] op_sel:[0,1] op_sel_hi:[1,1]
  v_cvt_pk_bf16_f32 v84, v168, v169
  v_cvt_pk_bf16_f32 v85, v170, v171
  v_cvt_pk_bf16_f32 v86, v172, v173
  v_cvt_pk_bf16_f32 v87, v174, v175
  v_pk_mul_f32 v[176:177], v[176:177], s[42:43] op_sel:[0,1] op_sel_hi:[1,1]
  v_pk_mul_f32 v[178:179], v[178:179], s[42:43] op_sel:[0,1] op_sel_hi:[1,1]
  v_pk_mul_f32 v[180:181], v[180:181], s[42:43] op_sel:[0,1] op_sel_hi:[1,1]
  v_pk_mul_f32 v[182:183], v[182:183], s[42:43] op_sel:[0,1] op_sel_hi:[1,1]
  v_cvt_pk_bf16_f32 v88, v176, v177
  v_cvt_pk_bf16_f32 v89, v178, v179
  v_cvt_pk_bf16_f32 v90, v180, v181
  v_cvt_pk_bf16_f32 v91, v182, v183
  v_pk_mul_f32 v[184:185], v[184:185], s[42:43] op_sel:[0,1] op_sel_hi:[1,1]
  v_pk_mul_f32 v[186:187], v[186:187], s[42:43] op_sel:[0,1] op_sel_hi:[1,1]
  v_pk_mul_f32 v[188:189], v[188:189], s[42:43] op_sel:[0,1] op_sel_hi:[1,1]
  v_pk_mul_f32 v[190:191], v[190:191], s[42:43] op_sel:[0,1] op_sel_hi:[1,1]
  v_cvt_pk_bf16_f32 v92, v184, v185
  v_cvt_pk_bf16_f32 v93, v186, v187
  v_cvt_pk_bf16_f32 v94, v188, v189
  v_cvt_pk_bf16_f32 v95, v190, v191
  s_waitcnt lgkmcnt(7)
  v_mfma_f32_32x32x16_bf16 v[128:143], a[128:131], v[64:67], 0
  s_waitcnt lgkmcnt(6)
  v_mfma_f32_32x32x16_bf16 v[128:143], a[132:135], v[68:71], v[128:143]
  s_waitcnt lgkmcnt(5)
  v_mfma_f32_32x32x16_bf16 v[128:143], a[136:139], v[72:75], v[128:143]
  s_waitcnt lgkmcnt(4)
  v_mfma_f32_32x32x16_bf16 v[128:143], a[140:143], v[76:79], v[128:143]
  s_waitcnt lgkmcnt(3)
  v_mfma_f32_32x32x16_bf16 v[128:143], a[144:147], v[80:83], v[128:143]
  s_waitcnt lgkmcnt(2)
  v_mfma_f32_32x32x16_bf16 v[128:143], a[148:151], v[84:87], v[128:143]
  s_waitcnt lgkmcnt(1)
  v_mfma_f32_32x32x16_bf16 v[128:143], a[152:155], v[88:91], v[128:143]
  s_waitcnt lgkmcnt(0)
  v_mfma_f32_32x32x16_bf16 v[128:143], a[156:159], v[92:95], v[128:143]
  ds_read_b64_tr_b16 a[160:161], v10
  ds_read_b64_tr_b16 a[162:163], v10 offset:2048
  ds_read_b64_tr_b16 a[164:165], v11
  ds_read_b64_tr_b16 a[166:167], v11 offset:2048
  ds_read_b64_tr_b16 a[168:169], v12
  ds_read_b64_tr_b16 a[170:171], v12 offset:2048
  ds_read_b64_tr_b16 a[172:173], v13
  ds_read_b64_tr_b16 a[174:175], v13 offset:2048
  ds_read_b64_tr_b16 a[176:177], v10 offset:4096
  ds_read_b64_tr_b16 a[178:179], v10 offset:6144
  ds_read_b64_tr_b16 a[180:181], v11 offset:4096
  ds_read_b64_tr_b16 a[182:183], v11 offset:6144
  ds_read_b64_tr_b16 a[184:185], v12 offset:4096
  ds_read_b64_tr_b16 a[186:187], v12 offset:6144
  ds_read_b64_tr_b16 a[188:189], v13 offset:4096
  ds_read_b64_tr_b16 a[190:191], v13 offset:6144
  v_max3_f32 v28, v128, v129, v130
  v_max3_f32 v28, v28, v131, v132
  v_max3_f32 v28, v28, v133, v134
  v_max3_f32 v28, v28, v135, v136
  v_max3_f32 v28, v28, v137, v138
  v_max3_f32 v28, v28, v139, v140
  v_max3_f32 v28, v28, v141, v142
  v_max_f32 v28, v28, v143
  v_mov_b32 v29, v28
  s_nop 1
  v_permlane32_swap_b32 v28, v29
  v_max_f32 v28, v28, v29
  v_sub_f32 v160, 0, v28
  v_mov_b32 v161, v160
  v_mov_b32 v162, v160
  v_mov_b32 v163, v160
  v_mov_b32 v164, v160
  v_mov_b32 v165, v160
  v_mov_b32 v166, v160
  v_mov_b32 v167, v160
  v_mov_b32 v168, v160
  v_mov_b32 v169, v160
  v_mov_b32 v170, v160
  v_mov_b32 v171, v160
  v_mov_b32 v172, v160
  v_mov_b32 v173, v160
  v_mov_b32 v174, v160
  v_mov_b32 v175, v160
  v_sub_f32 v128, v128, v28
  v_sub_f32 v129, v129, v28
  v_sub_f32 v130, v130, v28
  v_sub_f32 v131, v131, v28
  v_sub_f32 v132, v132, v28
  v_sub_f32 v133, v133, v28
  v_sub_f32 v134, v134, v28
  v_sub_f32 v135, v135, v28
  v_sub_f32 v136, v136, v28
  v_sub_f32 v137, v137, v28
  v_sub_f32 v138, v138, v28
  v_sub_f32 v139, v139, v28
  v_sub_f32 v140, v140, v28
  v_sub_f32 v141, v141, v28
  v_sub_f32 v142, v142, v28
  v_sub_f32 v143, v143, v28
  v_exp_f32 v16, v128
  v_exp_f32 v17, v129
  v_exp_f32 v18, v130
  v_add_f32 v24, v16, v17
  v_cvt_pk_bf16_f32 v32, v16, v17
  v_exp_f32 v19, v131
  v_add_f32 v24, v24, v18
  v_exp_f32 v20, v132
  v_add_f32 v24, v24, v19
  v_cvt_pk_bf16_f32 v33, v18, v19
  v_exp_f32 v21, v133
  v_add_f32 v24, v24, v20
  v_exp_f32 v22, v134
  v_add_f32 v24, v24, v21
  v_cvt_pk_bf16_f32 v34, v20, v21
  v_exp_f32 v23, v135
  v_add_f32 v24, v24, v22
  v_exp_f32 v16, v136
  v_add_f32 v24, v24, v23
  v_cvt_pk_bf16_f32 v35, v22, v23
  v_exp_f32 v17, v137
  v_add_f32 v24, v24, v16
  v_exp_f32 v18, v138
  v_add_f32 v24, v24, v17
  v_cvt_pk_bf16_f32 v36, v16, v17
  v_exp_f32 v19, v139
  v_add_f32 v24, v24, v18
  v_exp_f32 v20, v140
  v_add_f32 v24, v24, v19
  v_cvt_pk_bf16_f32 v37, v18, v19
  v_exp_f32 v21, v141
  v_add_f32 v24, v24, v20
  v_exp_f32 v22, v142
  v_add_f32 v24, v24, v21
  v_cvt_pk_bf16_f32 v38, v20, v21
  v_exp_f32 v23, v143
  v_add_f32 v24, v24, v22
  v_add_f32 v24, v24, v23
  v_cvt_pk_bf16_f32 v39, v22, v23
  v_mov_b32 v26, v24
  s_mov_b32 s37, 0x8000
  s_mov_b32 s36, 0xa000
  v_lshrrev_b32 v52, 3, v0
  v_mul_u32_u24 v52, 0x480, v52
  v_and_b32 v53, 7, v0
  v_bfe_u32 v54, v0, 4, 1
  v_lshlrev_b32 v54, 2, v54
  v_xor_b32 v53, v53, v54
  v_lshl_add_u32 v48, v53, 4, v52
  v_add_u32 v49, 0x2000, v48
  v_and_b32 v52, 1, v0
  v_lshlrev_b32 v52, 1, v52
  v_bfe_u32 v53, v0, 1, 1
  v_or_b32 v52, v52, v53
  v_lshlrev_b32 v52, 3, v52
  v_bfe_u32 v53, v0, 4, 1
  v_lshl_or_b32 v52, v53, 5, v52
  v_bfe_u32 v53, v0, 2, 2
  v_lshrrev_b32 v54, 5, v0
  v_lshl_add_u32 v54, v54, 3, v53
  v_lshl_add_u32 v52, v54, 7, v52
  v_lshrrev_b32 v53, 1, v53
  v_mov_b32 v54, s28
  v_and_b32 v54, 1, v54
  v_xor_b32 v53, v53, v54
  v_lshl_add_u32 v50, v53, 6, v52
  v_xor_b32 v53, 1, v53
  v_lshl_add_u32 v51, v53, 6, v52
  v_add_u32 v52, s60, v50
  v_add_u32 v53, s60, v51
  s_mov_b32 m0, 0x20000
  s_mov_b32 s66, 0
  buffer_load_dwordx4 v48, s[48:51], s66 offen lds
  buffer_load_dwordx4 v49, s[48:51], s66 offen offset:1024 lds
  s_mov_b32 m0, 0x20800
  s_mov_b32 s66, 0x4800
  buffer_load_dwordx4 v48, s[48:51], s66 offen lds
  buffer_load_dwordx4 v49, s[48:51], s66 offen offset:1024 lds
  s_mov_b32 m0, 0x21000
  s_mov_b32 s66, 0x9000
  buffer_load_dwordx4 v48, s[48:51], s66 offen lds
  buffer_load_dwordx4 v49, s[48:51], s66 offen offset:1024 lds
  s_mov_b32 m0, 0x21800
  s_mov_b32 s66, 0xd800
  buffer_load_dwordx4 v48, s[48:51], s66 offen lds
  buffer_load_dwordx4 v49, s[48:51], s66 offen offset:1024 lds
  s_mov_b32 m0, 0x22000
  s_mov_b32 s66, 0x120000
  buffer_load_dwordx4 v48, s[48:51], s66 offen lds
  buffer_load_dwordx4 v49, s[48:51], s66 offen offset:1024 lds
  s_mov_b32 m0, 0x22800
  s_mov_b32 s66, 0x124800
  buffer_load_dwordx4 v48, s[48:51], s66 offen lds
  buffer_load_dwordx4 v49, s[48:51], s66 offen offset:1024 lds
  s_mov_b32 m0, 0x23000
  s_mov_b32 s66, 0x129000
  buffer_load_dwordx4 v48, s[48:51], s66 offen lds
  buffer_load_dwordx4 v49, s[48:51], s66 offen offset:1024 lds
  s_mov_b32 m0, 0x23800
  s_mov_b32 s66, 0x12d800
  buffer_load_dwordx4 v48, s[48:51], s66 offen lds
  buffer_load_dwordx4 v49, s[48:51], s66 offen offset:1024 lds
  s_mov_b32 m0, 0x24000
  s_mov_b32 s66, 0x240000
  buffer_load_dwordx4 v48, s[48:51], s66 offen lds
  buffer_load_dwordx4 v49, s[48:51], s66 offen offset:1024 lds
  s_mov_b32 m0, 0x24800
  s_mov_b32 s66, 0x244800
  buffer_load_dwordx4 v48, s[48:51], s66 offen lds
  buffer_load_dwordx4 v49, s[48:51], s66 offen offset:1024 lds
  s_mov_b32 m0, 0x25000
  s_mov_b32 s66, 0x249000
  buffer_load_dwordx4 v48, s[48:51], s66 offen lds
  buffer_load_dwordx4 v49, s[48:51], s66 offen offset:1024 lds
  s_mov_b32 m0, 0x25800
  s_mov_b32 s66, 0x24d800
  buffer_load_dwordx4 v48, s[48:51], s66 offen lds
  buffer_load_dwordx4 v49, s[48:51], s66 offen offset:1024 lds
  s_mov_b32 m0, 0x26000
  s_mov_b32 s66, 0x360000
  buffer_load_dwordx4 v48, s[48:51], s66 offen lds
  buffer_load_dwordx4 v49, s[48:51], s66 offen offset:1024 lds
  s_mov_b32 m0, 0x26800
  s_mov_b32 s66, 0x364800
  buffer_load_dwordx4 v48, s[48:51], s66 offen lds
  buffer_load_dwordx4 v49, s[48:51], s66 offen offset:1024 lds
  s_mov_b32 m0, 0x27000
  s_mov_b32 s66, 0x369000
  buffer_load_dwordx4 v48, s[48:51], s66 offen lds
  buffer_load_dwordx4 v49, s[48:51], s66 offen offset:1024 lds
  s_mov_b32 m0, 0x27800
  s_mov_b32 s66, 0x36d800
  buffer_load_dwordx4 v48, s[48:51], s66 offen lds
  buffer_load_dwordx4 v49, s[48:51], s66 offen offset:1024 lds
  s_lshr_b32 s31, s2, 3
  s_mul_i32 s32, s31, 57
  s_lshr_b32 s32, s32, 9
  s_mul_i32 s33, s32, 9
  s_sub_u32 s31, s31, s33
  s_mul_i32 s33, s32, 7
  s_mul_i32 s34, s32, 28
  s_mul_i32 s34, s34, 0xab
  s_lshr_b32 s34, s34, 9
  s_cmp_ge_u32 s31, 5
  s_cselect_b32 s33, s34, s33
  s_cselect_b32 s31, 0x480, 0
  v_mul_lo_u32 v146, v0, s31
  s_mov_b32 s38, 0xa2000
  s_cmp_ge_u32 s33, 7
  s_cselect_b32 s31, 7, 0
  s_cselect_b32 s32, 0x120000, 0
  s_sub_u32 s33, s33, s31
  s_add_u32 s38, s38, s32
  s_cmp_ge_u32 s33, 7
  s_cselect_b32 s31, 7, 0
  s_cselect_b32 s32, 0x120000, 0
  s_sub_u32 s33, s33, s31
  s_add_u32 s38, s38, s32
  s_cmp_ge_u32 s33, 7
  s_cselect_b32 s31, 7, 0
  s_cselect_b32 s32, 0x120000, 0
  s_sub_u32 s33, s33, s31
  s_add_u32 s38, s38, s32
  s_mov_b32 s39, s33
  s_mul_i32 s33, s33, 0x12000
  s_add_u32 s38, s38, s33
  v_mul_u32_u24 v144, 0x480, v0
  s_mov_b32 s40, 0
A_LOOP1:
  s_waitcnt lgkmcnt(14)
  v_mfma_f32_32x32x16_bf16 a[0:15], a[160:163], v[32:35], a[0:15]
  ds_read_b128 a[128:131], v2 offset:40960
  s_mov_b32 m0, 0x1c000
  s_nop 0
  buffer_load_dwordx4 v60, s[12:15], s37 offen nt lds
  s_waitcnt lgkmcnt(13)
  v_mfma_f32_32x32x16_bf16 a[16:31], a[164:167], v[32:35], a[16:31]
  ds_read_b128 a[132:135], v3 offset:40960
  buffer_load_dwordx4 v60, s[12:15], s37 offen offset:1024 nt lds
  s_waitcnt lgkmcnt(12)
  v_mfma_f32_32x32x16_bf16 a[32:47], a[168:171], v[32:35], a[32:47]
  ds_read_b128 a[136:139], v4 offset:40960
  buffer_load_dwordx4 v60, s[12:15], s37 offen offset:2048 nt lds
  s_waitcnt lgkmcnt(11)
  v_mfma_f32_32x32x16_bf16 a[48:63], a[172:175], v[32:35], a[48:63]
  ds_read_b128 a[140:143], v5 offset:40960
  buffer_load_dwordx4 v60, s[12:15], s37 offen offset:3072 nt lds
  s_waitcnt lgkmcnt(10)
  v_mfma_f32_32x32x16_bf16 a[0:15], a[176:179], v[36:39], a[0:15]
  ds_read_b128 a[144:147], v6 offset:40960
  s_mov_b32 m0, 0x1d000
  s_nop 0
  buffer_load_dwordx4 v61, s[12:15], s37 offen nt lds
  s_waitcnt lgkmcnt(9)
  v_mfma_f32_32x32x16_bf16 a[16:31], a[180:183], v[36:39], a[16:31]
  ds_read_b128 a[148:151], v7 offset:40960
  buffer_load_dwordx4 v61, s[12:15], s37 offen offset:1024 nt lds
  s_waitcnt lgkmcnt(8)
  v_mfma_f32_32x32x16_bf16 a[32:47], a[184:187], v[36:39], a[32:47]
  ds_read_b128 a[152:155], v8 offset:40960
  buffer_load_dwordx4 v61, s[12:15], s37 offen offset:2048 nt lds
  s_waitcnt lgkmcnt(7)
  v_mfma_f32_32x32x16_bf16 a[48:63], a[188:191], v[36:39], a[48:63]
  ds_read_b128 a[156:159], v9 offset:40960
  buffer_load_dwordx4 v61, s[12:15], s37 offen offset:3072 nt lds
  s_add_u32 s37, s37, 0x2000
  s_waitcnt lgkmcnt(7)
  v_mfma_f32_32x32x16_bf16 v[128:143], a[128:131], v[64:67], v[160:175]
  s_mov_b32 m0, 0x4000
  s_nop 0
  buffer_load_dwordx4 v56, s[8:11], s36 offen nt lds
  s_waitcnt lgkmcnt(6)
  v_mfma_f32_32x32x16_bf16 v[128:143], a[132:135], v[68:71], v[128:143]
  buffer_load_dwordx4 v56, s[8:11], s36 offen offset:1024 nt lds
  s_waitcnt lgkmcnt(5)
  v_mfma_f32_32x32x16_bf16 v[128:143], a[136:139], v[72:75], v[128:143]
  buffer_load_dwordx4 v57, s[8:11], s36 offen offset:2048 nt lds
  s_waitcnt lgkmcnt(4)
  v_mfma_f32_32x32x16_bf16 v[128:143], a[140:143], v[76:79], v[128:143]
  buffer_load_dwordx4 v57, s[8:11], s36 offen offset:3072 nt lds
  s_waitcnt lgkmcnt(3)
  v_mfma_f32_32x32x16_bf16 v[128:143], a[144:147], v[80:83], v[128:143]
  s_mov_b32 m0, 0x5000
  s_nop 0
  buffer_load_dwordx4 v58, s[8:11], s36 offen nt lds
  s_waitcnt lgkmcnt(2)
  v_mfma_f32_32x32x16_bf16 v[128:143], a[148:151], v[84:87], v[128:143]
  buffer_load_dwordx4 v58, s[8:11], s36 offen offset:1024 nt lds
  s_waitcnt lgkmcnt(1)
  v_mfma_f32_32x32x16_bf16 v[128:143], a[152:155], v[88:91], v[128:143]
  buffer_load_dwordx4 v59, s[8:11], s36 offen offset:2048 nt lds
  s_waitcnt lgkmcnt(0)
  v_mfma_f32_32x32x16_bf16 v[128:143], a[156:159], v[92:95], v[128:143]
  buffer_load_dwordx4 v59, s[8:11], s36 offen offset:3072 nt lds
  s_add_u32 s36, s36, 0x2000
  s_waitcnt vmcnt(63)
  s_barrier
  s_nop 8
  v_exp_f32 v16, v128
  v_exp_f32 v17, v129
  ds_read_b64_tr_b16 a[160:161], v10 offset:32768
  v_exp_f32 v18, v130
  v_add_f32 v24, v16, v17
  ds_read_b64_tr_b16 a[162:163], v10 offset:34816
  v_cvt_pk_bf16_f32 v32, v16, v17
  v_exp_f32 v19, v131
  ds_read_b64_tr_b16 a[164:165], v11 offset:32768
  v_add_f32 v24, v24, v18
  v_exp_f32 v20, v132
  ds_read_b64_tr_b16 a[166:167], v11 offset:34816
  v_add_f32 v24, v24, v19
  v_cvt_pk_bf16_f32 v33, v18, v19
  ds_read_b64_tr_b16 a[168:169], v12 offset:32768
  v_exp_f32 v21, v133
  v_add_f32 v24, v24, v20
  ds_read_b64_tr_b16 a[170:171], v12 offset:34816
  v_exp_f32 v22, v134
  v_add_f32 v24, v24, v21
  ds_read_b64_tr_b16 a[172:173], v13 offset:32768
  v_cvt_pk_bf16_f32 v34, v20, v21
  v_exp_f32 v23, v135
  ds_read_b64_tr_b16 a[174:175], v13 offset:34816
  v_add_f32 v24, v24, v22
  v_exp_f32 v16, v136
  ds_read_b64_tr_b16 a[176:177], v10 offset:36864
  v_add_f32 v24, v24, v23
  v_cvt_pk_bf16_f32 v35, v22, v23
  ds_read_b64_tr_b16 a[178:179], v10 offset:38912
  v_exp_f32 v17, v137
  v_add_f32 v24, v24, v16
  ds_read_b64_tr_b16 a[180:181], v11 offset:36864
  v_exp_f32 v18, v138
  v_add_f32 v24, v24, v17
  ds_read_b64_tr_b16 a[182:183], v11 offset:38912
  v_cvt_pk_bf16_f32 v36, v16, v17
  v_exp_f32 v19, v139
  ds_read_b64_tr_b16 a[184:185], v12 offset:36864
  v_add_f32 v24, v24, v18
  v_exp_f32 v20, v140
  ds_read_b64_tr_b16 a[186:187], v12 offset:38912
  v_add_f32 v24, v24, v19
  v_cvt_pk_bf16_f32 v37, v18, v19
  ds_read_b64_tr_b16 a[188:189], v13 offset:36864
  v_exp_f32 v21, v141
  v_add_f32 v24, v24, v20
  ds_read_b64_tr_b16 a[190:191], v13 offset:38912
  v_exp_f32 v22, v142
  v_add_f32 v24, v24, v21
  v_cvt_pk_bf16_f32 v38, v20, v21
  v_exp_f32 v23, v143
  v_add_f32 v24, v24, v22
  v_add_f32 v24, v24, v23
  v_cvt_pk_bf16_f32 v39, v22, v23
  v_cmp_nge_f32 vcc, s42, v24
  s_nop 0
  s_cbranch_vccnz FBS_32
RET_32:
  v_add_f32 v26, v26, v24
  s_waitcnt lgkmcnt(14)
  v_mfma_f32_32x32x16_bf16 a[0:15], a[160:163], v[32:35], a[0:15]
  ds_read_b128 a[128:131], v2
  s_mov_b32 m0, 0x1e000
  s_nop 0
  buffer_load_dwordx4 v60, s[12:15], s37 offen nt lds
  s_waitcnt lgkmcnt(13)
  v_mfma_f32_32x32x16_bf16 a[16:31], a[164:167], v[32:35], a[16:31]
  ds_read_b128 a[132:135], v3
  buffer_load_dwordx4 v60, s[12:15], s37 offen offset:1024 nt lds
  s_waitcnt lgkmcnt(12)
  v_mfma_f32_32x32x16_bf16 a[32:47], a[168:171], v[32:35], a[32:47]
  ds_read_b128 a[136:139], v4
  buffer_load_dwordx4 v60, s[12:15], s37 offen offset:2048 nt lds
  s_waitcnt lgkmcnt(11)
  v_mfma_f32_32x32x16_bf16 a[48:63], a[172:175], v[32:35], a[48:63]
  ds_read_b128 a[140:143], v5
  buffer_load_dwordx4 v60, s[12:15], s37 offen offset:3072 nt lds
  s_waitcnt lgkmcnt(10)
  v_mfma_f32_32x32x16_bf16 a[0:15], a[176:179], v[36:39], a[0:15]
  ds_read_b128 a[144:147], v6
  s_mov_b32 m0, 0x1f000
  s_nop 0
  buffer_load_dwordx4 v61, s[12:15], s37 offen nt lds
  s_waitcnt lgkmcnt(9)
  v_mfma_f32_32x32x16_bf16 a[16:31], a[180:183], v[36:39], a[16:31]
  ds_read_b128 a[148:151], v7
  buffer_load_dwordx4 v61, s[12:15], s37 offen offset:1024 nt lds
  s_waitcnt lgkmcnt(8)
  v_mfma_f32_32x32x16_bf16 a[32:47], a[184:187], v[36:39], a[32:47]
  ds_read_b128 a[152:155], v8
  buffer_load_dwordx4 v61, s[12:15], s37 offen offset:2048 nt lds
  s_waitcnt lgkmcnt(7)
  v_mfma_f32_32x32x16_bf16 a[48:63], a[188:191], v[36:39], a[48:63]
  ds_read_b128 a[156:159], v9
  buffer_load_dwordx4 v61, s[12:15], s37 offen offset:3072 nt lds
  s_add_u32 s37, s37, 0x2000
  s_waitcnt lgkmcnt(7)
  v_mfma_f32_32x32x16_bf16 v[128:143], a[128:131], v[64:67], v[160:175]
  s_mov_b32 m0, 0x6000
  s_nop 0
  buffer_load_dwordx4 v56, s[8:11], s36 offen nt lds
  s_waitcnt lgkmcnt(6)
  v_mfma_f32_32x32x16_bf16 v[128:143], a[132:135], v[68:71], v[128:143]
  buffer_load_dwordx4 v56, s[8:11], s36 offen offset:1024 nt lds
  s_waitcnt lgkmcnt(5)
  v_mfma_f32_32x32x16_bf16 v[128:143], a[136:139], v[72:75], v[128:143]
  buffer_load_dwordx4 v57, s[8:11], s36 offen offset:2048 nt lds
  s_waitcnt lgkmcnt(4)
  v_mfma_f32_32x32x16_bf16 v[128:143], a[140:143], v[76:79], v[128:143]
  buffer_load_dwordx4 v57, s[8:11], s36 offen offset:3072 nt lds
  s_waitcnt lgkmcnt(3)
  v_mfma_f32_32x32x16_bf16 v[128:143], a[144:147], v[80:83], v[128:143]
  s_mov_b32 m0, 0x7000
  s_nop 0
  buffer_load_dwordx4 v58, s[8:11], s36 offen nt lds
  s_waitcnt lgkmcnt(2)
  v_mfma_f32_32x32x16_bf16 v[128:143], a[148:151], v[84:87], v[128:143]
  buffer_load_dwordx4 v58, s[8:11], s36 offen offset:1024 nt lds
  s_waitcnt lgkmcnt(1)
  v_mfma_f32_32x32x16_bf16 v[128:143], a[152:155], v[88:91], v[128:143]
  buffer_load_dwordx4 v59, s[8:11], s36 offen offset:2048 nt lds
  s_waitcnt lgkmcnt(0)
  v_mfma_f32_32x32x16_bf16 v[128:143], a[156:159], v[92:95], v[128:143]
  buffer_load_dwordx4 v59, s[8:11], s36 offen offset:3072 nt lds
  s_add_u32 s36, s36, 0x2000
  s_waitcnt vmcnt(56)
  s_barrier
  s_nop 8
  v_exp_f32 v16, v128
  v_exp_f32 v17, v129
  ds_read_b64_tr_b16 a[160:161], v10 offset:40960
  v_exp_f32 v18, v130
  v_add_f32 v24, v16, v17
  ds_read_b64_tr_b16 a[162:163], v10 offset:43008
  v_cvt_pk_bf16_f32 v32, v16, v17
  v_exp_f32 v19, v131
  ds_read_b64_tr_b16 a[164:165], v11 offset:40960
  v_add_f32 v24, v24, v18
  v_exp_f32 v20, v132
  ds_read_b64_tr_b16 a[166:167], v11 offset:43008
  v_add_f32 v24, v24, v19
  v_cvt_pk_bf16_f32 v33, v18, v19
  ds_read_b64_tr_b16 a[168:169], v12 offset:40960
  v_exp_f32 v21, v133
  v_add_f32 v24, v24, v20
  ds_read_b64_tr_b16 a[170:171], v12 offset:43008
  v_exp_f32 v22, v134
  v_add_f32 v24, v24, v21
  ds_read_b64_tr_b16 a[172:173], v13 offset:40960
  v_cvt_pk_bf16_f32 v34, v20, v21
  v_exp_f32 v23, v135
  ds_read_b64_tr_b16 a[174:175], v13 offset:43008
  v_add_f32 v24, v24, v22
  v_exp_f32 v16, v136
  ds_read_b64_tr_b16 a[176:177], v10 offset:45056
  v_add_f32 v24, v24, v23
  v_cvt_pk_bf16_f32 v35, v22, v23
  ds_read_b64_tr_b16 a[178:179], v10 offset:47104
  v_exp_f32 v17, v137
  v_add_f32 v24, v24, v16
  ds_read_b64_tr_b16 a[180:181], v11 offset:45056
  v_exp_f32 v18, v138
  v_add_f32 v24, v24, v17
  ds_read_b64_tr_b16 a[182:183], v11 offset:47104
  v_cvt_pk_bf16_f32 v36, v16, v17
  v_exp_f32 v19, v139
  ds_read_b64_tr_b16 a[184:185], v12 offset:45056
  v_add_f32 v24, v24, v18
  v_exp_f32 v20, v140
  ds_read_b64_tr_b16 a[186:187], v12 offset:47104
  v_add_f32 v24, v24, v19
  v_cvt_pk_bf16_f32 v37, v18, v19
  ds_read_b64_tr_b16 a[188:189], v13 offset:45056
  v_exp_f32 v21, v141
  v_add_f32 v24, v24, v20
  ds_read_b64_tr_b16 a[190:191], v13 offset:47104
  v_exp_f32 v22, v142
  v_add_f32 v24, v24, v21
  v_cvt_pk_bf16_f32 v38, v20, v21
  v_exp_f32 v23, v143
  v_add_f32 v24, v24, v22
  v_add_f32 v24, v24, v23
  v_cvt_pk_bf16_f32 v39, v22, v23
  v_cmp_nge_f32 vcc, s42, v24
  s_nop 0
  s_cbranch_vccnz FBS_33
RET_33:
  v_add_f32 v26, v26, v24
  s_waitcnt lgkmcnt(14)
  v_mfma_f32_32x32x16_bf16 a[0:15], a[160:163], v[32:35], a[0:15]
  ds_read_b128 a[128:131], v2 offset:8192
  s_mov_b32 m0, 0x14000
  s_nop 0
  buffer_load_dwordx4 v60, s[12:15], s37 offen nt lds
  s_waitcnt lgkmcnt(13)
  v_mfma_f32_32x32x16_bf16 a[16:31], a[164:167], v[32:35], a[16:31]
  ds_read_b128 a[132:135], v3 offset:8192
  buffer_load_dwordx4 v60, s[12:15], s37 offen offset:1024 nt lds
  s_waitcnt lgkmcnt(12)
  v_mfma_f32_32x32x16_bf16 a[32:47], a[168:171], v[32:35], a[32:47]
  ds_read_b128 a[136:139], v4 offset:8192
  buffer_load_dwordx4 v60, s[12:15], s37 offen offset:2048 nt lds
  s_waitcnt lgkmcnt(11)
  v_mfma_f32_32x32x16_bf16 a[48:63], a[172:175], v[32:35], a[48:63]
  ds_read_b128 a[140:143], v5 offset:8192
  buffer_load_dwordx4 v60, s[12:15], s37 offen offset:3072 nt lds
  s_waitcnt lgkmcnt(10)
  v_mfma_f32_32x32x16_bf16 a[0:15], a[176:179], v[36:39], a[0:15]
  ds_read_b128 a[144:147], v6 offset:8192
  s_mov_b32 m0, 0x15000
  s_nop 0
  buffer_load_dwordx4 v61, s[12:15], s37 offen nt lds
  s_waitcnt lgkmcnt(9)
  v_mfma_f32_32x32x16_bf16 a[16:31], a[180:183], v[36:39], a[16:31]
  ds_read_b128 a[148:151], v7 offset:8192
  buffer_load_dwordx4 v61, s[12:15], s37 offen offset:1024 nt lds
  s_waitcnt lgkmcnt(8)
  v_mfma_f32_32x32x16_bf16 a[32:47], a[184:187], v[36:39], a[32:47]
  ds_read_b128 a[152:155], v8 offset:8192
  buffer_load_dwordx4 v61, s[12:15], s37 offen offset:2048 nt lds
  s_waitcnt lgkmcnt(7)
  v_mfma_f32_32x32x16_bf16 a[48:63], a[188:191], v[36:39], a[48:63]
  ds_read_b128 a[156:159], v9 offset:8192
  buffer_load_dwordx4 v61, s[12:15], s37 offen offset:3072 nt lds
  s_add_u32 s37, s37, 0x2000
  s_waitcnt lgkmcnt(7)
  v_mfma_f32_32x32x16_bf16 v[128:143], a[128:131], v[64:67], v[160:175]
  s_mov_b32 m0, 0xe000
  s_nop 0
  buffer_load_dwordx4 v56, s[8:11], s36 offen nt lds
  s_waitcnt lgkmcnt(6)
  v_mfma_f32_32x32x16_bf16 v[128:143], a[132:135], v[68:71], v[128:143]
  buffer_load_dwordx4 v56, s[8:11], s36 offen offset:1024 nt lds
  s_waitcnt lgkmcnt(5)
  v_mfma_f32_32x32x16_bf16 v[128:143], a[136:139], v[72:75], v[128:143]
  buffer_load_dwordx4 v57, s[8:11], s36 offen offset:2048 nt lds
  s_branch PADO_9
PADA_9:
  s_branch HOPRET_g2
PAD_9:
  s_sub_u32 s40, s40, 1
  s_cbranch_scc1 HOPRET_gb
  s_branch PAD_11
PADO_9:
  s_waitcnt lgkmcnt(4)
  v_mfma_f32_32x32x16_bf16 v[128:143], a[140:143], v[76:79], v[128:143]
  buffer_load_dwordx4 v57, s[8:11], s36 offen offset:3072 nt lds
  s_waitcnt lgkmcnt(3)
  v_mfma_f32_32x32x16_bf16 v[128:143], a[144:147], v[80:83], v[128:143]
  s_mov_b32 m0, 0xf000
  s_nop 0
  buffer_load_dwordx4 v58, s[8:11], s36 offen nt lds
  s_waitcnt lgkmcnt(2)
  v_mfma_f32_32x32x16_bf16 v[128:143], a[148:151], v[84:87], v[128:143]
  buffer_load_dwordx4 v58, s[8:11], s36 offen offset:1024 nt lds
  s_waitcnt lgkmcnt(1)
  v_mfma_f32_32x32x16_bf16 v[128:143], a[152:155], v[88:91], v[128:143]
  buffer_load_dwordx4 v59, s[8:11], s36 offen offset:2048 nt lds
  s_waitcnt lgkmcnt(0)
  v_mfma_f32_32x32x16_bf16 v[128:143], a[156:159], v[92:95], v[128:143]
  buffer_load_dwordx4 v59, s[8:11], s36 offen offset:3072 nt lds
  s_add_u32 s36, s36, 0x2000
  s_waitcnt vmcnt(48)
  s_barrier
  s_nop 8
  v_exp_f32 v16, v128
  v_exp_f32 v17, v129
  ds_read_b64_tr_b16 a[160:161], v10 offset:8192
  v_exp_f32 v18, v130
  v_add_f32 v24, v16, v17
  ds_read_b64_tr_b16 a[162:163], v10 offset:10240
  v_cvt_pk_bf16_f32 v32, v16, v17
  v_exp_f32 v19, v131
  ds_read_b64_tr_b16 a[164:165], v11 offset:8192
  v_add_f32 v24, v24, v18
  v_exp_f32 v20, v132
  ds_read_b64_tr_b16 a[166:167], v11 offset:10240
  v_add_f32 v24, v24, v19
  v_cvt_pk_bf16_f32 v33, v18, v19
  ds_read_b64_tr_b16 a[168:169], v12 offset:8192
  v_exp_f32 v21, v133
  v_add_f32 v24, v24, v20
  ds_read_b64_tr_b16 a[170:171], v12 offset:10240
  v_exp_f32 v22, v134
  v_add_f32 v24, v24, v21
  ds_read_b64_tr_b16 a[172:173], v13 offset:8192
  v_cvt_pk_bf16_f32 v34, v20, v21
  v_exp_f32 v23, v135
  ds_read_b64_tr_b16 a[174:175], v13 offset:10240
  v_add_f32 v24, v24, v22
  v_exp_f32 v16, v136
  ds_read_b64_tr_b16 a[176:177], v10 offset:12288
  v_add_f32 v24, v24, v23
  v_cvt_pk_bf16_f32 v35, v22, v23
  ds_read_b64_tr_b16 a[178:179], v10 offset:14336
  v_exp_f32 v17, v137
  v_add_f32 v24, v24, v16
  ds_read_b64_tr_b16 a[180:181], v11 offset:12288
  v_exp_f32 v18, v138
  v_add_f32 v24, v24, v17
  ds_read_b64_tr_b16 a[182:183], v11 offset:14336
  v_cvt_pk_bf16_f32 v36, v16, v17
  v_exp_f32 v19, v139
  ds_read_b64_tr_b16 a[184:185], v12 offset:12288
  v_add_f32 v24, v24, v18
  v_exp_f32 v20, v140
  ds_read_b64_tr_b16 a[186:187], v12 offset:14336
  v_add_f32 v24, v24, v19
  v_cvt_pk_bf16_f32 v37, v18, v19
  ds_read_b64_tr_b16 a[188:189], v13 offset:12288
  v_exp_f32 v21, v141
  v_add_f32 v24, v24, v20
  ds_read_b64_tr_b16 a[190:191], v13 offset:14336
  v_exp_f32 v22, v142
  v_add_f32 v24, v24, v21
  v_cvt_pk_bf16_f32 v38, v20, v21
  v_exp_f32 v23, v143
  v_add_f32 v24, v24, v22
  v_add_f32 v24, v24, v23
  v_cvt_pk_bf16_f32 v39, v22, v23
  v_cmp_nge_f32 vcc, s42, v24
  s_nop 0
  s_cbranch_vccnz FBS_34
RET_34:
  v_add_f32 v26, v26, v24
  s_waitcnt lgkmcnt(14)
  v_mfma_f32_32x32x16_bf16 a[0:15], a[160:163], v[32:35], a[0:15]
  ds_read_b128 a[128:131], v2 offset:49152
  s_mov_b32 m0, 0x16000
  s_nop 0
  buffer_load_dwordx4 v60, s[12:15], s37 offen nt lds
  s_waitcnt lgkmcnt(13)
  v_mfma_f32_32x32x16_bf16 a[16:31], a[164:167], v[32:35], a[16:31]
  ds_read_b128 a[132:135], v3 offset:49152
  buffer_load_dwordx4 v60, s[12:15], s37 offen offset:1024 nt lds
  s_waitcnt lgkmcnt(12)
  v_mfma_f32_32x32x16_bf16 a[32:47], a[168:171], v[32:35], a[32:47]
  ds_read_b128 a[136:139], v4 offset:49152
  buffer_load_dwordx4 v60, s[12:15], s37 offen offset:2048 nt lds
  s_waitcnt lgkmcnt(11)
  v_mfma_f32_32x32x16_bf16 a[48:63], a[172:175], v[32:35], a[48:63]
  ds_read_b128 a[140:143], v5 offset:49152
  buffer_load_dwordx4 v60, s[12:15], s37 offen offset:3072 nt lds
  s_waitcnt lgkmcnt(10)
  v_mfma_f32_32x32x16_bf16 a[0:15], a[176:179], v[36:39], a[0:15]
  ds_read_b128 a[144:147], v6 offset:49152
  s_mov_b32 m0, 0x17000
  s_nop 0
  buffer_load_dwordx4 v61, s[12:15], s37 offen nt lds
  s_waitcnt lgkmcnt(9)
  v_mfma_f32_32x32x16_bf16 a[16:31], a[180:183], v[36:39], a[16:31]
  ds_read_b128 a[148:151], v7 offset:49152
  buffer_load_dwordx4 v61, s[12:15], s37 offen offset:1024 nt lds
  s_waitcnt lgkmcnt(8)
  v_mfma_f32_32x32x16_bf16 a[32:47], a[184:187], v[36:39], a[32:47]
  ds_read_b128 a[152:155], v8 offset:49152
  buffer_load_dwordx4 v61, s[12:15], s37 offen offset:2048 nt lds
  s_waitcnt lgkmcnt(7)
  v_mfma_f32_32x32x16_bf16 a[48:63], a[188:191], v[36:39], a[48:63]
  ds_read_b128 a[156:159], v9 offset:49152
  buffer_load_dwordx4 v61, s[12:15], s37 offen offset:3072 nt lds
  s_add_u32 s37, s37, 0x2000
  s_waitcnt lgkmcnt(7)
  v_mfma_f32_32x32x16_bf16 v[128:143], a[128:131], v[64:67], v[160:175]
  s_mov_b32 m0, 0x8000
  s_nop 0
  buffer_load_dwordx4 v56, s[8:11], s36 offen nt lds
  s_waitcnt lgkmcnt(6)
  v_mfma_f32_32x32x16_bf16 v[128:143], a[132:135], v[68:71], v[128:143]
  s_cmp_eq_u32 s40, 0
  s_cbranch_scc0 V1_3_T_n0
  ds_read_b64_tr_b16 v[192:193], v52
  ds_read_b64_tr_b16 v[194:195], v52 offset:512
  ds_read_b64_tr_b16 v[196:197], v53
  ds_read_b64_tr_b16 v[198:199], v53 offset:512
  ds_read_b64_tr_b16 v[200:201], v52 offset:2048
  ds_read_b64_tr_b16 v[202:203], v52 offset:2560
  ds_read_b64_tr_b16 v[204:205], v53 offset:2048
  ds_read_b64_tr_b16 v[206:207], v53 offset:2560
  ds_read_b64_tr_b16 v[208:209], v52 offset:4096
  ds_read_b64_tr_b16 v[210:211], v52 offset:4608
  ds_read_b64_tr_b16 v[212:213], v53 offset:4096
  ds_read_b64_tr_b16 v[214:215], v53 offset:4608
  ds_read_b64_tr_b16 v[216:217], v52 offset:6144
  ds_read_b64_tr_b16 v[218:219], v52 offset:6656
  ds_read_b64_tr_b16 v[220:221], v53 offset:6144
  ds_read_b64_tr_b16 v[222:223], v53 offset:6656
  s_branch V1_3_T_ret
V1_3_T_n0:
  s_cmp_eq_u32 s40, 1
  s_cbranch_scc0 V1_3_T_n1
  ds_read_b64_tr_b16 v[224:225], v52
  ds_read_b64_tr_b16 v[226:227], v52 offset:512
  ds_read_b64_tr_b16 v[228:229], v53
  ds_read_b64_tr_b16 v[230:231], v53 offset:512
  ds_read_b64_tr_b16 v[232:233], v52 offset:2048
  ds_read_b64_tr_b16 v[234:235], v52 offset:2560
  ds_read_b64_tr_b16 v[236:237], v53 offset:2048
  ds_read_b64_tr_b16 v[238:239], v53 offset:2560
  ds_read_b64_tr_b16 v[240:241], v52 offset:4096
  ds_read_b64_tr_b16 v[242:243], v52 offset:4608
  ds_read_b64_tr_b16 v[244:245], v53 offset:4096
  ds_read_b64_tr_b16 v[246:247], v53 offset:4608
  ds_read_b64_tr_b16 v[248:249], v52 offset:6144
  ds_read_b64_tr_b16 v[250:251], v52 offset:6656
  ds_read_b64_tr_b16 v[252:253], v53 offset:6144
  ds_read_b64_tr_b16 v[254:255], v53 offset:6656
  s_branch V1_3_T_ret
V1_3_T_n1:
  ds_read_b64_tr_b16 a[192:193], v52
  ds_read_b64_tr_b16 a[194:195], v52 offset:512
  ds_read_b64_tr_b16 a[196:197], v53
  ds_read_b64_tr_b16 a[198:199], v53 offset:512
  ds_read_b64_tr_b16 a[200:201], v52 offset:2048
  ds_read_b64_tr_b16 a[202:203], v52 offset:2560
  ds_read_b64_tr_b16 a[204:205], v53 offset:2048
  ds_read_b64_tr_b16 a[206:207], v53 offset:2560
  ds_read_b64_tr_b16 a[208:209], v52 offset:4096
  ds_read_b64_tr_b16 a[210:211], v52 offset:4608
  ds_read_b64_tr_b16 a[212:213], v53 offset:4096
  ds_read_b64_tr_b16 a[214:215], v53 offset:4608
  ds_read_b64_tr_b16 a[216:217], v52 offset:6144
  ds_read_b64_tr_b16 a[218:219], v52 offset:6656
  ds_read_b64_tr_b16 a[220:221], v53 offset:6144
  ds_read_b64_tr_b16 a[222:223], v53 offset:6656
V1_3_T_ret:
  buffer_load_dwordx4 v56, s[8:11], s36 offen offset:1024 nt lds
  s_waitcnt lgkmcnt(15)
  v_mfma_f32_32x32x16_bf16 v[128:143], a[136:139], v[72:75], v[128:143]
  buffer_load_dwordx4 v57, s[8:11], s36 offen offset:2048 nt lds
  s_waitcnt lgkmcnt(15)
  v_mfma_f32_32x32x16_bf16 v[128:143], a[140:143], v[76:79], v[128:143]
  buffer_load_dwordx4 v57, s[8:11], s36 offen offset:3072 nt lds
  s_waitcnt lgkmcnt(15)
  v_mfma_f32_32x32x16_bf16 v[128:143], a[144:147], v[80:83], v[128:143]
  s_mov_b32 m0, 0x9000
  s_nop 0
  buffer_load_dwordx4 v58, s[8:11], s36 offen nt lds
  s_waitcnt lgkmcnt(15)
  v_mfma_f32_32x32x16_bf16 v[128:143], a[148:151], v[84:87], v[128:143]
  buffer_load_dwordx4 v58, s[8:11], s36 offen offset:1024 nt lds
  s_waitcnt lgkmcnt(15)
  v_mfma_f32_32x32x16_bf16 v[128:143], a[152:155], v[88:91], v[128:143]
  buffer_load_dwordx4 v59, s[8:11], s36 offen offset:2048 nt lds
  s_waitcnt lgkmcnt(15)
  v_mfma_f32_32x32x16_bf16 v[128:143], a[156:159], v[92:95], v[128:143]
  buffer_load_dwordx4 v59, s[8:11], s36 offen offset:3072 nt lds
  s_add_u32 s36, s36, 0x2000
  s_waitcnt vmcnt(48) lgkmcnt(0)
  s_barrier
  s_nop 8
  v_exp_f32 v16, v128
  v_exp_f32 v17, v129
  ds_read_b64_tr_b16 a[160:161], v10 offset:49152
  v_exp_f32 v18, v130
  v_add_f32 v24, v16, v17
  ds_read_b64_tr_b16 a[162:163], v10 offset:51200
  v_cvt_pk_bf16_f32 v32, v16, v17
  v_exp_f32 v19, v131
  ds_read_b64_tr_b16 a[164:165], v11 offset:49152
  v_add_f32 v24, v24, v18
  v_exp_f32 v20, v132
  ds_read_b64_tr_b16 a[166:167], v11 offset:51200
  v_add_f32 v24, v24, v19
  v_cvt_pk_bf16_f32 v33, v18, v19
  ds_read_b64_tr_b16 a[168:169], v12 offset:49152
  v_exp_f32 v21, v133
  v_add_f32 v24, v24, v20
  ds_read_b64_tr_b16 a[170:171], v12 offset:51200
  v_exp_f32 v22, v134
  v_add_f32 v24, v24, v21
  ds_read_b64_tr_b16 a[172:173], v13 offset:49152
  v_cvt_pk_bf16_f32 v34, v20, v21
  v_exp_f32 v23, v135
  ds_read_b64_tr_b16 a[174:175], v13 offset:51200
  v_add_f32 v24, v24, v22
  v_exp_f32 v16, v136
  ds_read_b64_tr_b16 a[176:177], v10 offset:53248
  v_add_f32 v24, v24, v23
  v_cvt_pk_bf16_f32 v35, v22, v23
  ds_read_b64_tr_b16 a[178:179], v10 offset:55296
  v_exp_f32 v17, v137
  v_add_f32 v24, v24, v16
  ds_read_b64_tr_b16 a[180:181], v11 offset:53248
  v_exp_f32 v18, v138
  v_add_f32 v24, v24, v17
  ds_read_b64_tr_b16 a[182:183], v11 offset:55296
  v_cvt_pk_bf16_f32 v36, v16, v17
  v_exp_f32 v19, v139
  ds_read_b64_tr_b16 a[184:185], v12 offset:53248
  v_add_f32 v24, v24, v18
  v_exp_f32 v20, v140
  ds_read_b64_tr_b16 a[186:187], v12 offset:55296
  v_add_f32 v24, v24, v19
  v_cvt_pk_bf16_f32 v37, v18, v19
  ds_read_b64_tr_b16 a[188:189], v13 offset:53248
  v_exp_f32 v21, v141
  v_add_f32 v24, v24, v20
  ds_read_b64_tr_b16 a[190:191], v13 offset:55296
  v_exp_f32 v22, v142
  v_add_f32 v24, v24, v21
  v_cvt_pk_bf16_f32 v38, v20, v21
  v_exp_f32 v23, v143
  v_add_f32 v24, v24, v22
  v_add_f32 v24, v24, v23
  v_cvt_pk_bf16_f32 v39, v22, v23
  v_cmp_nge_f32 vcc, s42, v24
  s_nop 0
  s_cbranch_vccnz FBS_35
RET_35:
  v_add_f32 v26, v26, v24
  s_waitcnt lgkmcnt(14)
  v_mfma_f32_32x32x16_bf16 a[0:15], a[160:163], v[32:35], a[0:15]
  ds_read_b128 a[128:131], v2 offset:16384
  s_mov_b32 m0, 0x20000
  s_add_u32 s66, s46, 0
  buffer_load_dwordx4 v48, s[48:51], s66 offen lds
  s_waitcnt lgkmcnt(13)
  v_mfma_f32_32x32x16_bf16 a[16:31], a[164:167], v[32:35], a[16:31]
  ds_read_b128 a[132:135], v3 offset:16384
  buffer_load_dwordx4 v49, s[48:51], s66 offen offset:1024 lds
  s_mov_b32 m0, 0x20800
  s_add_u32 s66, s46, 0x4800
  s_waitcnt lgkmcnt(12)
  v_mfma_f32_32x32x16_bf16 a[32:47], a[168:171], v[32:35], a[32:47]
  ds_read_b128 a[136:139], v4 offset:16384
  buffer_load_dwordx4 v48, s[48:51], s66 offen lds
  buffer_load_dwordx4 v49, s[48:51], s66 offen offset:1024 lds
  s_waitcnt lgkmcnt(11)
  v_mfma_f32_32x32x16_bf16 a[48:63], a[172:175], v[32:35], a[48:63]
  ds_read_b128 a[140:143], v5 offset:16384
  s_mov_b32 m0, 0x21000
  s_add_u32 s66, s46, 0x9000
  buffer_load_dwordx4 v48, s[48:51], s66 offen lds
  s_waitcnt lgkmcnt(10)
  v_mfma_f32_32x32x16_bf16 a[0:15], a[176:179], v[36:39], a[0:15]
  ds_read_b128 a[144:147], v6 offset:16384
  buffer_load_dwordx4 v49, s[48:51], s66 offen offset:1024 lds
  s_mov_b32 m0, 0x21800
  s_waitcnt lgkmcnt(9)
  v_mfma_f32_32x32x16_bf16 a[16:31], a[180:183], v[36:39], a[16:31]
  ds_read_b128 a[148:151], v7 offset:16384
  s_add_u32 s66, s46, 0xd800
  buffer_load_dwordx4 v48, s[48:51], s66 offen lds
  buffer_load_dwordx4 v49, s[48:51], s66 offen offset:1024 lds
  s_waitcnt lgkmcnt(8)
  v_mfma_f32_32x32x16_bf16 a[32:47], a[184:187], v[36:39], a[32:47]
  ds_read_b128 a[152:155], v8 offset:16384
  s_mov_b32 m0, 0x10000
  s_nop 0
  buffer_load_dwordx4 v60, s[12:15], s37 offen nt lds
  s_waitcnt lgkmcnt(7)
  v_mfma_f32_32x32x16_bf16 a[48:63], a[188:191], v[36:39], a[48:63]
  ds_read_b128 a[156:159], v9 offset:16384
  buffer_load_dwordx4 v60, s[12:15], s37 offen offset:1024 nt lds
  buffer_load_dwordx4 v60, s[12:15], s37 offen offset:2048 nt lds
  s_waitcnt lgkmcnt(7)
  v_mfma_f32_32x32x16_bf16 v[128:143], a[128:131], v[64:67], v[160:175]
  buffer_load_dwordx4 v60, s[12:15], s37 offen offset:3072 nt lds
  s_mov_b32 m0, 0x11000
  s_waitcnt lgkmcnt(6)
  v_mfma_f32_32x32x16_bf16 v[128:143], a[132:135], v[68:71], v[128:143]
  buffer_load_dwordx4 v61, s[12:15], s37 offen nt lds
  buffer_load_dwordx4 v61, s[12:15], s37 offen offset:1024 nt lds
  s_waitcnt lgkmcnt(5)
  v_mfma_f32_32x32x16_bf16 v[128:143], a[136:139], v[72:75], v[128:143]
  buffer_load_dwordx4 v61, s[12:15], s37 offen offset:2048 nt lds
  buffer_load_dwordx4 v61, s[12:15], s37 offen offset:3072 nt lds
  s_add_u32 s37, s37, 0x2000
  s_waitcnt lgkmcnt(4)
  v_mfma_f32_32x32x16_bf16 v[128:143], a[140:143], v[76:79], v[128:143]
  s_mov_b32 m0, 0xa000
  s_nop 0
  buffer_load_dwordx4 v56, s[8:11], s36 offen nt lds
  s_waitcnt lgkmcnt(3)
  v_mfma_f32_32x32x16_bf16 v[128:143], a[144:147], v[80:83], v[128:143]
  buffer_load_dwordx4 v56, s[8:11], s36 offen offset:1024 nt lds
  buffer_load_dwordx4 v57, s[8:11], s36 offen offset:2048 nt lds
  s_waitcnt lgkmcnt(2)
  v_mfma_f32_32x32x16_bf16 v[128:143], a[148:151], v[84:87], v[128:143]
  buffer_load_dwordx4 v57, s[8:11], s36 offen offset:3072 nt lds
  s_mov_b32 m0, 0xb000
  s_nop 0
  buffer_load_dwordx4 v58, s[8:11], s36 offen nt lds
  s_waitcnt lgkmcnt(1)
  v_mfma_f32_32x32x16_bf16 v[128:143], a[152:155], v[88:91], v[128:143]
  buffer_load_dwordx4 v58, s[8:11], s36 offen offset:1024 nt lds
  buffer_load_dwordx4 v59, s[8:11], s36 offen offset:2048 nt lds
  s_waitcnt lgkmcnt(0)
  v_mfma_f32_32x32x16_bf16 v[128:143], a[156:159], v[92:95], v[128:143]
  buffer_load_dwordx4 v59, s[8:11], s36 offen offset:3072 nt lds
  s_add_u32 s36, s36, 0x2000
  s_waitcnt vmcnt(56)
  s_barrier
  s_nop 8
  v_exp_f32 v16, v128
  v_exp_f32 v17, v129
  ds_read_b64_tr_b16 a[160:161], v10 offset:57344
  v_exp_f32 v18, v130
  v_add_f32 v24, v16, v17
  ds_read_b64_tr_b16 a[162:163], v10 offset:59392
  v_cvt_pk_bf16_f32 v32, v16, v17
  v_exp_f32 v19, v131
  ds_read_b64_tr_b16 a[164:165], v11 offset:57344
  v_add_f32 v24, v24, v18
  v_exp_f32 v20, v132
  ds_read_b64_tr_b16 a[166:167], v11 offset:59392
  v_add_f32 v24, v24, v19
  v_cvt_pk_bf16_f32 v33, v18, v19
  ds_read_b64_tr_b16 a[168:169], v12 offset:57344
  v_exp_f32 v21, v133
  v_add_f32 v24, v24, v20
  ds_read_b64_tr_b16 a[170:171], v12 offset:59392
  v_exp_f32 v22, v134
  v_add_f32 v24, v24, v21
  ds_read_b64_tr_b16 a[172:173], v13 offset:57344
  v_cvt_pk_bf16_f32 v34, v20, v21
  v_exp_f32 v23, v135
  ds_read_b64_tr_b16 a[174:175], v13 offset:59392
  v_add_f32 v24, v24, v22
  v_exp_f32 v16, v136
  ds_read_b64_tr_b16 a[176:177], v10 offset:61440
  v_add_f32 v24, v24, v23
  v_cvt_pk_bf16_f32 v35, v22, v23
  ds_read_b64_tr_b16 a[178:179], v10 offset:63488
  v_exp_f32 v17, v137
  v_add_f32 v24, v24, v16
  ds_read_b64_tr_b16 a[180:181], v11 offset:61440
  v_exp_f32 v18, v138
  v_add_f32 v24, v24, v17
  ds_read_b64_tr_b16 a[182:183], v11 offset:63488
  v_cvt_pk_bf16_f32 v36, v16, v17
  v_exp_f32 v19, v139
  ds_read_b64_tr_b16 a[184:185], v12 offset:61440
  v_add_f32 v24, v24, v18
  v_exp_f32 v20, v140
  ds_read_b64_tr_b16 a[186:187], v12 offset:63488
  v_add_f32 v24, v24, v19
  v_cvt_pk_bf16_f32 v37, v18, v19
  ds_read_b64_tr_b16 a[188:189], v13 offset:61440
  v_exp_f32 v21, v141
  v_add_f32 v24, v24, v20
  ds_read_b64_tr_b16 a[190:191], v13 offset:63488
  v_exp_f32 v22, v142
  v_add_f32 v24, v24, v21
  v_cvt_pk_bf16_f32 v38, v20, v21
  v_exp_f32 v23, v143
  v_add_f32 v24, v24, v22
  v_add_f32 v24, v24, v23
  v_cvt_pk_bf16_f32 v39, v22, v23
  v_cmp_nge_f32 vcc, s42, v24
  s_nop 0
  s_cbranch_vccnz FBS_36
RET_36:
  v_add_f32 v26, v26, v24
  s_waitcnt lgkmcnt(14)
  v_mfma_f32_32x32x16_bf16 a[0:15], a[160:163], v[32:35], a[0:15]
  ds_read_b128 a[128:131], v2 offset:24576
  s_mov_b32 m0, 0x22000
  s_add_u32 s66, s46, 0x120000
  buffer_load_dwordx4 v48, s[48:51], s66 offen lds
  s_waitcnt lgkmcnt(13)
  v_mfma_f32_32x32x16_bf16 a[16:31], a[164:167], v[32:35], a[16:31]
  ds_read_b128 a[132:135], v3 offset:24576
  buffer_load_dwordx4 v49, s[48:51], s66 offen offset:1024 lds
  s_mov_b32 m0, 0x22800
  s_add_u32 s66, s46, 0x124800
  s_waitcnt lgkmcnt(12)
  v_mfma_f32_32x32x16_bf16 a[32:47], a[168:171], v[32:35], a[32:47]
  ds_read_b128 a[136:139], v4 offset:24576
  buffer_load_dwordx4 v48, s[48:51], s66 offen lds
  buffer_load_dwordx4 v49, s[48:51], s66 offen offset:1024 lds
  s_waitcnt lgkmcnt(11)
  v_mfma_f32_32x32x16_bf16 a[48:63], a[172:175], v[32:35], a[48:63]
  ds_read_b128 a[140:143], v5 offset:24576
  s_mov_b32 m0, 0x23000
  s_add_u32 s66, s46, 0x129000
  buffer_load_dwordx4 v48, s[48:51], s66 offen lds
  s_waitcnt lgkmcnt(10)
  v_mfma_f32_32x32x16_bf16 a[0:15], a[176:179], v[36:39], a[0:15]
  ds_read_b128 a[144:147], v6 offset:24576
  buffer_load_dwordx4 v49, s[48:51], s66 offen offset:1024 lds
  s_mov_b32 m0, 0x23800
  s_waitcnt lgkmcnt(9)
  v_mfma_f32_32x32x16_bf16 a[16:31], a[180:183], v[36:39], a[16:31]
  ds_read_b128 a[148:151], v7 offset:24576
  s_add_u32 s66, s46, 0x12d800
  buffer_load_dwordx4 v48, s[48:51], s66 offen lds
  buffer_load_dwordx4 v49, s[48:51], s66 offen offset:1024 lds
  s_waitcnt lgkmcnt(8)
  v_mfma_f32_32x32x16_bf16 a[32:47], a[184:187], v[36:39], a[32:47]
  ds_read_b128 a[152:155], v8 offset:24576
  s_mov_b32 m0, 0x18000
  s_nop 0
  buffer_load_dwordx4 v60, s[12:15], s37 offen nt lds
  s_waitcnt lgkmcnt(7)
  v_mfma_f32_32x32x16_bf16 a[48:63], a[188:191], v[36:39], a[48:63]
  ds_read_b128 a[156:159], v9 offset:24576
  buffer_load_dwordx4 v60, s[12:15], s37 offen offset:1024 nt lds
  buffer_load_dwordx4 v60, s[12:15], s37 offen offset:2048 nt lds
  s_waitcnt lgkmcnt(7)
  v_mfma_f32_32x32x16_bf16 v[128:143], a[128:131], v[64:67], v[160:175]
  buffer_load_dwordx4 v60, s[12:15], s37 offen offset:3072 nt lds
  s_mov_b32 m0, 0x19000
  s_waitcnt lgkmcnt(6)
  v_mfma_f32_32x32x16_bf16 v[128:143], a[132:135], v[68:71], v[128:143]
  buffer_load_dwordx4 v61, s[12:15], s37 offen nt lds
  buffer_load_dwordx4 v61, s[12:15], s37 offen offset:1024 nt lds
  s_waitcnt lgkmcnt(5)
  v_mfma_f32_32x32x16_bf16 v[128:143], a[136:139], v[72:75], v[128:143]
  buffer_load_dwordx4 v61, s[12:15], s37 offen offset:2048 nt lds
  buffer_load_dwordx4 v61, s[12:15], s37 offen offset:3072 nt lds
  s_add_u32 s37, s37, 0x2000
  s_waitcnt lgkmcnt(4)
  v_mfma_f32_32x32x16_bf16 v[128:143], a[140:143], v[76:79], v[128:143]
  s_mov_b32 m0, 0
  s_nop 0
  buffer_load_dwordx4 v56, s[8:11], s36 offen nt lds
  s_waitcnt lgkmcnt(3)
  v_mfma_f32_32x32x16_bf16 v[128:143], a[144:147], v[80:83], v[128:143]
  buffer_load_dwordx4 v56, s[8:11], s36 offen offset:1024 nt lds
  buffer_load_dwordx4 v57, s[8:11], s36 offen offset:2048 nt lds
  s_waitcnt lgkmcnt(2)
  v_mfma_f32_32x32x16_bf16 v[128:143], a[148:151], v[84:87], v[128:143]
  buffer_load_dwordx4 v57, s[8:11], s36 offen offset:3072 nt lds
  s_mov_b32 m0, 0x1000
  s_nop 0
  buffer_load_dwordx4 v58, s[8:11], s36 offen nt lds
  s_waitcnt lgkmcnt(1)
  v_mfma_f32_32x32x16_bf16 v[128:143], a[152:155], v[88:91], v[128:143]
  buffer_load_dwordx4 v58, s[8:11], s36 offen offset:1024 nt lds
  buffer_load_dwordx4 v59, s[8:11], s36 offen offset:2048 nt lds
  s_waitcnt lgkmcnt(0)
  v_mfma_f32_32x32x16_bf16 v[128:143], a[156:159], v[92:95], v[128:143]
  buffer_load_dwordx4 v59, s[8:11], s36 offen offset:3072 nt lds
  s_add_u32 s36, s36, 0x2000
  s_waitcnt vmcnt(63)
  s_barrier
  s_nop 8
  v_exp_f32 v16, v128
  v_exp_f32 v17, v129
  ds_read_b64_tr_b16 a[160:161], v10 offset:16384
  v_exp_f32 v18, v130
  v_add_f32 v24, v16, v17
  ds_read_b64_tr_b16 a[162:163], v10 offset:18432
  v_cvt_pk_bf16_f32 v32, v16, v17
  v_exp_f32 v19, v131
  ds_read_b64_tr_b16 a[164:165], v11 offset:16384
  v_add_f32 v24, v24, v18
  v_exp_f32 v20, v132
  ds_read_b64_tr_b16 a[166:167], v11 offset:18432
  v_add_f32 v24, v24, v19
  v_cvt_pk_bf16_f32 v33, v18, v19
  ds_read_b64_tr_b16 a[168:169], v12 offset:16384
  v_exp_f32 v21, v133
  v_add_f32 v24, v24, v20
  ds_read_b64_tr_b16 a[170:171], v12 offset:18432
  v_exp_f32 v22, v134
  v_add_f32 v24, v24, v21
  ds_read_b64_tr_b16 a[172:173], v13 offset:16384
  v_cvt_pk_bf16_f32 v34, v20, v21
  v_exp_f32 v23, v135
  ds_read_b64_tr_b16 a[174:175], v13 offset:18432
  v_add_f32 v24, v24, v22
  v_exp_f32 v16, v136
  ds_read_b64_tr_b16 a[176:177], v10 offset:20480
  v_add_f32 v24, v24, v23
  v_cvt_pk_bf16_f32 v35, v22, v23
  ds_read_b64_tr_b16 a[178:179], v10 offset:22528
  v_exp_f32 v17, v137
  v_add_f32 v24, v24, v16
  ds_read_b64_tr_b16 a[180:181], v11 offset:20480
  v_exp_f32 v18, v138
  v_add_f32 v24, v24, v17
  ds_read_b64_tr_b16 a[182:183], v11 offset:22528
  v_cvt_pk_bf16_f32 v36, v16, v17
  v_exp_f32 v19, v139
  ds_read_b64_tr_b16 a[184:185], v12 offset:20480
  v_add_f32 v24, v24, v18
  v_exp_f32 v20, v140
  ds_read_b64_tr_b16 a[186:187], v12 offset:22528
  v_add_f32 v24, v24, v19
  v_cvt_pk_bf16_f32 v37, v18, v19
  ds_read_b64_tr_b16 a[188:189], v13 offset:20480
  v_exp_f32 v21, v141
  v_add_f32 v24, v24, v20
  ds_read_b64_tr_b16 a[190:191], v13 offset:22528
  v_exp_f32 v22, v142
  v_add_f32 v24, v24, v21
  v_cvt_pk_bf16_f32 v38, v20, v21
  v_exp_f32 v23, v143
  v_add_f32 v24, v24, v22
  v_add_f32 v24, v24, v23
  v_cvt_pk_bf16_f32 v39, v22, v23
  v_cmp_nge_f32 vcc, s42, v24
  s_nop 0
  s_cbranch_vccnz FBS_37
RET_37:
  v_add_f32 v26, v26, v24
  s_waitcnt lgkmcnt(14)
  v_mfma_f32_32x32x16_bf16 a[0:15], a[160:163], v[32:35], a[0:15]
  ds_read_b128 a[128:131], v2 offset:57344
  s_mov_b32 m0, 0x24000
  s_add_u32 s66, s46, 0x240000
  buffer_load_dwordx4 v48, s[48:51], s66 offen lds
  s_waitcnt lgkmcnt(13)
  v_mfma_f32_32x32x16_bf16 a[16:31], a[164:167], v[32:35], a[16:31]
  ds_read_b128 a[132:135], v3 offset:57344
  buffer_load_dwordx4 v49, s[48:51], s66 offen offset:1024 lds
  s_mov_b32 m0, 0x24800
  s_add_u32 s66, s46, 0x244800
  s_waitcnt lgkmcnt(12)
  v_mfma_f32_32x32x16_bf16 a[32:47], a[168:171], v[32:35], a[32:47]
  ds_read_b128 a[136:139], v4 offset:57344
  buffer_load_dwordx4 v48, s[48:51], s66 offen lds
  buffer_load_dwordx4 v49, s[48:51], s66 offen offset:1024 lds
  s_waitcnt lgkmcnt(11)
  v_mfma_f32_32x32x16_bf16 a[48:63], a[172:175], v[32:35], a[48:63]
  ds_read_b128 a[140:143], v5 offset:57344
  s_mov_b32 m0, 0x25000
  s_add_u32 s66, s46, 0x249000
  buffer_load_dwordx4 v48, s[48:51], s66 offen lds
  s_waitcnt lgkmcnt(10)
  v_mfma_f32_32x32x16_bf16 a[0:15], a[176:179], v[36:39], a[0:15]
  ds_read_b128 a[144:147], v6 offset:57344
  buffer_load_dwordx4 v49, s[48:51], s66 offen offset:1024 lds
  s_mov_b32 m0, 0x25800
  s_waitcnt lgkmcnt(9)
  v_mfma_f32_32x32x16_bf16 a[16:31], a[180:183], v[36:39], a[16:31]
  ds_read_b128 a[148:151], v7 offset:57344
  s_add_u32 s66, s46, 0x24d800
  buffer_load_dwordx4 v48, s[48:51], s66 offen lds
  buffer_load_dwordx4 v49, s[48:51], s66 offen offset:1024 lds
  s_waitcnt lgkmcnt(8)
  v_mfma_f32_32x32x16_bf16 a[32:47], a[184:187], v[36:39], a[32:47]
  ds_read_b128 a[152:155], v8 offset:57344
  s_mov_b32 m0, 0x1a000
  s_nop 0
  buffer_load_dwordx4 v60, s[12:15], s37 offen nt lds
  s_waitcnt lgkmcnt(7)
  v_mfma_f32_32x32x16_bf16 a[48:63], a[188:191], v[36:39], a[48:63]
  ds_read_b128 a[156:159], v9 offset:57344
  buffer_load_dwordx4 v60, s[12:15], s37 offen offset:1024 nt lds
  buffer_load_dwordx4 v60, s[12:15], s37 offen offset:2048 nt lds
  s_waitcnt lgkmcnt(7)
  v_mfma_f32_32x32x16_bf16 v[128:143], a[128:131], v[64:67], v[160:175]
  buffer_load_dwordx4 v60, s[12:15], s37 offen offset:3072 nt lds
  s_mov_b32 m0, 0x1b000
  s_waitcnt lgkmcnt(6)
  v_mfma_f32_32x32x16_bf16 v[128:143], a[132:135], v[68:71], v[128:143]
  buffer_load_dwordx4 v61, s[12:15], s37 offen nt lds
  buffer_load_dwordx4 v61, s[12:15], s37 offen offset:1024 nt lds
  s_waitcnt lgkmcnt(5)
  v_mfma_f32_32x32x16_bf16 v[128:143], a[136:139], v[72:75], v[128:143]
  buffer_load_dwordx4 v61, s[12:15], s37 offen offset:2048 nt lds
  buffer_load_dwordx4 v61, s[12:15], s37 offen offset:3072 nt lds
  s_add_u32 s37, s37, 0x2000
  s_waitcnt lgkmcnt(4)
  v_mfma_f32_32x32x16_bf16 v[128:143], a[140:143], v[76:79], v[128:143]
  s_mov_b32 m0, 0x2000
  s_nop 0
  buffer_load_dwordx4 v56, s[8:11], s36 offen nt lds
  s_waitcnt lgkmcnt(3)
  v_mfma_f32_32x32x16_bf16 v[128:143], a[144:147], v[80:83], v[128:143]
  buffer_load_dwordx4 v56, s[8:11], s36 offen offset:1024 nt lds
  buffer_load_dwordx4 v57, s[8:11], s36 offen offset:2048 nt lds
  s_waitcnt lgkmcnt(2)
  v_mfma_f32_32x32x16_bf16 v[128:143], a[148:151], v[84:87], v[128:143]
  buffer_load_dwordx4 v57, s[8:11], s36 offen offset:3072 nt lds
  s_mov_b32 m0, 0x3000
  s_nop 0
  buffer_load_dwordx4 v58, s[8:11], s36 offen nt lds
  s_waitcnt lgkmcnt(1)
  v_mfma_f32_32x32x16_bf16 v[128:143], a[152:155], v[88:91], v[128:143]
  buffer_load_dwordx4 v58, s[8:11], s36 offen offset:1024 nt lds
  buffer_load_dwordx4 v59, s[8:11], s36 offen offset:2048 nt lds
  s_waitcnt lgkmcnt(0)
  v_mfma_f32_32x32x16_bf16 v[128:143], a[156:159], v[92:95], v[128:143]
  buffer_load_dwordx4 v59, s[8:11], s36 offen offset:3072 nt lds
  s_add_u32 s36, s36, 0x2000
  s_waitcnt vmcnt(63)
  s_barrier
  s_nop 8
  s_branch PADO_10
PADA_10:
  s_branch HOPRET_g2
PAD_10:
  s_sub_u32 s40, s40, 1
  s_cbranch_scc1 HOPRET_gb
  s_branch PAD_5
PADO_10:
  v_exp_f32 v16, v128
  v_exp_f32 v17, v129
  ds_read_b64_tr_b16 a[160:161], v10 offset:24576
  v_exp_f32 v18, v130
  v_add_f32 v24, v16, v17
  ds_read_b64_tr_b16 a[162:163], v10 offset:26624
  v_cvt_pk_bf16_f32 v32, v16, v17
  v_exp_f32 v19, v131
  ds_read_b64_tr_b16 a[164:165], v11 offset:24576
  v_add_f32 v24, v24, v18
  v_exp_f32 v20, v132
  ds_read_b64_tr_b16 a[166:167], v11 offset:26624
  v_add_f32 v24, v24, v19
  v_cvt_pk_bf16_f32 v33, v18, v19
  ds_read_b64_tr_b16 a[168:169], v12 offset:24576
  v_exp_f32 v21, v133
  v_add_f32 v24, v24, v20
  ds_read_b64_tr_b16 a[170:171], v12 offset:26624
  v_exp_f32 v22, v134
  v_add_f32 v24, v24, v21
  ds_read_b64_tr_b16 a[172:173], v13 offset:24576
  v_cvt_pk_bf16_f32 v34, v20, v21
  v_exp_f32 v23, v135
  ds_read_b64_tr_b16 a[174:175], v13 offset:26624
  v_add_f32 v24, v24, v22
  v_exp_f32 v16, v136
  ds_read_b64_tr_b16 a[176:177], v10 offset:28672
  v_add_f32 v24, v24, v23
  v_cvt_pk_bf16_f32 v35, v22, v23
  ds_read_b64_tr_b16 a[178:179], v10 offset:30720
  v_exp_f32 v17, v137
  v_add_f32 v24, v24, v16
  ds_read_b64_tr_b16 a[180:181], v11 offset:28672
  v_exp_f32 v18, v138
  v_add_f32 v24, v24, v17
  ds_read_b64_tr_b16 a[182:183], v11 offset:30720
  v_cvt_pk_bf16_f32 v36, v16, v17
  v_exp_f32 v19, v139
  ds_read_b64_tr_b16 a[184:185], v12 offset:28672
  v_add_f32 v24, v24, v18
  v_exp_f32 v20, v140
  ds_read_b64_tr_b16 a[186:187], v12 offset:30720
  v_add_f32 v24, v24, v19
  v_cvt_pk_bf16_f32 v37, v18, v19
  ds_read_b64_tr_b16 a[188:189], v13 offset:28672
  v_exp_f32 v21, v141
  v_add_f32 v24, v24, v20
  ds_read_b64_tr_b16 a[190:191], v13 offset:30720
  v_exp_f32 v22, v142
  v_add_f32 v24, v24, v21
  v_cvt_pk_bf16_f32 v38, v20, v21
  v_exp_f32 v23, v143
  v_add_f32 v24, v24, v22
  v_add_f32 v24, v24, v23
  v_cvt_pk_bf16_f32 v39, v22, v23
  v_cmp_nge_f32 vcc, s42, v24
  s_nop 0
  s_cbranch_vccnz FBS_38
RET_38:
  v_add_f32 v26, v26, v24
  s_waitcnt lgkmcnt(14)
  v_mfma_f32_32x32x16_bf16 a[0:15], a[160:163], v[32:35], a[0:15]
  ds_read_b128 a[128:131], v2 offset:32768
  s_mov_b32 m0, 0x26000
  s_add_u32 s66, s46, 0x360000
  buffer_load_dwordx4 v48, s[48:51], s66 offen lds
  s_waitcnt lgkmcnt(13)
  v_mfma_f32_32x32x16_bf16 a[16:31], a[164:167], v[32:35], a[16:31]
  ds_read_b128 a[132:135], v3 offset:32768
  buffer_load_dwordx4 v49, s[48:51], s66 offen offset:1024 lds
  s_mov_b32 m0, 0x26800
  s_add_u32 s66, s46, 0x364800
  s_waitcnt lgkmcnt(12)
  v_mfma_f32_32x32x16_bf16 a[32:47], a[168:171], v[32:35], a[32:47]
  ds_read_b128 a[136:139], v4 offset:32768
  buffer_load_dwordx4 v48, s[48:51], s66 offen lds
  buffer_load_dwordx4 v49, s[48:51], s66 offen offset:1024 lds
  s_waitcnt lgkmcnt(11)
  v_mfma_f32_32x32x16_bf16 a[48:63], a[172:175], v[32:35], a[48:63]
  ds_read_b128 a[140:143], v5 offset:32768
  s_mov_b32 m0, 0x27000
  s_add_u32 s66, s46, 0x369000
  buffer_load_dwordx4 v48, s[48:51], s66 offen lds
  s_waitcnt lgkmcnt(10)
  v_mfma_f32_32x32x16_bf16 a[0:15], a[176:179], v[36:39], a[0:15]
  ds_read_b128 a[144:147], v6 offset:32768
  buffer_load_dwordx4 v49, s[48:51], s66 offen offset:1024 lds
  s_mov_b32 m0, 0x27800
  s_add_u32 s66, s46, 0x36d800
  s_waitcnt lgkmcnt(9)
  v_mfma_f32_32x32x16_bf16 a[16:31], a[180:183], v[36:39], a[16:31]
  ds_read_b128 a[148:151], v7 offset:32768
  buffer_load_dwordx4 v48, s[48:51], s66 offen lds
  buffer_load_dwordx4 v49, s[48:51], s66 offen offset:1024 lds
  s_waitcnt lgkmcnt(8)
  v_mfma_f32_32x32x16_bf16 a[32:47], a[184:187], v[36:39], a[32:47]
  ds_read_b128 a[152:155], v8 offset:32768
  s_add_u32 s46, s46, 0x12000
  s_mov_b32 m0, 0x12000
  s_nop 0
  buffer_load_dwordx4 v60, s[12:15], s37 offen nt lds
  s_waitcnt lgkmcnt(7)
  v_mfma_f32_32x32x16_bf16 a[48:63], a[188:191], v[36:39], a[48:63]
  ds_read_b128 a[156:159], v9 offset:32768
  buffer_load_dwordx4 v60, s[12:15], s37 offen offset:1024 nt lds
  buffer_load_dwordx4 v60, s[12:15], s37 offen offset:2048 nt lds
  s_waitcnt lgkmcnt(7)
  v_mfma_f32_32x32x16_bf16 v[128:143], a[128:131], v[64:67], v[160:175]
  buffer_load_dwordx4 v60, s[12:15], s37 offen offset:3072 nt lds
  s_mov_b32 m0, 0x13000
  s_waitcnt lgkmcnt(6)
  v_mfma_f32_32x32x16_bf16 v[128:143], a[132:135], v[68:71], v[128:143]
  buffer_load_dwordx4 v61, s[12:15], s37 offen nt lds
  buffer_load_dwordx4 v61, s[12:15], s37 offen offset:1024 nt lds
  s_waitcnt lgkmcnt(5)
  v_mfma_f32_32x32x16_bf16 v[128:143], a[136:139], v[72:75], v[128:143]
  buffer_load_dwordx4 v61, s[12:15], s37 offen offset:2048 nt lds
  buffer_load_dwordx4 v61, s[12:15], s37 offen offset:3072 nt lds
  s_waitcnt lgkmcnt(4)
  v_mfma_f32_32x32x16_bf16 v[128:143], a[140:143], v[76:79], v[128:143]
  s_add_u32 s37, s37, 0x2000
  s_mov_b32 m0, 0xc000
  s_nop 0
  buffer_load_dwordx4 v56, s[8:11], s36 offen nt lds
  s_waitcnt lgkmcnt(3)
  v_mfma_f32_32x32x16_bf16 v[128:143], a[144:147], v[80:83], v[128:143]
  buffer_load_dwordx4 v56, s[8:11], s36 offen offset:1024 nt lds
  buffer_load_dwordx4 v57, s[8:11], s36 offen offset:2048 nt lds
  s_waitcnt lgkmcnt(2)
  v_mfma_f32_32x32x16_bf16 v[128:143], a[148:151], v[84:87], v[128:143]
  buffer_load_dwordx4 v57, s[8:11], s36 offen offset:3072 nt lds
  s_mov_b32 m0, 0xd000
  s_nop 0
  buffer_load_dwordx4 v58, s[8:11], s36 offen nt lds
  s_waitcnt lgkmcnt(1)
  v_mfma_f32_32x32x16_bf16 v[128:143], a[152:155], v[88:91], v[128:143]
  buffer_load_dwordx4 v58, s[8:11], s36 offen offset:1024 nt lds
  buffer_load_dwordx4 v59, s[8:11], s36 offen offset:2048 nt lds
  s_waitcnt lgkmcnt(0)
  v_mfma_f32_32x32x16_bf16 v[128:143], a[156:159], v[92:95], v[128:143]
  buffer_load_dwordx4 v59, s[8:11], s36 offen offset:3072 nt lds
  s_add_u32 s36, s36, 0x2000
  s_waitcnt vmcnt(63)
  s_barrier
  s_nop 8
  v_exp_f32 v16, v128
  v_exp_f32 v17, v129
  ds_read_b64_tr_b16 a[160:161], v10
  v_exp_f32 v18, v130
  v_add_f32 v24, v16, v17
  ds_read_b64_tr_b16 a[162:163], v10 offset:2048
  v_cvt_pk_bf16_f32 v32, v16, v17
  v_exp_f32 v19, v131
  ds_read_b64_tr_b16 a[164:165], v11
  v_add_f32 v24, v24, v18
  v_exp_f32 v20, v132
  ds_read_b64_tr_b16 a[166:167], v11 offset:2048
  v_add_f32 v24, v24, v19
  v_cvt_pk_bf16_f32 v33, v18, v19
  ds_read_b64_tr_b16 a[168:169], v12
  v_exp_f32 v21, v133
  v_add_f32 v24, v24, v20
  ds_read_b64_tr_b16 a[170:171], v12 offset:2048
  v_exp_f32 v22, v134
  v_add_f32 v24, v24, v21
  ds_read_b64_tr_b16 a[172:173], v13
  v_cvt_pk_bf16_f32 v34, v20, v21
  v_exp_f32 v23, v135
  ds_read_b64_tr_b16 a[174:175], v13 offset:2048
  v_add_f32 v24, v24, v22
  v_exp_f32 v16, v136
  ds_read_b64_tr_b16 a[176:177], v10 offset:4096
  v_add_f32 v24, v24, v23
  v_cvt_pk_bf16_f32 v35, v22, v23
  ds_read_b64_tr_b16 a[178:179], v10 offset:6144
  v_exp_f32 v17, v137
  v_add_f32 v24, v24, v16
  ds_read_b64_tr_b16 a[180:181], v11 offset:4096
  v_exp_f32 v18, v138
  v_add_f32 v24, v24, v17
  ds_read_b64_tr_b16 a[182:183], v11 offset:6144
  v_cvt_pk_bf16_f32 v36, v16, v17
  v_exp_f32 v19, v139
  ds_read_b64_tr_b16 a[184:185], v12 offset:4096
  v_add_f32 v24, v24, v18
  v_exp_f32 v20, v140
  ds_read_b64_tr_b16 a[186:187], v12 offset:6144
  v_add_f32 v24, v24, v19
  v_cvt_pk_bf16_f32 v37, v18, v19
  ds_read_b64_tr_b16 a[188:189], v13 offset:4096
  v_exp_f32 v21, v141
  v_add_f32 v24, v24, v20
  ds_read_b64_tr_b16 a[190:191], v13 offset:6144
  v_exp_f32 v22, v142
  v_add_f32 v24, v24, v21
  v_cvt_pk_bf16_f32 v38, v20, v21
  v_exp_f32 v23, v143
  v_add_f32 v24, v24, v22
  v_add_f32 v24, v24, v23
  v_cvt_pk_bf16_f32 v39, v22, v23
  v_cmp_nge_f32 vcc, s42, v24
  s_nop 0
  s_cbranch_vccnz FBS_39
RET_39:
  v_add_f32 v26, v26, v24
  s_add_u32 s40, s40, 1
  s_cmp_lt_u32 s40, 3
  s_cbranch_scc1 A_LOOP1
  s_waitcnt lgkmcnt(14)
  v_mfma_f32_32x32x16_bf16 a[0:15], a[160:163], v[32:35], a[0:15]
  ds_read_b128 a[128:131], v2 offset:40960
  s_mov_b32 m0, 0x8000
  s_mov_b32 s66, 0x5a000
  buffer_load_dwordx4 v48, s[48:51], s66 offen lds
  s_waitcnt lgkmcnt(13)
  v_mfma_f32_32x32x16_bf16 a[16:31], a[164:167], v[32:35], a[16:31]
  ds_read_b128 a[132:135], v3 offset:40960
  buffer_load_dwordx4 v49, s[48:51], s66 offen offset:1024 lds
  s_mov_b32 m0, 0x8800
  s_mov_b32 s66, 0x5e800
  s_waitcnt lgkmcnt(12)
  v_mfma_f32_32x32x16_bf16 a[32:47], a[168:171], v[32:35], a[32:47]
  ds_read_b128 a[136:139], v4 offset:40960
  buffer_load_dwordx4 v48, s[48:51], s66 offen lds
  buffer_load_dwordx4 v49, s[48:51], s66 offen offset:1024 lds
  s_waitcnt lgkmcnt(11)
  v_mfma_f32_32x32x16_bf16 a[48:63], a[172:175], v[32:35], a[48:63]
  ds_read_b128 a[140:143], v5 offset:40960
  s_mov_b32 m0, 0x9000
  s_mov_b32 s66, 0x63000
  buffer_load_dwordx4 v48, s[48:51], s66 offen lds
  s_waitcnt lgkmcnt(10)
  v_mfma_f32_32x32x16_bf16 a[0:15], a[176:179], v[36:39], a[0:15]
  ds_read_b128 a[144:147], v6 offset:40960
  buffer_load_dwordx4 v49, s[48:51], s66 offen offset:1024 lds
  s_mov_b32 m0, 0x9800
  s_waitcnt lgkmcnt(9)
  v_mfma_f32_32x32x16_bf16 a[16:31], a[180:183], v[36:39], a[16:31]
  ds_read_b128 a[148:151], v7 offset:40960
  s_mov_b32 s66, 0x67800
  buffer_load_dwordx4 v48, s[48:51], s66 offen lds
  buffer_load_dwordx4 v49, s[48:51], s66 offen offset:1024 lds
  s_waitcnt lgkmcnt(8)
  v_mfma_f32_32x32x16_bf16 a[32:47], a[184:187], v[36:39], a[32:47]
  ds_read_b128 a[152:155], v8 offset:40960
  s_mov_b32 m0, 0x1c000
  s_nop 0
  buffer_load_dwordx4 v60, s[12:15], s37 offen nt lds
  s_waitcnt lgkmcnt(7)
  v_mfma_f32_32x32x16_bf16 a[48:63], a[188:191], v[36:39], a[48:63]
  ds_read_b128 a[156:159], v9 offset:40960
  buffer_load_dwordx4 v60, s[12:15], s37 offen offset:1024 nt lds
  buffer_load_dwordx4 v60, s[12:15], s37 offen offset:2048 nt lds
  s_waitcnt lgkmcnt(7)
  v_mfma_f32_32x32x16_bf16 v[128:143], a[128:131], v[64:67], v[160:175]
  buffer_load_dwordx4 v60, s[12:15], s37 offen offset:3072 nt lds
  s_mov_b32 m0, 0x1d000
  s_waitcnt lgkmcnt(6)
  v_mfma_f32_32x32x16_bf16 v[128:143], a[132:135], v[68:71], v[128:143]
  buffer_load_dwordx4 v61, s[12:15], s37 offen nt lds
  buffer_load_dwordx4 v61, s[12:15], s37 offen offset:1024 nt lds
  s_waitcnt lgkmcnt(5)
  v_mfma_f32_32x32x16_bf16 v[128:143], a[136:139], v[72:75], v[128:143]
  buffer_load_dwordx4 v61, s[12:15], s37 offen offset:2048 nt lds
  buffer_load_dwordx4 v61, s[12:15], s37 offen offset:3072 nt lds
  s_add_u32 s37, s37, 0x2000
  s_waitcnt lgkmcnt(4)
  v_mfma_f32_32x32x16_bf16 v[128:143], a[140:143], v[76:79], v[128:143]
  s_mov_b32 m0, 0x4000
  s_nop 0
  buffer_load_dwordx4 v56, s[8:11], s36 offen nt lds
  s_waitcnt lgkmcnt(3)
  v_mfma_f32_32x32x16_bf16 v[128:143], a[144:147], v[80:83], v[128:143]
  buffer_load_dwordx4 v56, s[8:11], s36 offen offset:1024 nt lds
  buffer_load_dwordx4 v57, s[8:11], s36 offen offset:2048 nt lds
  s_waitcnt lgkmcnt(2)
  v_mfma_f32_32x32x16_bf16 v[128:143], a[148:151], v[84:87], v[128:143]
  buffer_load_dwordx4 v57, s[8:11], s36 offen offset:3072 nt lds
  s_mov_b32 m0, 0x5000
  s_nop 0
  buffer_load_dwordx4 v58, s[8:11], s36 offen nt lds
  s_waitcnt lgkmcnt(1)
  v_mfma_f32_32x32x16_bf16 v[128:143], a[152:155], v[88:91], v[128:143]
  buffer_load_dwordx4 v58, s[8:11], s36 offen offset:1024 nt lds
  buffer_load_dwordx4 v59, s[8:11], s36 offen offset:2048 nt lds
  s_waitcnt lgkmcnt(0)
  v_mfma_f32_32x32x16_bf16 v[128:143], a[156:159], v[92:95], v[128:143]
  buffer_load_dwordx4 v59, s[8:11], s36 offen offset:3072 nt lds
  s_add_u32 s36, s36, 0x2000
  s_waitcnt vmcnt(63)
  s_barrier
  s_nop 8
  v_exp_f32 v16, v128
  v_exp_f32 v17, v129
  ds_read_b64_tr_b16 a[160:161], v10 offset:32768
  v_exp_f32 v18, v130
  v_add_f32 v24, v16, v17
  ds_read_b64_tr_b16 a[162:163], v10 offset:34816
  v_cvt_pk_bf16_f32 v32, v16, v17
  v_exp_f32 v19, v131
  ds_read_b64_tr_b16 a[164:165], v11 offset:32768
  v_add_f32 v24, v24, v18
  v_exp_f32 v20, v132
  ds_read_b64_tr_b16 a[166:167], v11 offset:34816
  v_add_f32 v24, v24, v19
  v_cvt_pk_bf16_f32 v33, v18, v19
  ds_read_b64_tr_b16 a[168:169], v12 offset:32768
  v_exp_f32 v21, v133
  v_add_f32 v24, v24, v20
  ds_read_b64_tr_b16 a[170:171], v12 offset:34816
  v_exp_f32 v22, v134
  v_add_f32 v24, v24, v21
  ds_read_b64_tr_b16 a[172:173], v13 offset:32768
  v_cvt_pk_bf16_f32 v34, v20, v21
  v_exp_f32 v23, v135
  ds_read_b64_tr_b16 a[174:175], v13 offset:34816
  v_add_f32 v24, v24, v22
  v_exp_f32 v16, v136
  ds_read_b64_tr_b16 a[176:177], v10 offset:36864
  v_add_f32 v24, v24, v23
  v_cvt_pk_bf16_f32 v35, v22, v23
  ds_read_b64_tr_b16 a[178:179], v10 offset:38912
  v_exp_f32 v17, v137
  v_add_f32 v24, v24, v16
  ds_read_b64_tr_b16 a[180:181], v11 offset:36864
  v_exp_f32 v18, v138
  v_add_f32 v24, v24, v17
  ds_read_b64_tr_b16 a[182:183], v11 offset:38912
  v_cvt_pk_bf16_f32 v36, v16, v17
  v_exp_f32 v19, v139
  ds_read_b64_tr_b16 a[184:185], v12 offset:36864
  v_add_f32 v24, v24, v18
  v_exp_f32 v20, v140
  ds_read_b64_tr_b16 a[186:187], v12 offset:38912
  v_add_f32 v24, v24, v19
  v_cvt_pk_bf16_f32 v37, v18, v19
  ds_read_b64_tr_b16 a[188:189], v13 offset:36864
  v_exp_f32 v21, v141
  v_add_f32 v24, v24, v20
  ds_read_b64_tr_b16 a[190:191], v13 offset:38912
  v_exp_f32 v22, v142
  v_add_f32 v24, v24, v21
  v_cvt_pk_bf16_f32 v38, v20, v21
  v_exp_f32 v23, v143
  v_add_f32 v24, v24, v22
  v_add_f32 v24, v24, v23
  v_cvt_pk_bf16_f32 v39, v22, v23
  v_cmp_nge_f32 vcc, s42, v24
  s_nop 0
  s_cbranch_vccnz FBS_40
RET_40:
  v_add_f32 v26, v26, v24
  s_waitcnt lgkmcnt(14)
  v_mfma_f32_32x32x16_bf16 a[0:15], a[160:163], v[32:35], a[0:15]
  ds_read_b128 a[128:131], v2
  s_mov_b32 m0, 0xa000
  s_mov_b32 s66, 0x17a000
  buffer_load_dwordx4 v48, s[48:51], s66 offen lds
  s_waitcnt lgkmcnt(13)
  v_mfma_f32_32x32x16_bf16 a[16:31], a[164:167], v[32:35], a[16:31]
  ds_read_b128 a[132:135], v3
  buffer_load_dwordx4 v49, s[48:51], s66 offen offset:1024 lds
  s_mov_b32 m0, 0xa800
  s_mov_b32 s66, 0x17e800
  s_waitcnt lgkmcnt(12)
  v_mfma_f32_32x32x16_bf16 a[32:47], a[168:171], v[32:35], a[32:47]
  ds_read_b128 a[136:139], v4
  buffer_load_dwordx4 v48, s[48:51], s66 offen lds
  buffer_load_dwordx4 v49, s[48:51], s66 offen offset:1024 lds
  s_waitcnt lgkmcnt(11)
  v_mfma_f32_32x32x16_bf16 a[48:63], a[172:175], v[32:35], a[48:63]
  ds_read_b128 a[140:143], v5
  s_mov_b32 m0, 0xb000
  s_mov_b32 s66, 0x183000
  buffer_load_dwordx4 v48, s[48:51], s66 offen lds
  s_waitcnt lgkmcnt(10)
  v_mfma_f32_32x32x16_bf16 a[0:15], a[176:179], v[36:39], a[0:15]
  ds_read_b128 a[144:147], v6
  buffer_load_dwordx4 v49, s[48:51], s66 offen offset:1024 lds
  s_mov_b32 m0, 0xb800
  s_waitcnt lgkmcnt(9)
  v_mfma_f32_32x32x16_bf16 a[16:31], a[180:183], v[36:39], a[16:31]
  ds_read_b128 a[148:151], v7
  s_mov_b32 s66, 0x187800
  buffer_load_dwordx4 v48, s[48:51], s66 offen lds
  buffer_load_dwordx4 v49, s[48:51], s66 offen offset:1024 lds
  s_waitcnt lgkmcnt(8)
  v_mfma_f32_32x32x16_bf16 a[32:47], a[184:187], v[36:39], a[32:47]
  ds_read_b128 a[152:155], v8
  s_mov_b32 m0, 0x1e000
  s_nop 0
  buffer_load_dwordx4 v60, s[12:15], s37 offen nt lds
  s_waitcnt lgkmcnt(7)
  v_mfma_f32_32x32x16_bf16 a[48:63], a[188:191], v[36:39], a[48:63]
  ds_read_b128 a[156:159], v9
  buffer_load_dwordx4 v60, s[12:15], s37 offen offset:1024 nt lds
  buffer_load_dwordx4 v60, s[12:15], s37 offen offset:2048 nt lds
  s_waitcnt lgkmcnt(7)
  v_mfma_f32_32x32x16_bf16 v[128:143], a[128:131], v[64:67], v[160:175]
  buffer_load_dwordx4 v60, s[12:15], s37 offen offset:3072 nt lds
  s_mov_b32 m0, 0x1f000
  s_waitcnt lgkmcnt(6)
  v_mfma_f32_32x32x16_bf16 v[128:143], a[132:135], v[68:71], v[128:143]
  buffer_load_dwordx4 v61, s[12:15], s37 offen nt lds
  buffer_load_dwordx4 v61, s[12:15], s37 offen offset:1024 nt lds
  s_waitcnt lgkmcnt(5)
  v_mfma_f32_32x32x16_bf16 v[128:143], a[136:139], v[72:75], v[128:143]
  buffer_load_dwordx4 v61, s[12:15], s37 offen offset:2048 nt lds
  buffer_load_dwordx4 v61, s[12:15], s37 offen offset:3072 nt lds
  s_add_u32 s37, s37, 0x2000
  s_waitcnt lgkmcnt(4)
  v_mfma_f32_32x32x16_bf16 v[128:143], a[140:143], v[76:79], v[128:143]
  s_mov_b32 m0, 0x6000
  s_nop 0
  buffer_load_dwordx4 v56, s[8:11], s36 offen nt lds
  s_waitcnt lgkmcnt(3)
  v_mfma_f32_32x32x16_bf16 v[128:143], a[144:147], v[80:83], v[128:143]
  buffer_load_dwordx4 v56, s[8:11], s36 offen offset:1024 nt lds
  buffer_load_dwordx4 v57, s[8:11], s36 offen offset:2048 nt lds
  s_waitcnt lgkmcnt(2)
  v_mfma_f32_32x32x16_bf16 v[128:143], a[148:151], v[84:87], v[128:143]
  buffer_load_dwordx4 v57, s[8:11], s36 offen offset:3072 nt lds
  s_mov_b32 m0, 0x7000
  s_nop 0
  buffer_load_dwordx4 v58, s[8:11], s36 offen nt lds
  s_waitcnt lgkmcnt(1)
  v_mfma_f32_32x32x16_bf16 v[128:143], a[152:155], v[88:91], v[128:143]
  buffer_load_dwordx4 v58, s[8:11], s36 offen offset:1024 nt lds
  buffer_load_dwordx4 v59, s[8:11], s36 offen offset:2048 nt lds
  s_waitcnt lgkmcnt(0)
  v_mfma_f32_32x32x16_bf16 v[128:143], a[156:159], v[92:95], v[128:143]
  buffer_load_dwordx4 v59, s[8:11], s36 offen offset:3072 nt lds
  s_add_u32 s36, s36, 0x2000
  s_waitcnt vmcnt(63)
  s_barrier
  s_nop 8
  v_exp_f32 v16, v128
  v_exp_f32 v17, v129
  ds_read_b64_tr_b16 a[160:161], v10 offset:40960
  v_exp_f32 v18, v130
  v_add_f32 v24, v16, v17
  ds_read_b64_tr_b16 a[162:163], v10 offset:43008
  v_cvt_pk_bf16_f32 v32, v16, v17
  v_exp_f32 v19, v131
  ds_read_b64_tr_b16 a[164:165], v11 offset:40960
  v_add_f32 v24, v24, v18
  v_exp_f32 v20, v132
  ds_read_b64_tr_b16 a[166:167], v11 offset:43008
  v_add_f32 v24, v24, v19
  v_cvt_pk_bf16_f32 v33, v18, v19
  ds_read_b64_tr_b16 a[168:169], v12 offset:40960
  v_exp_f32 v21, v133
  v_add_f32 v24, v24, v20
  ds_read_b64_tr_b16 a[170:171], v12 offset:43008
  v_exp_f32 v22, v134
  v_add_f32 v24, v24, v21
  ds_read_b64_tr_b16 a[172:173], v13 offset:40960
  v_cvt_pk_bf16_f32 v34, v20, v21
  v_exp_f32 v23, v135
  ds_read_b64_tr_b16 a[174:175], v13 offset:43008
  v_add_f32 v24, v24, v22
  v_exp_f32 v16, v136
  ds_read_b64_tr_b16 a[176:177], v10 offset:45056
  v_add_f32 v24, v24, v23
  v_cvt_pk_bf16_f32 v35, v22, v23
  ds_read_b64_tr_b16 a[178:179], v10 offset:47104
  v_exp_f32 v17, v137
  v_add_f32 v24, v24, v16
  ds_read_b64_tr_b16 a[180:181], v11 offset:45056
  v_exp_f32 v18, v138
  v_add_f32 v24, v24, v17
  ds_read_b64_tr_b16 a[182:183], v11 offset:47104
  v_cvt_pk_bf16_f32 v36, v16, v17
  v_exp_f32 v19, v139
  ds_read_b64_tr_b16 a[184:185], v12 offset:45056
  v_add_f32 v24, v24, v18
  v_exp_f32 v20, v140
  ds_read_b64_tr_b16 a[186:187], v12 offset:47104
  v_add_f32 v24, v24, v19
  v_cvt_pk_bf16_f32 v37, v18, v19
  ds_read_b64_tr_b16 a[188:189], v13 offset:45056
  v_exp_f32 v21, v141
  v_add_f32 v24, v24, v20
  ds_read_b64_tr_b16 a[190:191], v13 offset:47104
  v_exp_f32 v22, v142
  v_add_f32 v24, v24, v21
  v_cvt_pk_bf16_f32 v38, v20, v21
  v_exp_f32 v23, v143
  v_add_f32 v24, v24, v22
  v_add_f32 v24, v24, v23
  v_cvt_pk_bf16_f32 v39, v22, v23
  v_cmp_nge_f32 vcc, s42, v24
  s_nop 0
  s_cbranch_vccnz FBS_41
RET_41:
  v_add_f32 v26, v26, v24
  s_waitcnt lgkmcnt(14)
  v_mfma_f32_32x32x16_bf16 a[0:15], a[160:163], v[32:35], a[0:15]
  ds_read_b128 a[128:131], v2 offset:8192
  s_mov_b32 m0, 0
  s_mov_b32 s66, 0x29a000
  buffer_load_dwordx4 v48, s[48:51], s66 offen lds
  s_waitcnt lgkmcnt(13)
  v_mfma_f32_32x32x16_bf16 a[16:31], a[164:167], v[32:35], a[16:31]
  ds_read_b128 a[132:135], v3 offset:8192
  buffer_load_dwordx4 v49, s[48:51], s66 offen offset:1024 lds
  s_mov_b32 m0, 0x800
  s_mov_b32 s66, 0x29e800
  s_waitcnt lgkmcnt(12)
  v_mfma_f32_32x32x16_bf16 a[32:47], a[168:171], v[32:35], a[32:47]
  ds_read_b128 a[136:139], v4 offset:8192
  buffer_load_dwordx4 v48, s[48:51], s66 offen lds
  buffer_load_dwordx4 v49, s[48:51], s66 offen offset:1024 lds
  s_waitcnt lgkmcnt(11)
  v_mfma_f32_32x32x16_bf16 a[48:63], a[172:175], v[32:35], a[48:63]
  ds_read_b128 a[140:143], v5 offset:8192
  s_mov_b32 m0, 0x1000
  s_mov_b32 s66, 0x2a3000
  buffer_load_dwordx4 v48, s[48:51], s66 offen lds
  s_waitcnt lgkmcnt(10)
  v_mfma_f32_32x32x16_bf16 a[0:15], a[176:179], v[36:39], a[0:15]
  ds_read_b128 a[144:147], v6 offset:8192
  buffer_load_dwordx4 v49, s[48:51], s66 offen offset:1024 lds
  s_mov_b32 m0, 0x1800
  s_waitcnt lgkmcnt(9)
  v_mfma_f32_32x32x16_bf16 a[16:31], a[180:183], v[36:39], a[16:31]
  ds_read_b128 a[148:151], v7 offset:8192
  s_mov_b32 s66, 0x2a7800
  buffer_load_dwordx4 v48, s[48:51], s66 offen lds
  buffer_load_dwordx4 v49, s[48:51], s66 offen offset:1024 lds
  s_waitcnt lgkmcnt(8)
  v_mfma_f32_32x32x16_bf16 a[32:47], a[184:187], v[36:39], a[32:47]
  ds_read_b128 a[152:155], v8 offset:8192
  s_mov_b32 m0, 0x14000
  s_nop 0
  buffer_load_dwordx4 v60, s[12:15], s37 offen nt lds
  s_waitcnt lgkmcnt(7)
  v_mfma_f32_32x32x16_bf16 a[48:63], a[188:191], v[36:39], a[48:63]
  ds_read_b128 a[156:159], v9 offset:8192
  buffer_load_dwordx4 v60, s[12:15], s37 offen offset:1024 nt lds
  buffer_load_dwordx4 v60, s[12:15], s37 offen offset:2048 nt lds
  s_waitcnt lgkmcnt(7)
  v_mfma_f32_32x32x16_bf16 v[128:143], a[128:131], v[64:67], v[160:175]
  buffer_load_dwordx4 v60, s[12:15], s37 offen offset:3072 nt lds
  s_mov_b32 m0, 0x15000
  s_waitcnt lgkmcnt(6)
  v_mfma_f32_32x32x16_bf16 v[128:143], a[132:135], v[68:71], v[128:143]
  buffer_load_dwordx4 v61, s[12:15], s37 offen nt lds
  buffer_load_dwordx4 v61, s[12:15], s37 offen offset:1024 nt lds
  s_waitcnt lgkmcnt(5)
  v_mfma_f32_32x32x16_bf16 v[128:143], a[136:139], v[72:75], v[128:143]
  buffer_load_dwordx4 v61, s[12:15], s37 offen offset:2048 nt lds
  buffer_load_dwordx4 v61, s[12:15], s37 offen offset:3072 nt lds
  s_add_u32 s37, s37, 0x2000
  s_waitcnt lgkmcnt(4)
  v_mfma_f32_32x32x16_bf16 v[128:143], a[140:143], v[76:79], v[128:143]
  s_mov_b32 m0, 0xe000
  s_nop 0
  buffer_load_dwordx4 v56, s[8:11], s36 offen nt lds
  s_waitcnt lgkmcnt(3)
  v_mfma_f32_32x32x16_bf16 v[128:143], a[144:147], v[80:83], v[128:143]
  buffer_load_dwordx4 v56, s[8:11], s36 offen offset:1024 nt lds
  buffer_load_dwordx4 v57, s[8:11], s36 offen offset:2048 nt lds
  s_waitcnt lgkmcnt(2)
  v_mfma_f32_32x32x16_bf16 v[128:143], a[148:151], v[84:87], v[128:143]
  buffer_load_dwordx4 v57, s[8:11], s36 offen offset:3072 nt lds
  s_mov_b32 m0, 0xf000
  s_nop 0
  buffer_load_dwordx4 v58, s[8:11], s36 offen nt lds
  s_waitcnt lgkmcnt(1)
  v_mfma_f32_32x32x16_bf16 v[128:143], a[152:155], v[88:91], v[128:143]
  buffer_load_dwordx4 v58, s[8:11], s36 offen offset:1024 nt lds
  buffer_load_dwordx4 v59, s[8:11], s36 offen offset:2048 nt lds
  s_waitcnt lgkmcnt(0)
  v_mfma_f32_32x32x16_bf16 v[128:143], a[156:159], v[92:95], v[128:143]
  buffer_load_dwordx4 v59, s[8:11], s36 offen offset:3072 nt lds
  s_add_u32 s36, s36, 0x2000
  s_waitcnt vmcnt(63)
  s_barrier
  s_nop 8
  v_exp_f32 v16, v128
  v_exp_f32 v17, v129
  ds_read_b64_tr_b16 a[160:161], v10 offset:8192
  v_exp_f32 v18, v130
  v_add_f32 v24, v16, v17
  ds_read_b64_tr_b16 a[162:163], v10 offset:10240
  v_cvt_pk_bf16_f32 v32, v16, v17
  v_exp_f32 v19, v131
  ds_read_b64_tr_b16 a[164:165], v11 offset:8192
  v_add_f32 v24, v24, v18
  v_exp_f32 v20, v132
  ds_read_b64_tr_b16 a[166:167], v11 offset:10240
  v_add_f32 v24, v24, v19
  v_cvt_pk_bf16_f32 v33, v18, v19
  ds_read_b64_tr_b16 a[168:169], v12 offset:8192
  v_exp_f32 v21, v133
  v_add_f32 v24, v24, v20
  ds_read_b64_tr_b16 a[170:171], v12 offset:10240
  v_exp_f32 v22, v134
  v_add_f32 v24, v24, v21
  ds_read_b64_tr_b16 a[172:173], v13 offset:8192
  v_cvt_pk_bf16_f32 v34, v20, v21
  v_exp_f32 v23, v135
  ds_read_b64_tr_b16 a[174:175], v13 offset:10240
  v_add_f32 v24, v24, v22
  v_exp_f32 v16, v136
  ds_read_b64_tr_b16 a[176:177], v10 offset:12288
  v_add_f32 v24, v24, v23
  v_cvt_pk_bf16_f32 v35, v22, v23
  ds_read_b64_tr_b16 a[178:179], v10 offset:14336
  v_exp_f32 v17, v137
  v_add_f32 v24, v24, v16
  ds_read_b64_tr_b16 a[180:181], v11 offset:12288
  v_exp_f32 v18, v138
  v_add_f32 v24, v24, v17
  ds_read_b64_tr_b16 a[182:183], v11 offset:14336
  v_cvt_pk_bf16_f32 v36, v16, v17
  v_exp_f32 v19, v139
  ds_read_b64_tr_b16 a[184:185], v12 offset:12288
  v_add_f32 v24, v24, v18
  v_exp_f32 v20, v140
  ds_read_b64_tr_b16 a[186:187], v12 offset:14336
  v_add_f32 v24, v24, v19
  v_cvt_pk_bf16_f32 v37, v18, v19
  ds_read_b64_tr_b16 a[188:189], v13 offset:12288
  v_exp_f32 v21, v141
  v_add_f32 v24, v24, v20
  ds_read_b64_tr_b16 a[190:191], v13 offset:14336
  v_exp_f32 v22, v142
  v_add_f32 v24, v24, v21
  v_cvt_pk_bf16_f32 v38, v20, v21
  v_exp_f32 v23, v143
  v_add_f32 v24, v24, v22
  v_add_f32 v24, v24, v23
  v_cvt_pk_bf16_f32 v39, v22, v23
  v_cmp_nge_f32 vcc, s42, v24
  s_nop 0
  s_cbranch_vccnz FBS_42
RET_42:
  v_add_f32 v26, v26, v24
  s_waitcnt lgkmcnt(14)
  v_mfma_f32_32x32x16_bf16 a[0:15], a[160:163], v[32:35], a[0:15]
  ds_read_b128 a[128:131], v2 offset:49152
  s_mov_b32 m0, 0x2000
  s_mov_b32 s66, 0x3ba000
  buffer_load_dwordx4 v48, s[48:51], s66 offen lds
  buffer_load_dwordx4 v49, s[48:51], s66 offen offset:1024 lds
  s_waitcnt lgkmcnt(13)
  v_mfma_f32_32x32x16_bf16 a[16:31], a[164:167], v[32:35], a[16:31]
  s_branch PADO_11
PADA_11:
  s_branch HOPRET_g2
PAD_11:
  s_sub_u32 s40, s40, 1
  s_cbranch_scc1 HOPRET_gb
  s_branch PAD_13
PADO_11:
  ds_read_b128 a[132:135], v3 offset:49152
  s_mov_b32 m0, 0x2800
  s_mov_b32 s66, 0x3be800
  buffer_load_dwordx4 v48, s[48:51], s66 offen lds
  buffer_load_dwordx4 v49, s[48:51], s66 offen offset:1024 lds
  s_waitcnt lgkmcnt(12)
  v_mfma_f32_32x32x16_bf16 a[32:47], a[168:171], v[32:35], a[32:47]
  ds_read_b128 a[136:139], v4 offset:49152
  s_mov_b32 m0, 0x3000
  s_mov_b32 s66, 0x3c3000
  buffer_load_dwordx4 v48, s[48:51], s66 offen lds
  buffer_load_dwordx4 v49, s[48:51], s66 offen offset:1024 lds
  s_mov_b32 m0, 0x3800
  s_waitcnt lgkmcnt(11)
  v_mfma_f32_32x32x16_bf16 a[48:63], a[172:175], v[32:35], a[48:63]
  ds_read_b128 a[140:143], v5 offset:49152
  s_mov_b32 s66, 0x3c7800
  buffer_load_dwordx4 v48, s[48:51], s66 offen lds
  buffer_load_dwordx4 v49, s[48:51], s66 offen offset:1024 lds
  s_mov_b32 m0, 0x10000
  s_waitcnt lgkmcnt(10)
  v_mfma_f32_32x32x16_bf16 a[0:15], a[176:179], v[36:39], a[0:15]
  ds_read_b128 a[144:147], v6 offset:49152
  s_mov_b32 s66, 0x6c000
  buffer_load_dwordx4 v48, s[48:51], s66 offen lds
  buffer_load_dwordx4 v49, s[48:51], s66 offen offset:1024 lds
  s_mov_b32 m0, 0x10800
  s_waitcnt lgkmcnt(9)
  v_mfma_f32_32x32x16_bf16 a[16:31], a[180:183], v[36:39], a[16:31]
  ds_read_b128 a[148:151], v7 offset:49152
  s_mov_b32 s66, 0x70800
  buffer_load_dwordx4 v48, s[48:51], s66 offen lds
  buffer_load_dwordx4 v49, s[48:51], s66 offen offset:1024 lds
  s_mov_b32 m0, 0x11000
  s_waitcnt lgkmcnt(8)
  v_mfma_f32_32x32x16_bf16 a[32:47], a[184:187], v[36:39], a[32:47]
  ds_read_b128 a[152:155], v8 offset:49152
  s_mov_b32 s66, 0x75000
  buffer_load_dwordx4 v48, s[48:51], s66 offen lds
  buffer_load_dwordx4 v49, s[48:51], s66 offen offset:1024 lds
  s_mov_b32 m0, 0x11800
  s_mov_b32 s66, 0x79800
  s_waitcnt lgkmcnt(7)
  v_mfma_f32_32x32x16_bf16 a[48:63], a[188:191], v[36:39], a[48:63]
  ds_read_b128 a[156:159], v9 offset:49152
  buffer_load_dwordx4 v48, s[48:51], s66 offen lds
  buffer_load_dwordx4 v49, s[48:51], s66 offen offset:1024 lds
  s_mov_b32 m0, 0x16000
  s_waitcnt lgkmcnt(7)
  v_mfma_f32_32x32x16_bf16 v[128:143], a[128:131], v[64:67], v[160:175]
  buffer_load_dwordx4 v60, s[12:15], s37 offen nt lds
  buffer_load_dwordx4 v60, s[12:15], s37 offen offset:1024 nt lds
  buffer_load_dwordx4 v60, s[12:15], s37 offen offset:2048 nt lds
  buffer_load_dwordx4 v60, s[12:15], s37 offen offset:3072 nt lds
  s_waitcnt lgkmcnt(6)
  v_mfma_f32_32x32x16_bf16 v[128:143], a[132:135], v[68:71], v[128:143]
  ds_read_b64_tr_b16 a[224:225], v52
  ds_read_b64_tr_b16 a[226:227], v52 offset:512
  ds_read_b64_tr_b16 a[228:229], v53
  ds_read_b64_tr_b16 a[230:231], v53 offset:512
  ds_read_b64_tr_b16 a[232:233], v52 offset:2048
  ds_read_b64_tr_b16 a[234:235], v52 offset:2560
  ds_read_b64_tr_b16 a[236:237], v53 offset:2048
  ds_read_b64_tr_b16 a[238:239], v53 offset:2560
  ds_read_b64_tr_b16 a[240:241], v52 offset:4096
  ds_read_b64_tr_b16 a[242:243], v52 offset:4608
  ds_read_b64_tr_b16 a[244:245], v53 offset:4096
  ds_read_b64_tr_b16 a[246:247], v53 offset:4608
  ds_read_b64_tr_b16 a[248:249], v52 offset:6144
  ds_read_b64_tr_b16 a[250:251], v52 offset:6656
  ds_read_b64_tr_b16 a[252:253], v53 offset:6144
  ds_read_b64_tr_b16 a[254:255], v53 offset:6656
  s_mov_b32 m0, 0x17000
  s_nop 0
  buffer_load_dwordx4 v61, s[12:15], s37 offen nt lds
  buffer_load_dwordx4 v61, s[12:15], s37 offen offset:1024 nt lds
  s_waitcnt lgkmcnt(15)
  v_mfma_f32_32x32x16_bf16 v[128:143], a[136:139], v[72:75], v[128:143]
  buffer_load_dwordx4 v61, s[12:15], s37 offen offset:2048 nt lds
  buffer_load_dwordx4 v61, s[12:15], s37 offen offset:3072 nt lds
  s_add_u32 s37, s37, 0x2000
  buffer_load_dword v145, v144, s[48:51], s38 offen
  s_waitcnt lgkmcnt(15)
  v_mfma_f32_32x32x16_bf16 v[128:143], a[140:143], v[76:79], v[128:143]
  s_add_u32 s38, s38, 0x12000
  s_add_u32 s39, s39, 1
  s_cmp_eq_u32 s39, 7
  s_cselect_b32 s47, 0xa2000, 0
  s_cselect_b32 s39, 0, s39
  s_add_u32 s38, s38, s47
  s_waitcnt lgkmcnt(15)
  v_mfma_f32_32x32x16_bf16 v[128:143], a[144:147], v[80:83], v[128:143]
  s_cmp_ge_u32 s38, 0x480000
  s_cselect_b32 s47, 0x480000, 0
  s_sub_u32 s38, s38, s47
  buffer_load_dword v145, v144, s[48:51], s38 offen
  s_add_u32 s38, s38, 0x12000
  s_waitcnt lgkmcnt(15)
  v_mfma_f32_32x32x16_bf16 v[128:143], a[148:151], v[84:87], v[128:143]
  s_add_u32 s39, s39, 1
  s_cmp_eq_u32 s39, 7
  s_cselect_b32 s47, 0xa2000, 0
  s_cselect_b32 s39, 0, s39
  s_add_u32 s38, s38, s47
  s_cmp_ge_u32 s38, 0x480000
  s_waitcnt lgkmcnt(15)
  v_mfma_f32_32x32x16_bf16 v[128:143], a[152:155], v[88:91], v[128:143]
  s_cselect_b32 s47, 0x480000, 0
  s_sub_u32 s38, s38, s47
  buffer_load_dword v145, v144, s[48:51], s38 offen
  s_add_u32 s38, s38, 0x12000
  s_add_u32 s39, s39, 1
  s_cmp_eq_u32 s39, 7
  s_waitcnt lgkmcnt(15)
  v_mfma_f32_32x32x16_bf16 v[128:143], a[156:159], v[92:95], v[128:143]
  s_cselect_b32 s47, 0xa2000, 0
  s_cselect_b32 s39, 0, s39
  s_add_u32 s38, s38, s47
  s_cmp_ge_u32 s38, 0x480000
  s_cselect_b32 s47, 0x480000, 0
  s_sub_u32 s38, s38, s47
  s_waitcnt vmcnt(63) lgkmcnt(0)
  s_barrier
  s_nop 4
  v_exp_f32 v16, v128
  v_exp_f32 v17, v129
  ds_read_b64_tr_b16 a[160:161], v10 offset:49152
  v_exp_f32 v18, v130
  v_add_f32 v24, v16, v17
  ds_read_b64_tr_b16 a[162:163], v10 offset:51200
  v_cvt_pk_bf16_f32 v32, v16, v17
  v_exp_f32 v19, v131
  ds_read_b64_tr_b16 a[164:165], v11 offset:49152
  v_add_f32 v24, v24, v18
  v_exp_f32 v20, v132
  ds_read_b64_tr_b16 a[166:167], v11 offset:51200
  v_add_f32 v24, v24, v19
  v_cvt_pk_bf16_f32 v33, v18, v19
  ds_read_b64_tr_b16 a[168:169], v12 offset:49152
  v_exp_f32 v21, v133
  v_add_f32 v24, v24, v20
  ds_read_b64_tr_b16 a[170:171], v12 offset:51200
  v_exp_f32 v22, v134
  v_add_f32 v24, v24, v21
  ds_read_b64_tr_b16 a[172:173], v13 offset:49152
  v_cvt_pk_bf16_f32 v34, v20, v21
  v_exp_f32 v23, v135
  ds_read_b64_tr_b16 a[174:175], v13 offset:51200
  v_add_f32 v24, v24, v22
  v_exp_f32 v16, v136
  ds_read_b64_tr_b16 a[176:177], v10 offset:53248
  v_add_f32 v24, v24, v23
  v_cvt_pk_bf16_f32 v35, v22, v23
  ds_read_b64_tr_b16 a[178:179], v10 offset:55296
  v_exp_f32 v17, v137
  v_add_f32 v24, v24, v16
  ds_read_b64_tr_b16 a[180:181], v11 offset:53248
  v_exp_f32 v18, v138
  v_add_f32 v24, v24, v17
  ds_read_b64_tr_b16 a[182:183], v11 offset:55296
  v_cvt_pk_bf16_f32 v36, v16, v17
  v_exp_f32 v19, v139
  ds_read_b64_tr_b16 a[184:185], v12 offset:53248
  v_add_f32 v24, v24, v18
  v_exp_f32 v20, v140
  ds_read_b64_tr_b16 a[186:187], v12 offset:55296
  v_add_f32 v24, v24, v19
  v_cvt_pk_bf16_f32 v37, v18, v19
  ds_read_b64_tr_b16 a[188:189], v13 offset:53248
  v_exp_f32 v21, v141
  v_add_f32 v24, v24, v20
  ds_read_b64_tr_b16 a[190:191], v13 offset:55296
  v_exp_f32 v22, v142
  v_add_f32 v24, v24, v21
  v_cvt_pk_bf16_f32 v38, v20, v21
  v_exp_f32 v23, v143
  v_add_f32 v24, v24, v22
  v_add_f32 v24, v24, v23
  v_cvt_pk_bf16_f32 v39, v22, v23
  v_cmp_nge_f32 vcc, s42, v24
  s_nop 0
  s_cbranch_vccnz FBS_43
RET_43:
  v_add_f32 v26, v26, v24
  s_waitcnt lgkmcnt(14)
  v_mfma_f32_32x32x16_bf16 a[0:15], a[160:163], v[32:35], a[0:15]
  ds_read_b128 a[128:131], v2 offset:16384
  s_mov_b32 m0, 0x18000
  s_mov_b32 s66, 0x18c000
  buffer_load_dwordx4 v48, s[48:51], s66 offen lds
  buffer_load_dwordx4 v49, s[48:51], s66 offen offset:1024 lds
  s_mov_b32 m0, 0x18800
  s_mov_b32 s66, 0x190800
  s_waitcnt lgkmcnt(13)
  v_mfma_f32_32x32x16_bf16 a[16:31], a[164:167], v[32:35], a[16:31]
  ds_read_b128 a[132:135], v3 offset:16384
  buffer_load_dwordx4 v48, s[48:51], s66 offen lds
  buffer_load_dwordx4 v49, s[48:51], s66 offen offset:1024 lds
  s_mov_b32 m0, 0x19000
  s_mov_b32 s66, 0x195000
  buffer_load_dwordx4 v48, s[48:51], s66 offen lds
  s_waitcnt lgkmcnt(12)
  v_mfma_f32_32x32x16_bf16 a[32:47], a[168:171], v[32:35], a[32:47]
  ds_read_b128 a[136:139], v4 offset:16384
  buffer_load_dwordx4 v49, s[48:51], s66 offen offset:1024 lds
  s_mov_b32 m0, 0x19800
  s_mov_b32 s66, 0x199800
  buffer_load_dwordx4 v48, s[48:51], s66 offen lds
  buffer_load_dwordx4 v49, s[48:51], s66 offen offset:1024 lds
  s_waitcnt lgkmcnt(11)
  v_mfma_f32_32x32x16_bf16 a[48:63], a[172:175], v[32:35], a[48:63]
  ds_read_b128 a[140:143], v5 offset:16384
  s_mov_b32 m0, 0x1a000
  s_mov_b32 s66, 0x2ac000
  buffer_load_dwordx4 v48, s[48:51], s66 offen lds
  buffer_load_dwordx4 v49, s[48:51], s66 offen offset:1024 lds
  s_mov_b32 m0, 0x1a800
  s_mov_b32 s66, 0x2b0800
  s_waitcnt lgkmcnt(10)
  v_mfma_f32_32x32x16_bf16 a[0:15], a[176:179], v[36:39], a[0:15]
  ds_read_b128 a[144:147], v6 offset:16384
  buffer_load_dwordx4 v48, s[48:51], s66 offen lds
  buffer_load_dwordx4 v49, s[48:51], s66 offen offset:1024 lds
  s_mov_b32 m0, 0x1b000
  s_mov_b32 s66, 0x2b5000
  buffer_load_dwordx4 v48, s[48:51], s66 offen lds
  s_waitcnt lgkmcnt(9)
  v_mfma_f32_32x32x16_bf16 a[16:31], a[180:183], v[36:39], a[16:31]
  ds_read_b128 a[148:151], v7 offset:16384
  buffer_load_dwordx4 v49, s[48:51], s66 offen offset:1024 lds
  s_mov_b32 m0, 0x1b800
  s_mov_b32 s66, 0x2b9800
  buffer_load_dwordx4 v48, s[48:51], s66 offen lds
  buffer_load_dwordx4 v49, s[48:51], s66 offen offset:1024 lds
  s_waitcnt lgkmcnt(8)
  v_mfma_f32_32x32x16_bf16 a[32:47], a[184:187], v[36:39], a[32:47]
  ds_read_b128 a[152:155], v8 offset:16384
  s_mov_b32 m0, 0x20000
  s_mov_b32 s66, 0x48000
  buffer_load_dwordx4 v48, s[48:51], s66 offen lds
  buffer_load_dwordx4 v49, s[48:51], s66 offen offset:1024 lds
  s_mov_b32 m0, 0x20800
  s_mov_b32 s66, 0x4c800
  s_waitcnt lgkmcnt(7)
  v_mfma_f32_32x32x16_bf16 a[48:63], a[188:191], v[36:39], a[48:63]
  ds_read_b128 a[156:159], v9 offset:16384
  buffer_load_dwordx4 v48, s[48:51], s66 offen lds
  buffer_load_dwordx4 v49, s[48:51], s66 offen offset:1024 lds
  s_mov_b32 m0, 0x21000
  s_mov_b32 s66, 0x51000
  buffer_load_dwordx4 v48, s[48:51], s66 offen lds
  s_waitcnt lgkmcnt(7)
  v_mfma_f32_32x32x16_bf16 v[128:143], a[128:131], v[64:67], v[160:175]
  buffer_load_dwordx4 v49, s[48:51], s66 offen offset:1024 lds
  s_mov_b32 m0, 0x21800
  s_mov_b32 s66, 0x55800
  buffer_load_dwordx4 v48, s[48:51], s66 offen lds
  buffer_load_dwordx4 v49, s[48:51], s66 offen offset:1024 lds
  s_mov_b32 m0, 0x22000
  s_waitcnt lgkmcnt(6)
  v_mfma_f32_32x32x16_bf16 v[128:143], a[132:135], v[68:71], v[128:143]
  s_mov_b32 s66, 0x168000
  buffer_load_dwordx4 v48, s[48:51], s66 offen lds
  buffer_load_dwordx4 v49, s[48:51], s66 offen offset:1024 lds
  s_mov_b32 m0, 0x22800
  s_mov_b32 s66, 0x16c800
  s_waitcnt lgkmcnt(5)
  v_mfma_f32_32x32x16_bf16 v[128:143], a[136:139], v[72:75], v[128:143]
  buffer_load_dwordx4 v48, s[48:51], s66 offen lds
  buffer_load_dwordx4 v49, s[48:51], s66 offen offset:1024 lds
  s_mov_b32 m0, 0x23000
  s_mov_b32 s66, 0x171000
  buffer_load_dwordx4 v48, s[48:51], s66 offen lds
  s_waitcnt lgkmcnt(4)
  v_mfma_f32_32x32x16_bf16 v[128:143], a[140:143], v[76:79], v[128:143]
  buffer_load_dwordx4 v49, s[48:51], s66 offen offset:1024 lds
  s_mov_b32 m0, 0x23800
  s_mov_b32 s66, 0x175800
  buffer_load_dwordx4 v48, s[48:51], s66 offen lds
  buffer_load_dwordx4 v49, s[48:51], s66 offen offset:1024 lds
  s_waitcnt lgkmcnt(3)
  v_mfma_f32_32x32x16_bf16 v[128:143], a[144:147], v[80:83], v[128:143]
  buffer_load_dword v145, v144, s[48:51], s38 offen
  s_add_u32 s38, s38, 0x12000
  s_add_u32 s39, s39, 1
  s_cmp_eq_u32 s39, 7
  s_cselect_b32 s47, 0xa2000, 0
  s_cselect_b32 s39, 0, s39
  s_add_u32 s38, s38, s47
  s_cmp_ge_u32 s38, 0x480000
  s_waitcnt lgkmcnt(2)
  v_mfma_f32_32x32x16_bf16 v[128:143], a[148:151], v[84:87], v[128:143]
  s_cselect_b32 s47, 0x480000, 0
  s_sub_u32 s38, s38, s47
  buffer_load_dword v145, v144, s[48:51], s38 offen
  s_add_u32 s38, s38, 0x12000
  s_add_u32 s39, s39, 1
  s_cmp_eq_u32 s39, 7
  s_cselect_b32 s47, 0xa2000, 0
  s_waitcnt lgkmcnt(1)
  v_mfma_f32_32x32x16_bf16 v[128:143], a[152:155], v[88:91], v[128:143]
  s_cselect_b32 s39, 0, s39
  s_add_u32 s38, s38, s47
  s_cmp_ge_u32 s38, 0x480000
  s_cselect_b32 s47, 0x480000, 0
  s_sub_u32 s38, s38, s47
  buffer_load_dword v145, v144, s[48:51], s38 offen
  s_add_u32 s38, s38, 0x12000
  s_waitcnt lgkmcnt(0)
  v_mfma_f32_32x32x16_bf16 v[128:143], a[156:159], v[92:95], v[128:143]
  s_add_u32 s39, s39, 1
  s_cmp_eq_u32 s39, 7
  s_cselect_b32 s47, 0xa2000, 0
  s_cselect_b32 s39, 0, s39
  s_add_u32 s38, s38, s47
  s_cmp_ge_u32 s38, 0x480000
  s_cselect_b32 s47, 0x480000, 0
  s_sub_u32 s38, s38, s47
  s_waitcnt vmcnt(63)
  s_barrier
  s_nop 2
  v_exp_f32 v16, v128
  v_exp_f32 v17, v129
  ds_read_b64_tr_b16 a[160:161], v10 offset:57344
  v_exp_f32 v18, v130
  v_add_f32 v24, v16, v17
  ds_read_b64_tr_b16 a[162:163], v10 offset:59392
  v_cvt_pk_bf16_f32 v32, v16, v17
  v_exp_f32 v19, v131
  ds_read_b64_tr_b16 a[164:165], v11 offset:57344
  v_add_f32 v24, v24, v18
  v_exp_f32 v20, v132
  ds_read_b64_tr_b16 a[166:167], v11 offset:59392
  v_add_f32 v24, v24, v19
  v_cvt_pk_bf16_f32 v33, v18, v19
  ds_read_b64_tr_b16 a[168:169], v12 offset:57344
  v_exp_f32 v21, v133
  v_add_f32 v24, v24, v20
  ds_read_b64_tr_b16 a[170:171], v12 offset:59392
  v_exp_f32 v22, v134
  v_add_f32 v24, v24, v21
  ds_read_b64_tr_b16 a[172:173], v13 offset:57344
  v_cvt_pk_bf16_f32 v34, v20, v21
  v_exp_f32 v23, v135
  ds_read_b64_tr_b16 a[174:175], v13 offset:59392
  v_add_f32 v24, v24, v22
  v_exp_f32 v16, v136
  ds_read_b64_tr_b16 a[176:177], v10 offset:61440
  v_add_f32 v24, v24, v23
  v_cvt_pk_bf16_f32 v35, v22, v23
  ds_read_b64_tr_b16 a[178:179], v10 offset:63488
  v_exp_f32 v17, v137
  v_add_f32 v24, v24, v16
  ds_read_b64_tr_b16 a[180:181], v11 offset:61440
  v_exp_f32 v18, v138
  v_add_f32 v24, v24, v17
  ds_read_b64_tr_b16 a[182:183], v11 offset:63488
  v_cvt_pk_bf16_f32 v36, v16, v17
  v_exp_f32 v19, v139
  ds_read_b64_tr_b16 a[184:185], v12 offset:61440
  v_add_f32 v24, v24, v18
  v_exp_f32 v20, v140
  ds_read_b64_tr_b16 a[186:187], v12 offset:63488
  v_add_f32 v24, v24, v19
  v_cvt_pk_bf16_f32 v37, v18, v19
  ds_read_b64_tr_b16 a[188:189], v13 offset:61440
  v_exp_f32 v21, v141
  v_add_f32 v24, v24, v20
  ds_read_b64_tr_b16 a[190:191], v13 offset:63488
  v_exp_f32 v22, v142
  v_add_f32 v24, v24, v21
  v_cvt_pk_bf16_f32 v38, v20, v21
  v_exp_f32 v23, v143
  v_add_f32 v24, v24, v22
  v_add_f32 v24, v24, v23
  v_cvt_pk_bf16_f32 v39, v22, v23
  v_cmp_nge_f32 vcc, s42, v24
  s_nop 0
  s_cbranch_vccnz FBS_44
RET_44:
  v_add_f32 v26, v26, v24
  s_waitcnt lgkmcnt(14)
  v_mfma_f32_32x32x16_bf16 a[0:15], a[160:163], v[32:35], a[0:15]
  ds_read_b128 a[128:131], v2 offset:24576
  s_mov_b32 m0, 0x12000
  s_mov_b32 s66, 0x3cc000
  buffer_load_dwordx4 v48, s[48:51], s66 offen lds
  buffer_load_dwordx4 v49, s[48:51], s66 offen offset:1024 lds
  s_mov_b32 m0, 0x12800
  s_waitcnt lgkmcnt(13)
  v_mfma_f32_32x32x16_bf16 a[16:31], a[164:167], v[32:35], a[16:31]
  ds_read_b128 a[132:135], v3 offset:24576
  s_mov_b32 s66, 0x3d0800
  buffer_load_dwordx4 v48, s[48:51], s66 offen lds
  buffer_load_dwordx4 v49, s[48:51], s66 offen offset:1024 lds
  s_mov_b32 m0, 0x13000
  s_mov_b32 s66, 0x3d5000
  s_waitcnt lgkmcnt(12)
  v_mfma_f32_32x32x16_bf16 a[32:47], a[168:171], v[32:35], a[32:47]
  ds_read_b128 a[136:139], v4 offset:24576
  buffer_load_dwordx4 v48, s[48:51], s66 offen lds
  buffer_load_dwordx4 v49, s[48:51], s66 offen offset:1024 lds
  s_mov_b32 m0, 0x13800
  s_mov_b32 s66, 0x3d9800
  buffer_load_dwordx4 v48, s[48:51], s66 offen lds
  s_waitcnt lgkmcnt(11)
  v_mfma_f32_32x32x16_bf16 a[48:63], a[172:175], v[32:35], a[48:63]
  ds_read_b128 a[140:143], v5 offset:24576
  buffer_load_dwordx4 v49, s[48:51], s66 offen offset:1024 lds
  s_mov_b32 m0, 0x24000
  s_mov_b32 s66, 0x288000
  buffer_load_dwordx4 v48, s[48:51], s66 offen lds
  buffer_load_dwordx4 v49, s[48:51], s66 offen offset:1024 lds
  s_waitcnt lgkmcnt(10)
  v_mfma_f32_32x32x16_bf16 a[0:15], a[176:179], v[36:39], a[0:15]
  ds_read_b128 a[144:147], v6 offset:24576
  s_mov_b32 m0, 0x24800
  s_mov_b32 s66, 0x28c800
  buffer_load_dwordx4 v48, s[48:51], s66 offen lds
  buffer_load_dwordx4 v49, s[48:51], s66 offen offset:1024 lds
  s_mov_b32 m0, 0x25000
  s_waitcnt lgkmcnt(9)
  v_mfma_f32_32x32x16_bf16 a[16:31], a[180:183], v[36:39], a[16:31]
  ds_read_b128 a[148:151], v7 offset:24576
  s_mov_b32 s66, 0x291000
  buffer_load_dwordx4 v48, s[48:51], s66 offen lds
  buffer_load_dwordx4 v49, s[48:51], s66 offen offset:1024 lds
  s_mov_b32 m0, 0x25800
  s_mov_b32 s66, 0x295800
  s_waitcnt lgkmcnt(8)
  v_mfma_f32_32x32x16_bf16 a[32:47], a[184:187], v[36:39], a[32:47]
  ds_read_b128 a[152:155], v8 offset:24576
  buffer_load_dwordx4 v48, s[48:51], s66 offen lds
  buffer_load_dwordx4 v49, s[48:51], s66 offen offset:1024 lds
  s_mov_b32 m0, 0x26000
  s_mov_b32 s66, 0x3a8000
  buffer_load_dwordx4 v48, s[48:51], s66 offen lds
  s_waitcnt lgkmcnt(7)
  v_mfma_f32_32x32x16_bf16 a[48:63], a[188:191], v[36:39], a[48:63]
  ds_read_b128 a[156:159], v9 offset:24576
  buffer_load_dwordx4 v49, s[48:51], s66 offen offset:1024 lds
  s_mov_b32 m0, 0x26800
  s_mov_b32 s66, 0x3ac800
  buffer_load_dwordx4 v48, s[48:51], s66 offen lds
  s_waitcnt lgkmcnt(7)
  v_mfma_f32_32x32x16_bf16 v[128:143], a[128:131], v[64:67], v[160:175]
  buffer_load_dwordx4 v49, s[48:51], s66 offen offset:1024 lds
  s_mov_b32 m0, 0x27000
  s_mov_b32 s66, 0x3b1000
  buffer_load_dwordx4 v48, s[48:51], s66 offen lds
  buffer_load_dwordx4 v49, s[48:51], s66 offen offset:1024 lds
  s_waitcnt lgkmcnt(6)
  v_mfma_f32_32x32x16_bf16 v[128:143], a[132:135], v[68:71], v[128:143]
  s_mov_b32 m0, 0x27800
  s_mov_b32 s66, 0x3b5800
  buffer_load_dwordx4 v48, s[48:51], s66 offen lds
  buffer_load_dwordx4 v49, s[48:51], s66 offen offset:1024 lds
  s_mov_b32 m0, 0xc000
  s_mov_b32 s66, 0x7e000
  s_waitcnt lgkmcnt(5)
  v_mfma_f32_32x32x16_bf16 v[128:143], a[136:139], v[72:75], v[128:143]
  buffer_load_dwordx4 v48, s[48:51], s66 offen lds
  buffer_load_dwordx4 v49, s[48:51], s66 offen offset:1024 lds
  s_mov_b32 m0, 0xc800
  s_mov_b32 s66, 0x82800
  buffer_load_dwordx4 v48, s[48:51], s66 offen lds
  s_waitcnt lgkmcnt(4)
  v_mfma_f32_32x32x16_bf16 v[128:143], a[140:143], v[76:79], v[128:143]
  buffer_load_dwordx4 v49, s[48:51], s66 offen offset:1024 lds
  s_mov_b32 m0, 0xd000
  s_mov_b32 s66, 0x87000
  buffer_load_dwordx4 v48, s[48:51], s66 offen lds
  s_waitcnt lgkmcnt(3)
  v_mfma_f32_32x32x16_bf16 v[128:143], a[144:147], v[80:83], v[128:143]
  buffer_load_dwordx4 v49, s[48:51], s66 offen offset:1024 lds
  s_mov_b32 m0, 0xd800
  s_mov_b32 s66, 0x8b800
  buffer_load_dwordx4 v48, s[48:51], s66 offen lds
  buffer_load_dwordx4 v49, s[48:51], s66 offen offset:1024 lds
  s_waitcnt lgkmcnt(2)
  v_mfma_f32_32x32x16_bf16 v[128:143], a[148:151], v[84:87], v[128:143]
  buffer_load_dword v145, v144, s[48:51], s38 offen
  s_add_u32 s38, s38, 0x12000
  s_add_u32 s39, s39, 1
  s_cmp_eq_u32 s39, 7
  s_cselect_b32 s47, 0xa2000, 0
  s_cselect_b32 s39, 0, s39
  s_waitcnt lgkmcnt(1)
  v_mfma_f32_32x32x16_bf16 v[128:143], a[152:155], v[88:91], v[128:143]
  s_add_u32 s38, s38, s47
  s_cmp_ge_u32 s38, 0x480000
  s_cselect_b32 s47, 0x480000, 0
  s_sub_u32 s38, s38, s47
  buffer_load_dword v145, v146, s[48:51], s38 offen
  s_add_u32 s38, s38, 0x12000
  s_add_u32 s39, s39, 1
  s_waitcnt lgkmcnt(0)
  v_mfma_f32_32x32x16_bf16 v[128:143], a[156:159], v[92:95], v[128:143]
  s_cmp_eq_u32 s39, 7
  s_cselect_b32 s47, 0xa2000, 0
  s_cselect_b32 s39, 0, s39
  s_add_u32 s38, s38, s47
  s_cmp_ge_u32 s38, 0x480000
  s_cselect_b32 s47, 0x480000, 0
  s_sub_u32 s38, s38, s47
  s_waitcnt vmcnt(63)
  s_barrier
  s_nop 3
  v_exp_f32 v16, v128
  v_exp_f32 v17, v129
  ds_read_b64_tr_b16 a[160:161], v10 offset:16384
  v_exp_f32 v18, v130
  v_add_f32 v24, v16, v17
  ds_read_b64_tr_b16 a[162:163], v10 offset:18432
  v_cvt_pk_bf16_f32 v32, v16, v17
  v_exp_f32 v19, v131
  ds_read_b64_tr_b16 a[164:165], v11 offset:16384
  v_add_f32 v24, v24, v18
  v_exp_f32 v20, v132
  ds_read_b64_tr_b16 a[166:167], v11 offset:18432
  v_add_f32 v24, v24, v19
  v_cvt_pk_bf16_f32 v33, v18, v19
  ds_read_b64_tr_b16 a[168:169], v12 offset:16384
  v_exp_f32 v21, v133
  v_add_f32 v24, v24, v20
  ds_read_b64_tr_b16 a[170:171], v12 offset:18432
  v_exp_f32 v22, v134
  v_add_f32 v24, v24, v21
  ds_read_b64_tr_b16 a[172:173], v13 offset:16384
  v_cvt_pk_bf16_f32 v34, v20, v21
  v_exp_f32 v23, v135
  ds_read_b64_tr_b16 a[174:175], v13 offset:18432
  v_add_f32 v24, v24, v22
  v_exp_f32 v16, v136
  ds_read_b64_tr_b16 a[176:177], v10 offset:20480
  v_add_f32 v24, v24, v23
  v_cvt_pk_bf16_f32 v35, v22, v23
  ds_read_b64_tr_b16 a[178:179], v10 offset:22528
  v_exp_f32 v17, v137
  v_add_f32 v24, v24, v16
  ds_read_b64_tr_b16 a[180:181], v11 offset:20480
  v_exp_f32 v18, v138
  v_add_f32 v24, v24, v17
  ds_read_b64_tr_b16 a[182:183], v11 offset:22528
  v_cvt_pk_bf16_f32 v36, v16, v17
  v_exp_f32 v19, v139
  ds_read_b64_tr_b16 a[184:185], v12 offset:20480
  v_add_f32 v24, v24, v18
  v_exp_f32 v20, v140
  ds_read_b64_tr_b16 a[186:187], v12 offset:22528
  v_add_f32 v24, v24, v19
  v_cvt_pk_bf16_f32 v37, v18, v19
  ds_read_b64_tr_b16 a[188:189], v13 offset:20480
  v_exp_f32 v21, v141
  v_add_f32 v24, v24, v20
  ds_read_b64_tr_b16 a[190:191], v13 offset:22528
  v_exp_f32 v22, v142
  v_add_f32 v24, v24, v21
  v_cvt_pk_bf16_f32 v38, v20, v21
  v_exp_f32 v23, v143
  v_add_f32 v24, v24, v22
  v_add_f32 v24, v24, v23
  v_cvt_pk_bf16_f32 v39, v22, v23
  v_cmp_nge_f32 vcc, s42, v24
  s_nop 0
  s_cbranch_vccnz FBS_45
RET_45:
  v_add_f32 v26, v26, v24
  s_waitcnt lgkmcnt(14)
  v_mfma_f32_32x32x16_bf16 a[0:15], a[160:163], v[32:35], a[0:15]
  ds_read_b128 a[128:131], v2 offset:57344
  s_mov_b32 m0, 0x4000
  s_mov_b32 s66, 0x19e000
  buffer_load_dwordx4 v48, s[48:51], s66 offen lds
  buffer_load_dwordx4 v49, s[48:51], s66 offen offset:1024 lds
  s_mov_b32 m0, 0x4800
  s_waitcnt lgkmcnt(13)
  v_mfma_f32_32x32x16_bf16 a[16:31], a[164:167], v[32:35], a[16:31]
  ds_read_b128 a[132:135], v3 offset:57344
  s_mov_b32 s66, 0x1a2800
  buffer_load_dwordx4 v48, s[48:51], s66 offen lds
  buffer_load_dwordx4 v49, s[48:51], s66 offen offset:1024 lds
  s_mov_b32 m0, 0x5000
  s_mov_b32 s66, 0x1a7000
  s_waitcnt lgkmcnt(12)
  v_mfma_f32_32x32x16_bf16 a[32:47], a[168:171], v[32:35], a[32:47]
  ds_read_b128 a[136:139], v4 offset:57344
  buffer_load_dwordx4 v48, s[48:51], s66 offen lds
  buffer_load_dwordx4 v49, s[48:51], s66 offen offset:1024 lds
  s_mov_b32 m0, 0x5800
  s_mov_b32 s66, 0x1ab800
  buffer_load_dwordx4 v48, s[48:51], s66 offen lds
  s_waitcnt lgkmcnt(11)
  v_mfma_f32_32x32x16_bf16 a[48:63], a[172:175], v[32:35], a[48:63]
  ds_read_b128 a[140:143], v5 offset:57344
  buffer_load_dwordx4 v49, s[48:51], s66 offen offset:1024 lds
  s_mov_b32 m0, 0x6000
  s_mov_b32 s66, 0x2be000
  buffer_load_dwordx4 v48, s[48:51], s66 offen lds
  buffer_load_dwordx4 v49, s[48:51], s66 offen offset:1024 lds
  s_waitcnt lgkmcnt(10)
  v_mfma_f32_32x32x16_bf16 a[0:15], a[176:179], v[36:39], a[0:15]
  ds_read_b128 a[144:147], v6 offset:57344
  s_mov_b32 m0, 0x6800
  s_mov_b32 s66, 0x2c2800
  buffer_load_dwordx4 v48, s[48:51], s66 offen lds
  buffer_load_dwordx4 v49, s[48:51], s66 offen offset:1024 lds
  s_mov_b32 m0, 0x7000
  s_waitcnt lgkmcnt(9)
  v_mfma_f32_32x32x16_bf16 a[16:31], a[180:183], v[36:39], a[16:31]
  ds_read_b128 a[148:151], v7 offset:57344
  s_mov_b32 s66, 0x2c7000
  buffer_load_dwordx4 v48, s[48:51], s66 offen lds
  buffer_load_dwordx4 v49, s[48:51], s66 offen offset:1024 lds
  s_mov_b32 m0, 0x7800
  s_mov_b32 s66, 0x2cb800
  s_branch PADO_12
PADA_12:
  s_branch HOPRET_g2
PAD_12:
  s_sub_u32 s40, s40, 1
  s_cbranch_scc1 HOPRET_gb
  s_branch PAD_LF_TAIL
PADO_12:
  s_waitcnt lgkmcnt(8)
  v_mfma_f32_32x32x16_bf16 a[32:47], a[184:187], v[36:39], a[32:47]
  ds_read_b128 a[152:155], v8 offset:57344
  buffer_load_dwordx4 v48, s[48:51], s66 offen lds
  buffer_load_dwordx4 v49, s[48:51], s66 offen offset:1024 lds
  s_mov_b32 m0, 0x1c000
  s_mov_b32 s66, 0x90000
  buffer_load_dwordx4 v48, s[48:51], s66 offen lds
  s_waitcnt lgkmcnt(7)
  v_mfma_f32_32x32x16_bf16 a[48:63], a[188:191], v[36:39], a[48:63]
  ds_read_b128 a[156:159], v9 offset:57344
  buffer_load_dwordx4 v49, s[48:51], s66 offen offset:1024 lds
  s_mov_b32 m0, 0x1c800
  s_mov_b32 s66, 0x94800
  buffer_load_dwordx4 v48, s[48:51], s66 offen lds
  s_waitcnt lgkmcnt(7)
  v_mfma_f32_32x32x16_bf16 v[128:143], a[128:131], v[64:67], v[160:175]
  buffer_load_dwordx4 v49, s[48:51], s66 offen offset:1024 lds
  s_mov_b32 m0, 0x1d000
  s_mov_b32 s66, 0x99000
  buffer_load_dwordx4 v48, s[48:51], s66 offen lds
  buffer_load_dwordx4 v49, s[48:51], s66 offen offset:1024 lds
  s_waitcnt lgkmcnt(6)
  v_mfma_f32_32x32x16_bf16 v[128:143], a[132:135], v[68:71], v[128:143]
  s_mov_b32 m0, 0x1d800
  s_mov_b32 s66, 0x9d800
  buffer_load_dwordx4 v48, s[48:51], s66 offen lds
  buffer_load_dwordx4 v49, s[48:51], s66 offen offset:1024 lds
  s_mov_b32 m0, 0x1e000
  s_mov_b32 s66, 0x1b0000
  s_waitcnt lgkmcnt(5)
  v_mfma_f32_32x32x16_bf16 v[128:143], a[136:139], v[72:75], v[128:143]
  buffer_load_dwordx4 v48, s[48:51], s66 offen lds
  buffer_load_dwordx4 v49, s[48:51], s66 offen offset:1024 lds
  s_mov_b32 m0, 0x1e800
  s_mov_b32 s66, 0x1b4800
  buffer_load_dwordx4 v48, s[48:51], s66 offen lds
  s_waitcnt lgkmcnt(4)
  v_mfma_f32_32x32x16_bf16 v[128:143], a[140:143], v[76:79], v[128:143]
  buffer_load_dwordx4 v49, s[48:51], s66 offen offset:1024 lds
  s_mov_b32 m0, 0x1f000
  s_mov_b32 s66, 0x1b9000
  buffer_load_dwordx4 v48, s[48:51], s66 offen lds
  s_waitcnt lgkmcnt(3)
  v_mfma_f32_32x32x16_bf16 v[128:143], a[144:147], v[80:83], v[128:143]
  buffer_load_dwordx4 v49, s[48:51], s66 offen offset:1024 lds
  s_mov_b32 m0, 0x1f800
  s_mov_b32 s66, 0x1bd800
  buffer_load_dwordx4 v48, s[48:51], s66 offen lds
  buffer_load_dwordx4 v49, s[48:51], s66 offen offset:1024 lds
  s_waitcnt lgkmcnt(2)
  v_mfma_f32_32x32x16_bf16 v[128:143], a[148:151], v[84:87], v[128:143]
  buffer_load_dword v145, v146, s[48:51], s38 offen
  s_add_u32 s38, s38, 0x12000
  s_add_u32 s39, s39, 1
  s_cmp_eq_u32 s39, 7
  s_cselect_b32 s47, 0xa2000, 0
  s_cselect_b32 s39, 0, s39
  s_waitcnt lgkmcnt(1)
  v_mfma_f32_32x32x16_bf16 v[128:143], a[152:155], v[88:91], v[128:143]
  s_add_u32 s38, s38, s47
  s_cmp_ge_u32 s38, 0x480000
  s_cselect_b32 s47, 0x480000, 0
  s_sub_u32 s38, s38, s47
  buffer_load_dword v145, v146, s[48:51], s38 offen
  s_add_u32 s38, s38, 0x12000
  s_add_u32 s39, s39, 1
  s_waitcnt lgkmcnt(0)
  v_mfma_f32_32x32x16_bf16 v[128:143], a[156:159], v[92:95], v[128:143]
  s_cmp_eq_u32 s39, 7
  s_cselect_b32 s47, 0xa2000, 0
  s_cselect_b32 s39, 0, s39
  s_add_u32 s38, s38, s47
  s_cmp_ge_u32 s38, 0x480000
  s_cselect_b32 s47, 0x480000, 0
  s_sub_u32 s38, s38, s47
  s_waitcnt vmcnt(63)
  s_barrier
  s_mov_b32 m0, 0xe000
  s_mov_b32 s66, 0x3de000
  buffer_load_dwordx4 v48, s[48:51], s66 offen lds
  buffer_load_dwordx4 v49, s[48:51], s66 offen offset:1024 lds
  s_mov_b32 m0, 0xe800
  s_mov_b32 s66, 0x3e2800
  buffer_load_dwordx4 v48, s[48:51], s66 offen lds
  buffer_load_dwordx4 v49, s[48:51], s66 offen offset:1024 lds
  s_mov_b32 m0, 0xf000
  s_mov_b32 s66, 0x3e7000
  buffer_load_dwordx4 v48, s[48:51], s66 offen lds
  buffer_load_dwordx4 v49, s[48:51], s66 offen offset:1024 lds
  s_mov_b32 m0, 0xf800
  s_mov_b32 s66, 0x3eb800
  buffer_load_dwordx4 v48, s[48:51], s66 offen lds
  buffer_load_dwordx4 v49, s[48:51], s66 offen offset:1024 lds
  s_mov_b32 m0, 0x14000
  s_mov_b32 s66, 0x2d0000
  buffer_load_dwordx4 v48, s[48:51], s66 offen lds
  buffer_load_dwordx4 v49, s[48:51], s66 offen offset:1024 lds
  s_mov_b32 m0, 0x14800
  s_mov_b32 s66, 0x2d4800
  buffer_load_dwordx4 v48, s[48:51], s66 offen lds
  buffer_load_dwordx4 v49, s[48:51], s66 offen offset:1024 lds
  s_mov_b32 m0, 0x15000
  s_mov_b32 s66, 0x2d9000
  buffer_load_dwordx4 v48, s[48:51], s66 offen lds
  buffer_load_dwordx4 v49, s[48:51], s66 offen offset:1024 lds
  s_mov_b32 m0, 0x15800
  s_mov_b32 s66, 0x2dd800
  buffer_load_dwordx4 v48, s[48:51], s66 offen lds
  buffer_load_dwordx4 v49, s[48:51], s66 offen offset:1024 lds
  v_exp_f32 v16, v128
  v_exp_f32 v17, v129
  ds_read_b64_tr_b16 a[160:161], v10 offset:24576
  v_exp_f32 v18, v130
  v_add_f32 v24, v16, v17
  ds_read_b64_tr_b16 a[162:163], v10 offset:26624
  v_cvt_pk_bf16_f32 v32, v16, v17
  v_exp_f32 v19, v131
  ds_read_b64_tr_b16 a[164:165], v11 offset:24576
  v_add_f32 v24, v24, v18
  v_exp_f32 v20, v132
  ds_read_b64_tr_b16 a[166:167], v11 offset:26624
  v_add_f32 v24, v24, v19
  v_cvt_pk_bf16_f32 v33, v18, v19
  ds_read_b64_tr_b16 a[168:169], v12 offset:24576
  v_exp_f32 v21, v133
  v_add_f32 v24, v24, v20
  ds_read_b64_tr_b16 a[170:171], v12 offset:26624
  v_exp_f32 v22, v134
  v_add_f32 v24, v24, v21
  ds_read_b64_tr_b16 a[172:173], v13 offset:24576
  v_cvt_pk_bf16_f32 v34, v20, v21
  v_exp_f32 v23, v135
  ds_read_b64_tr_b16 a[174:175], v13 offset:26624
  v_add_f32 v24, v24, v22
  v_exp_f32 v16, v136
  ds_read_b64_tr_b16 a[176:177], v10 offset:28672
  v_add_f32 v24, v24, v23
  v_cvt_pk_bf16_f32 v35, v22, v23
  ds_read_b64_tr_b16 a[178:179], v10 offset:30720
  v_exp_f32 v17, v137
  v_add_f32 v24, v24, v16
  ds_read_b64_tr_b16 a[180:181], v11 offset:28672
  v_exp_f32 v18, v138
  v_add_f32 v24, v24, v17
  ds_read_b64_tr_b16 a[182:183], v11 offset:30720
  v_cvt_pk_bf16_f32 v36, v16, v17
  v_exp_f32 v19, v139
  ds_read_b64_tr_b16 a[184:185], v12 offset:28672
  v_add_f32 v24, v24, v18
  v_exp_f32 v20, v140
  ds_read_b64_tr_b16 a[186:187], v12 offset:30720
  v_add_f32 v24, v24, v19
  v_cvt_pk_bf16_f32 v37, v18, v19
  ds_read_b64_tr_b16 a[188:189], v13 offset:28672
  v_exp_f32 v21, v141
  v_add_f32 v24, v24, v20
  ds_read_b64_tr_b16 a[190:191], v13 offset:30720
  v_exp_f32 v22, v142
  v_add_f32 v24, v24, v21
  v_cvt_pk_bf16_f32 v38, v20, v21
  v_exp_f32 v23, v143
  v_add_f32 v24, v24, v22
  v_add_f32 v24, v24, v23
  v_cvt_pk_bf16_f32 v39, v22, v23
  v_cmp_nge_f32 vcc, s42, v24
  s_nop 0
  s_cbranch_vccnz FBS_46
RET_46:
  v_add_f32 v26, v26, v24
  s_waitcnt lgkmcnt(0)
  s_barrier
  v_lshlrev_b32 v14, 4, v0
  v_add_u32 v15, 0x1000, v14
  s_mov_b32 m0, 0x16000
  s_mov_b32 s66, 0x3f0000
  buffer_load_dwordx4 v48, s[48:51], s66 offen lds
  buffer_load_dwordx4 v49, s[48:51], s66 offen offset:1024 lds
  s_mov_b32 m0, 0x16800
  s_mov_b32 s66, 0x3f4800
  buffer_load_dwordx4 v48, s[48:51], s66 offen lds
  buffer_load_dwordx4 v49, s[48:51], s66 offen offset:1024 lds
  s_mov_b32 m0, 0x17000
  s_mov_b32 s66, 0x3f9000
  buffer_load_dwordx4 v48, s[48:51], s66 offen lds
  buffer_load_dwordx4 v49, s[48:51], s66 offen offset:1024 lds
  s_mov_b32 m0, 0x17800
  s_mov_b32 s66, 0x3fd800
  buffer_load_dwordx4 v48, s[48:51], s66 offen lds
  buffer_load_dwordx4 v49, s[48:51], s66 offen offset:1024 lds
  v_mfma_f32_32x32x16_bf16 a[0:15], a[160:163], v[32:35], a[0:15]
  v_mfma_f32_32x32x16_bf16 a[16:31], a[164:167], v[32:35], a[16:31]
  v_mfma_f32_32x32x16_bf16 a[32:47], a[168:171], v[32:35], a[32:47]
  v_mfma_f32_32x32x16_bf16 a[48:63], a[172:175], v[32:35], a[48:63]
  v_mfma_f32_32x32x16_bf16 a[0:15], a[176:179], v[36:39], a[0:15]
  v_mfma_f32_32x32x16_bf16 a[16:31], a[180:183], v[36:39], a[16:31]
  v_mfma_f32_32x32x16_bf16 a[32:47], a[184:187], v[36:39], a[32:47]
  v_mfma_f32_32x32x16_bf16 a[48:63], a[188:191], v[36:39], a[48:63]
  v_mov_b32 v29, v26
  v_mov_b32 v28, v26
  s_nop 1
  v_permlane32_swap_b32 v28, v29
  v_add_f32 v28, v28, v29
  v_rcp_f32 v28, v28
  s_mov_b32 s44, 0x180000
  v_accvgpr_read_b32 v128, a0
  v_accvgpr_read_b32 v129, a1
  v_accvgpr_read_b32 v130, a2
  v_accvgpr_read_b32 v131, a3
  v_accvgpr_read_b32 v132, a4
  v_accvgpr_read_b32 v133, a5
  v_accvgpr_read_b32 v134, a6
  v_accvgpr_read_b32 v135, a7
  v_pk_mul_f32 v[128:129], v[128:129], v[28:29] op_sel_hi:[1,0]
  v_pk_mul_f32 v[130:131], v[130:131], v[28:29] op_sel_hi:[1,0]
  v_pk_mul_f32 v[132:133], v[132:133], v[28:29] op_sel_hi:[1,0]
  v_pk_mul_f32 v[134:135], v[134:135], v[28:29] op_sel_hi:[1,0]
  v_cvt_pk_bf16_f32 v160, v128, v129
  v_cvt_pk_bf16_f32 v161, v130, v131
  v_cvt_pk_bf16_f32 v162, v132, v133
  v_cvt_pk_bf16_f32 v163, v134, v135
  buffer_store_dwordx4 v[160:163], v14, s[24:27], s44 offen sc1
  v_accvgpr_read_b32 v136, a8
  v_accvgpr_read_b32 v137, a9
  v_accvgpr_read_b32 v138, a10
  v_accvgpr_read_b32 v139, a11
  v_accvgpr_read_b32 v140, a12
  v_accvgpr_read_b32 v141, a13
  v_accvgpr_read_b32 v142, a14
  v_accvgpr_read_b32 v143, a15
  v_pk_mul_f32 v[136:137], v[136:137], v[28:29] op_sel_hi:[1,0]
  v_pk_mul_f32 v[138:139], v[138:139], v[28:29] op_sel_hi:[1,0]
  v_pk_mul_f32 v[140:141], v[140:141], v[28:29] op_sel_hi:[1,0]
  v_pk_mul_f32 v[142:143], v[142:143], v[28:29] op_sel_hi:[1,0]
  v_cvt_pk_bf16_f32 v164, v136, v137
  v_cvt_pk_bf16_f32 v165, v138, v139
  v_cvt_pk_bf16_f32 v166, v140, v141
  v_cvt_pk_bf16_f32 v167, v142, v143
  buffer_store_dwordx4 v[164:167], v14, s[24:27], s44 offen offset:1024 sc1
  v_accvgpr_read_b32 v128, a16
  v_accvgpr_read_b32 v129, a17
  v_accvgpr_read_b32 v130, a18
  v_accvgpr_read_b32 v131, a19
  v_accvgpr_read_b32 v132, a20
  v_accvgpr_read_b32 v133, a21
  v_accvgpr_read_b32 v134, a22
  v_accvgpr_read_b32 v135, a23
  v_pk_mul_f32 v[128:129], v[128:129], v[28:29] op_sel_hi:[1,0]
  v_pk_mul_f32 v[130:131], v[130:131], v[28:29] op_sel_hi:[1,0]
  v_pk_mul_f32 v[132:133], v[132:133], v[28:29] op_sel_hi:[1,0]
  v_pk_mul_f32 v[134:135], v[134:135], v[28:29] op_sel_hi:[1,0]
  v_cvt_pk_bf16_f32 v168, v128, v129
  v_cvt_pk_bf16_f32 v169, v130, v131
  v_cvt_pk_bf16_f32 v170, v132, v133
  v_cvt_pk_bf16_f32 v171, v134, v135
  buffer_store_dwordx4 v[168:171], v14, s[24:27], s44 offen offset:2048 sc1
  v_accvgpr_read_b32 v136, a24
  v_accvgpr_read_b32 v137, a25
  v_accvgpr_read_b32 v138, a26
  v_accvgpr_read_b32 v139, a27
  v_accvgpr_read_b32 v140, a28
  v_accvgpr_read_b32 v141, a29
  v_accvgpr_read_b32 v142, a30
  v_accvgpr_read_b32 v143, a31
  v_pk_mul_f32 v[136:137], v[136:137], v[28:29] op_sel_hi:[1,0]
  v_pk_mul_f32 v[138:139], v[138:139], v[28:29] op_sel_hi:[1,0]
  v_pk_mul_f32 v[140:141], v[140:141], v[28:29] op_sel_hi:[1,0]
  v_pk_mul_f32 v[142:143], v[142:143], v[28:29] op_sel_hi:[1,0]
  v_cvt_pk_bf16_f32 v172, v136, v137
  v_cvt_pk_bf16_f32 v173, v138, v139
  v_cvt_pk_bf16_f32 v174, v140, v141
  v_cvt_pk_bf16_f32 v175, v142, v143
  buffer_store_dwordx4 v[172:175], v14, s[24:27], s44 offen offset:3072 sc1
  v_accvgpr_read_b32 v128, a32
  v_accvgpr_read_b32 v129, a33
  v_accvgpr_read_b32 v130, a34
  v_accvgpr_read_b32 v131, a35
  v_accvgpr_read_b32 v132, a36
  v_accvgpr_read_b32 v133, a37
  v_accvgpr_read_b32 v134, a38
  v_accvgpr_read_b32 v135, a39
  v_pk_mul_f32 v[128:129], v[128:129], v[28:29] op_sel_hi:[1,0]
  v_pk_mul_f32 v[130:131], v[130:131], v[28:29] op_sel_hi:[1,0]
  v_pk_mul_f32 v[132:133], v[132:133], v[28:29] op_sel_hi:[1,0]
  v_pk_mul_f32 v[134:135], v[134:135], v[28:29] op_sel_hi:[1,0]
  v_cvt_pk_bf16_f32 v160, v128, v129
  v_cvt_pk_bf16_f32 v161, v130, v131
  v_cvt_pk_bf16_f32 v162, v132, v133
  v_cvt_pk_bf16_f32 v163, v134, v135
  buffer_store_dwordx4 v[160:163], v15, s[24:27], s44 offen sc1
  v_accvgpr_read_b32 v136, a40
  v_accvgpr_read_b32 v137, a41
  v_accvgpr_read_b32 v138, a42
  v_accvgpr_read_b32 v139, a43
  v_accvgpr_read_b32 v140, a44
  v_accvgpr_read_b32 v141, a45
  v_accvgpr_read_b32 v142, a46
  v_accvgpr_read_b32 v143, a47
  v_pk_mul_f32 v[136:137], v[136:137], v[28:29] op_sel_hi:[1,0]
  v_pk_mul_f32 v[138:139], v[138:139], v[28:29] op_sel_hi:[1,0]
  v_pk_mul_f32 v[140:141], v[140:141], v[28:29] op_sel_hi:[1,0]
  v_pk_mul_f32 v[142:143], v[142:143], v[28:29] op_sel_hi:[1,0]
  v_cvt_pk_bf16_f32 v164, v136, v137
  v_cvt_pk_bf16_f32 v165, v138, v139
  v_cvt_pk_bf16_f32 v166, v140, v141
  v_cvt_pk_bf16_f32 v167, v142, v143
  buffer_store_dwordx4 v[164:167], v15, s[24:27], s44 offen offset:1024 sc1
  v_accvgpr_read_b32 v128, a48
  v_accvgpr_read_b32 v129, a49
  v_accvgpr_read_b32 v130, a50
  v_accvgpr_read_b32 v131, a51
  v_accvgpr_read_b32 v132, a52
  v_accvgpr_read_b32 v133, a53
  v_accvgpr_read_b32 v134, a54
  v_accvgpr_read_b32 v135, a55
  v_pk_mul_f32 v[128:129], v[128:129], v[28:29] op_sel_hi:[1,0]
  v_pk_mul_f32 v[130:131], v[130:131], v[28:29] op_sel_hi:[1,0]
  v_pk_mul_f32 v[132:133], v[132:133], v[28:29] op_sel_hi:[1,0]
  v_pk_mul_f32 v[134:135], v[134:135], v[28:29] op_sel_hi:[1,0]
  v_cvt_pk_bf16_f32 v168, v128, v129
  v_cvt_pk_bf16_f32 v169, v130, v131
  v_cvt_pk_bf16_f32 v170, v132, v133
  v_cvt_pk_bf16_f32 v171, v134, v135
  buffer_store_dwordx4 v[168:171], v15, s[24:27], s44 offen offset:2048 sc1
  v_accvgpr_read_b32 v136, a56
  v_accvgpr_read_b32 v137, a57
  v_accvgpr_read_b32 v138, a58
  v_accvgpr_read_b32 v139, a59
  v_accvgpr_read_b32 v140, a60
  v_accvgpr_read_b32 v141, a61
  v_accvgpr_read_b32 v142, a62
  v_accvgpr_read_b32 v143, a63
  v_pk_mul_f32 v[136:137], v[136:137], v[28:29] op_sel_hi:[1,0]
  v_pk_mul_f32 v[138:139], v[138:139], v[28:29] op_sel_hi:[1,0]
  v_pk_mul_f32 v[140:141], v[140:141], v[28:29] op_sel_hi:[1,0]
  v_pk_mul_f32 v[142:143], v[142:143], v[28:29] op_sel_hi:[1,0]
  v_cvt_pk_bf16_f32 v172, v136, v137
  v_cvt_pk_bf16_f32 v173, v138, v139
  v_cvt_pk_bf16_f32 v174, v140, v141
  v_cvt_pk_bf16_f32 v175, v142, v143
  buffer_store_dwordx4 v[172:175], v15, s[24:27], s44 offen offset:3072 sc1
  v_add_u32 v2, s60, v50
  v_add_u32 v3, s60, v51
  v_add_u32 v4, s61, v50
  v_add_u32 v5, s61, v51
  v_add_u32 v6, s62, v50
  v_add_u32 v7, s62, v51
  v_add_u32 v8, s63, v50
  v_add_u32 v9, s63, v51
  v_add_u32 v10, s64, v50
  v_add_u32 v11, s64, v51
  v_mov_b32 v12, v48
  v_mov_b32 v13, v49
  s_waitcnt vmcnt(8)
  s_barrier
  ds_read_b64_tr_b16 v[64:65], v2
  ds_read_b64_tr_b16 v[66:67], v2 offset:512
  ds_read_b64_tr_b16 v[68:69], v3
  ds_read_b64_tr_b16 v[70:71], v3 offset:512
  ds_read_b64_tr_b16 v[72:73], v2 offset:2048
  ds_read_b64_tr_b16 v[74:75], v2 offset:2560
  ds_read_b64_tr_b16 v[76:77], v3 offset:2048
  ds_read_b64_tr_b16 v[78:79], v3 offset:2560
  ds_read_b64_tr_b16 v[80:81], v2 offset:4096
  ds_read_b64_tr_b16 v[82:83], v2 offset:4608
  ds_read_b64_tr_b16 v[84:85], v3 offset:4096
  ds_read_b64_tr_b16 v[86:87], v3 offset:4608
  ds_read_b64_tr_b16 v[88:89], v2 offset:6144
  ds_read_b64_tr_b16 v[90:91], v2 offset:6656
  ds_read_b64_tr_b16 v[92:93], v3 offset:6144
  ds_read_b64_tr_b16 v[94:95], v3 offset:6656
  ds_read_b64_tr_b16 v[96:97], v4
  ds_read_b64_tr_b16 v[98:99], v4 offset:512
  ds_read_b64_tr_b16 v[100:101], v5
  ds_read_b64_tr_b16 v[102:103], v5 offset:512
  ds_read_b64_tr_b16 v[104:105], v4 offset:2048
  ds_read_b64_tr_b16 v[106:107], v4 offset:2560
  ds_read_b64_tr_b16 v[108:109], v5 offset:2048
  ds_read_b64_tr_b16 v[110:111], v5 offset:2560
  ds_read_b64_tr_b16 v[112:113], v4 offset:4096
  ds_read_b64_tr_b16 v[114:115], v4 offset:4608
  ds_read_b64_tr_b16 v[116:117], v5 offset:4096
  ds_read_b64_tr_b16 v[118:119], v5 offset:4608
  ds_read_b64_tr_b16 v[120:121], v4 offset:6144
  ds_read_b64_tr_b16 v[122:123], v4 offset:6656
  ds_read_b64_tr_b16 v[124:125], v5 offset:6144
  ds_read_b64_tr_b16 v[126:127], v5 offset:6656
  ds_read_b64_tr_b16 a[128:129], v6
  ds_read_b64_tr_b16 a[130:131], v6 offset:512
  ds_read_b64_tr_b16 a[132:133], v7
  ds_read_b64_tr_b16 a[134:135], v7 offset:512
  ds_read_b64_tr_b16 a[136:137], v6 offset:2048
  ds_read_b64_tr_b16 a[138:139], v6 offset:2560
  ds_read_b64_tr_b16 a[140:141], v7 offset:2048
  ds_read_b64_tr_b16 a[142:143], v7 offset:2560
  ds_read_b64_tr_b16 a[144:145], v6 offset:4096
  ds_read_b64_tr_b16 a[146:147], v6 offset:4608
  ds_read_b64_tr_b16 a[148:149], v7 offset:4096
  ds_read_b64_tr_b16 a[150:151], v7 offset:4608
  ds_read_b64_tr_b16 a[152:153], v6 offset:6144
  ds_read_b64_tr_b16 a[154:155], v6 offset:6656
  ds_read_b64_tr_b16 a[156:157], v7 offset:6144
  ds_read_b64_tr_b16 a[158:159], v7 offset:6656
  ds_read_b64_tr_b16 a[160:161], v8
  ds_read_b64_tr_b16 a[162:163], v8 offset:512
  ds_read_b64_tr_b16 a[164:165], v9
  ds_read_b64_tr_b16 a[166:167], v9 offset:512
  ds_read_b64_tr_b16 a[168:169], v8 offset:2048
  ds_read_b64_tr_b16 a[170:171], v8 offset:2560
  ds_read_b64_tr_b16 a[172:173], v9 offset:2048
  ds_read_b64_tr_b16 a[174:175], v9 offset:2560
  ds_read_b64_tr_b16 a[176:177], v8 offset:4096
  ds_read_b64_tr_b16 a[178:179], v8 offset:4608
  ds_read_b64_tr_b16 a[180:181], v9 offset:4096
  ds_read_b64_tr_b16 a[182:183], v9 offset:4608
  ds_read_b64_tr_b16 a[184:185], v8 offset:6144
  ds_read_b64_tr_b16 a[186:187], v8 offset:6656
  ds_read_b64_tr_b16 a[188:189], v9 offset:6144
  ds_read_b64_tr_b16 a[190:191], v9 offset:6656
  ds_read_b64_tr_b16 v[32:33], v10
  ds_read_b64_tr_b16 v[34:35], v10 offset:512
  ds_read_b64_tr_b16 v[36:37], v11
  ds_read_b64_tr_b16 v[38:39], v11 offset:512
  ds_read_b64_tr_b16 v[40:41], v10 offset:2048
  ds_read_b64_tr_b16 v[42:43], v10 offset:2560
  ds_read_b64_tr_b16 v[44:45], v11 offset:2048
  ds_read_b64_tr_b16 v[46:47], v11 offset:2560
  ds_read_b64_tr_b16 v[48:49], v10 offset:4096
  ds_read_b64_tr_b16 v[50:51], v10 offset:4608
  ds_read_b64_tr_b16 v[52:53], v11 offset:4096
  ds_read_b64_tr_b16 v[54:55], v11 offset:4608
  ds_read_b64_tr_b16 v[56:57], v10 offset:6144
  ds_read_b64_tr_b16 v[58:59], v10 offset:6656
  ds_read_b64_tr_b16 v[60:61], v11 offset:6144
  ds_read_b64_tr_b16 v[62:63], v11 offset:6656
  s_add_u32 m0, s60, 0
  s_add_u32 s66, s65, 0xa2000
  s_waitcnt lgkmcnt(15)
  buffer_load_dwordx4 v12, s[48:51], s66 offen lds
  buffer_load_dwordx4 v13, s[48:51], s66 offen offset:1024 lds
  s_add_u32 m0, s60, 0x800
  s_add_u32 s66, s65, 0xa6800
  buffer_load_dwordx4 v12, s[48:51], s66 offen lds
  buffer_load_dwordx4 v13, s[48:51], s66 offen offset:1024 lds
  s_add_u32 m0, s60, 0x1000
  s_add_u32 s66, s65, 0xab000
  buffer_load_dwordx4 v12, s[48:51], s66 offen lds
  buffer_load_dwordx4 v13, s[48:51], s66 offen offset:1024 lds
  s_add_u32 m0, s60, 0x1800
  s_add_u32 s66, s65, 0xaf800
  buffer_load_dwordx4 v12, s[48:51], s66 offen lds
  buffer_load_dwordx4 v13, s[48:51], s66 offen offset:1024 lds
  s_add_u32 m0, s61, 0
  s_add_u32 s66, s65, 0xb4000
  s_waitcnt lgkmcnt(15)
  buffer_load_dwordx4 v12, s[48:51], s66 offen lds
  buffer_load_dwordx4 v13, s[48:51], s66 offen offset:1024 lds
  s_add_u32 m0, s61, 0x800
  s_add_u32 s66, s65, 0xb8800
  buffer_load_dwordx4 v12, s[48:51], s66 offen lds
  buffer_load_dwordx4 v13, s[48:51], s66 offen offset:1024 lds
  s_add_u32 m0, s61, 0x1000
  s_add_u32 s66, s65, 0xbd000
  buffer_load_dwordx4 v12, s[48:51], s66 offen lds
  buffer_load_dwordx4 v13, s[48:51], s66 offen offset:1024 lds
  s_add_u32 m0, s61, 0x1800
  s_add_u32 s66, s65, 0xc1800
  buffer_load_dwordx4 v12, s[48:51], s66 offen lds
  buffer_load_dwordx4 v13, s[48:51], s66 offen offset:1024 lds
  s_add_u32 m0, s62, 0
  s_add_u32 s66, s65, 0xc6000
  s_waitcnt lgkmcnt(15)
  buffer_load_dwordx4 v12, s[48:51], s66 offen lds
  buffer_load_dwordx4 v13, s[48:51], s66 offen offset:1024 lds
  s_add_u32 m0, s62, 0x800
  s_add_u32 s66, s65, 0xca800
  buffer_load_dwordx4 v12, s[48:51], s66 offen lds
  buffer_load_dwordx4 v13, s[48:51], s66 offen offset:1024 lds
  s_add_u32 m0, s62, 0x1000
  s_add_u32 s66, s65, 0xcf000
  buffer_load_dwordx4 v12, s[48:51], s66 offen lds
  buffer_load_dwordx4 v13, s[48:51], s66 offen offset:1024 lds
  s_add_u32 m0, s62, 0x1800
  s_add_u32 s66, s65, 0xd3800
  buffer_load_dwordx4 v12, s[48:51], s66 offen lds
  buffer_load_dwordx4 v13, s[48:51], s66 offen offset:1024 lds
  s_waitcnt vmcnt(24)
  s_waitcnt lgkmcnt(0)
  s_barrier
  s_branch F_TAIL
PADA_LF_TAIL:
  s_branch HOPRET_g2
PAD_LF_TAIL:
  s_sub_u32 s40, s40, 1
  s_cbranch_scc1 HOPRET_gb
  s_branch PAD_1
F_TAIL:
  s_cmp_eq_u32 s28, 0
  s_cbranch_scc0 F_NOSIG
  s_lshl_b32 s31, s29, 5
  v_mov_b32 v17, s31
  v_mov_b32 v18, 1
  s_mov_b64 s[32:33], exec
  s_mov_b64 exec, 1
  global_atomic_add v17, v18, s[70:71] sc1
  s_mov_b64 exec, s[32:33]
F_NOSIG:
  s_cmp_ge_u32 s72, 252
  s_cbranch_scc1 F_EXIT
  s_add_u32 m0, s63, 0
  s_add_u32 s66, s65, 0xd8000
  buffer_load_dwordx4 v12, s[48:51], s66 offen lds
  buffer_load_dwordx4 v13, s[48:51], s66 offen offset:1024 lds
  s_add_u32 m0, s63, 0x800
  s_add_u32 s66, s65, 0xdc800
  buffer_load_dwordx4 v12, s[48:51], s66 offen lds
  buffer_load_dwordx4 v13, s[48:51], s66 offen offset:1024 lds
  s_add_u32 m0, s63, 0x1000
  s_add_u32 s66, s65, 0xe1000
  buffer_load_dwordx4 v12, s[48:51], s66 offen lds
  buffer_load_dwordx4 v13, s[48:51], s66 offen offset:1024 lds
  s_add_u32 m0, s63, 0x1800
  s_add_u32 s66, s65, 0xe5800
  buffer_load_dwordx4 v12, s[48:51], s66 offen lds
  buffer_load_dwordx4 v13, s[48:51], s66 offen offset:1024 lds
  s_add_u32 m0, s64, 0
  s_add_u32 s66, s65, 0xea000
  buffer_load_dwordx4 v12, s[48:51], s66 offen lds
  buffer_load_dwordx4 v13, s[48:51], s66 offen offset:1024 lds
  s_add_u32 m0, s64, 0x800
  s_add_u32 s66, s65, 0xee800
  buffer_load_dwordx4 v12, s[48:51], s66 offen lds
  buffer_load_dwordx4 v13, s[48:51], s66 offen offset:1024 lds
  s_add_u32 m0, s64, 0x1000
  s_add_u32 s66, s65, 0xf3000
  buffer_load_dwordx4 v12, s[48:51], s66 offen lds
  buffer_load_dwordx4 v13, s[48:51], s66 offen offset:1024 lds
  s_add_u32 m0, s64, 0x1800
  s_add_u32 s66, s65, 0xf7800
  buffer_load_dwordx4 v12, s[48:51], s66 offen lds
  buffer_load_dwordx4 v13, s[48:51], s66 offen offset:1024 lds
  s_waitcnt vmcnt(32)
  ds_read_b64_tr_b16 v[128:129], v2
  ds_read_b64_tr_b16 v[130:131], v2 offset:512
  ds_read_b64_tr_b16 v[132:133], v3
  ds_read_b64_tr_b16 v[134:135], v3 offset:512
  ds_read_b64_tr_b16 v[136:137], v2 offset:2048
  ds_read_b64_tr_b16 v[138:139], v2 offset:2560
  ds_read_b64_tr_b16 v[140:141], v3 offset:2048
  ds_read_b64_tr_b16 v[142:143], v3 offset:2560
  ds_read_b64_tr_b16 v[144:145], v2 offset:4096
  ds_read_b64_tr_b16 v[146:147], v2 offset:4608
  ds_read_b64_tr_b16 v[148:149], v3 offset:4096
  ds_read_b64_tr_b16 v[150:151], v3 offset:4608
  ds_read_b64_tr_b16 v[152:153], v2 offset:6144
  ds_read_b64_tr_b16 v[154:155], v2 offset:6656
  ds_read_b64_tr_b16 v[156:157], v3 offset:6144
  ds_read_b64_tr_b16 v[158:159], v3 offset:6656
  s_waitcnt vmcnt(24)
  ds_read_b64_tr_b16 v[160:161], v4
  ds_read_b64_tr_b16 v[162:163], v4 offset:512
  ds_read_b64_tr_b16 v[164:165], v5
  ds_read_b64_tr_b16 v[166:167], v5 offset:512
  ds_read_b64_tr_b16 v[168:169], v4 offset:2048
  ds_read_b64_tr_b16 v[170:171], v4 offset:2560
  ds_read_b64_tr_b16 v[172:173], v5 offset:2048
  ds_read_b64_tr_b16 v[174:175], v5 offset:2560
  ds_read_b64_tr_b16 v[176:177], v4 offset:4096
  s_branch PADO_13
PADA_13:
  s_branch HOPRET_g2
PAD_13:
  s_sub_u32 s40, s40, 1
  s_cbranch_scc1 HOPRET_gb
  s_branch PAD_2
PADO_13:
  ds_read_b64_tr_b16 v[178:179], v4 offset:4608
  ds_read_b64_tr_b16 v[180:181], v5 offset:4096
  ds_read_b64_tr_b16 v[182:183], v5 offset:4608
  ds_read_b64_tr_b16 v[184:185], v4 offset:6144
  ds_read_b64_tr_b16 v[186:187], v4 offset:6656
  ds_read_b64_tr_b16 v[188:189], v5 offset:6144
  ds_read_b64_tr_b16 v[190:191], v5 offset:6656
  s_add_u32 m0, s60, 0
  s_add_u32 s66, s65, 0xfc000
  s_waitcnt lgkmcnt(15)
  buffer_load_dwordx4 v12, s[48:51], s66 offen lds
  buffer_load_dwordx4 v13, s[48:51], s66 offen offset:1024 lds
  s_add_u32 m0, s60, 0x800
  s_add_u32 s66, s65, 0x100800
  buffer_load_dwordx4 v12, s[48:51], s66 offen lds
  buffer_load_dwordx4 v13, s[48:51], s66 offen offset:1024 lds
  s_add_u32 m0, s60, 0x1000
  s_add_u32 s66, s65, 0x105000
  buffer_load_dwordx4 v12, s[48:51], s66 offen lds
  buffer_load_dwordx4 v13, s[48:51], s66 offen offset:1024 lds
  s_add_u32 m0, s60, 0x1800
  s_add_u32 s66, s65, 0x109800
  buffer_load_dwordx4 v12, s[48:51], s66 offen lds
  buffer_load_dwordx4 v13, s[48:51], s66 offen offset:1024 lds
  s_add_u32 m0, s61, 0
  s_add_u32 s66, s65, 0x10e000
  s_waitcnt lgkmcnt(0)
  buffer_load_dwordx4 v12, s[48:51], s66 offen lds
  buffer_load_dwordx4 v13, s[48:51], s66 offen offset:1024 lds
  s_add_u32 m0, s61, 0x800
  s_add_u32 s66, s65, 0x112800
  buffer_load_dwordx4 v12, s[48:51], s66 offen lds
  buffer_load_dwordx4 v13, s[48:51], s66 offen offset:1024 lds
  s_add_u32 m0, s61, 0x1000
  s_add_u32 s66, s65, 0x117000
  buffer_load_dwordx4 v12, s[48:51], s66 offen lds
  buffer_load_dwordx4 v13, s[48:51], s66 offen offset:1024 lds
  s_add_u32 m0, s61, 0x1800
  s_add_u32 s66, s65, 0x11b800
  buffer_load_dwordx4 v12, s[48:51], s66 offen lds
  buffer_load_dwordx4 v13, s[48:51], s66 offen offset:1024 lds
  s_lshr_b32 s31, s28, 1
  s_lshl_b32 s31, s31, 18
  s_sub_u32 s32, 0x40000, s31
  v_add_u32 v16, s32, v14
  v_add_u32 v14, s31, v14
  s_cmp_eq_u32 s28, 0
  s_cbranch_scc0 F_NOPOLL
  v_and_b32 v17, 1, v0
  v_mov_b32 v18, s45
  v_mov_b32 v19, s35
  v_cmp_eq_u32 vcc, 1, v17
  v_cndmask_b32 v17, v18, v19, vcc
  s_mov_b32 s73, 0
F_POLL:
  global_load_dword v18, v17, s[70:71] sc1
  s_waitcnt vmcnt(0)
  v_cmp_gt_u32 vcc, 32, v18
  s_nop 1
  s_cbranch_vccz F_NOPOLL
  s_sleep 1
  s_add_u32 s73, s73, 1
  s_cmp_lt_u32 s73, 0x40000
  s_cbranch_scc1 F_POLL
F_NOPOLL:
  s_barrier
  s_mov_b32 s67, 0
  buffer_load_dwordx4 a[64:67], v14, s[52:55], s67 offen sc1
  buffer_load_dwordx4 a[68:71], v16, s[52:55], s67 offen sc1
  buffer_load_dwordx4 a[72:75], v14, s[52:55], s67 offen offset:1024 sc1
  buffer_load_dwordx4 a[76:79], v16, s[52:55], s67 offen offset:1024 sc1
  buffer_load_dwordx4 a[80:83], v14, s[52:55], s67 offen offset:2048 sc1
  buffer_load_dwordx4 a[84:87], v16, s[52:55], s67 offen offset:2048 sc1
  buffer_load_dwordx4 a[88:91], v14, s[52:55], s67 offen offset:3072 sc1
  buffer_load_dwordx4 a[92:95], v16, s[52:55], s67 offen offset:3072 sc1
  s_mov_b32 s67, 0x1000
  buffer_load_dwordx4 a[96:99], v14, s[52:55], s67 offen sc1
  buffer_load_dwordx4 a[100:103], v16, s[52:55], s67 offen sc1
  buffer_load_dwordx4 a[104:107], v14, s[52:55], s67 offen offset:1024 sc1
  buffer_load_dwordx4 a[108:111], v16, s[52:55], s67 offen offset:1024 sc1
  buffer_load_dwordx4 a[112:115], v14, s[52:55], s67 offen offset:2048 sc1
  buffer_load_dwordx4 a[116:119], v16, s[52:55], s67 offen offset:2048 sc1
  buffer_load_dwordx4 a[120:123], v14, s[52:55], s67 offen offset:3072 sc1
  buffer_load_dwordx4 a[124:127], v16, s[52:55], s67 offen offset:3072 sc1
  s_waitcnt vmcnt(15)
  v_mfma_f32_32x32x16_bf16 a[0:15], v[192:195], a[64:67], 0
  v_mfma_f32_32x32x16_bf16 a[32:47], v[196:199], a[64:67], 0
  s_waitcnt vmcnt(14)
  v_mfma_f32_32x32x16_bf16 a[16:31], v[192:195], a[68:71], 0
  v_mfma_f32_32x32x16_bf16 a[48:63], v[196:199], a[68:71], 0
  s_mov_b32 s67, 0x2000
  buffer_load_dwordx4 v[192:195], v14, s[52:55], s67 offen sc1
  buffer_load_dwordx4 v[196:199], v16, s[52:55], s67 offen sc1
  s_waitcnt vmcnt(15)
  v_mfma_f32_32x32x16_bf16 a[0:15], v[200:203], a[72:75], a[0:15]
  v_mfma_f32_32x32x16_bf16 a[32:47], v[204:207], a[72:75], a[32:47]
  s_waitcnt vmcnt(14)
  v_mfma_f32_32x32x16_bf16 a[16:31], v[200:203], a[76:79], a[16:31]
  v_mfma_f32_32x32x16_bf16 a[48:63], v[204:207], a[76:79], a[48:63]
  buffer_load_dwordx4 a[64:67], v14, s[52:55], s67 offen offset:1024 sc1
  buffer_load_dwordx4 a[68:71], v16, s[52:55], s67 offen offset:1024 sc1
  buffer_load_dwordx4 v[200:203], v14, s[52:55], s67 offen offset:2048 sc1
  buffer_load_dwordx4 v[204:207], v16, s[52:55], s67 offen offset:2048 sc1
  s_waitcnt vmcnt(17)
  v_mfma_f32_32x32x16_bf16 a[0:15], v[208:211], a[80:83], a[0:15]
  v_mfma_f32_32x32x16_bf16 a[32:47], v[212:215], a[80:83], a[32:47]
  s_waitcnt vmcnt(16)
  v_mfma_f32_32x32x16_bf16 a[16:31], v[208:211], a[84:87], a[16:31]
  v_mfma_f32_32x32x16_bf16 a[48:63], v[212:215], a[84:87], a[48:63]
  buffer_load_dwordx4 a[72:75], v14, s[52:55], s67 offen offset:3072 sc1
  buffer_load_dwordx4 a[76:79], v16, s[52:55], s67 offen offset:3072 sc1
  s_mov_b32 s67, 0x3000
  buffer_load_dwordx4 v[208:211], v14, s[52:55], s67 offen sc1
  buffer_load_dwordx4 v[212:215], v16, s[52:55], s67 offen sc1
  s_waitcnt vmcnt(19)
  v_mfma_f32_32x32x16_bf16 a[0:15], v[216:219], a[88:91], a[0:15]
  v_mfma_f32_32x32x16_bf16 a[32:47], v[220:223], a[88:91], a[32:47]
  s_waitcnt vmcnt(18)
  v_mfma_f32_32x32x16_bf16 a[16:31], v[216:219], a[92:95], a[16:31]
  v_mfma_f32_32x32x16_bf16 a[48:63], v[220:223], a[92:95], a[48:63]
  buffer_load_dwordx4 a[80:83], v14, s[52:55], s67 offen offset:1024 sc1
  buffer_load_dwordx4 a[84:87], v16, s[52:55], s67 offen offset:1024 sc1
  buffer_load_dwordx4 v[216:219], v14, s[52:55], s67 offen offset:2048 sc1
  buffer_load_dwordx4 v[220:223], v16, s[52:55], s67 offen offset:2048 sc1
  s_waitcnt vmcnt(21)
  v_mfma_f32_32x32x16_bf16 a[0:15], v[224:227], a[96:99], a[0:15]
  v_mfma_f32_32x32x16_bf16 a[32:47], v[228:231], a[96:99], a[32:47]
  s_waitcnt vmcnt(20)
  v_mfma_f32_32x32x16_bf16 a[16:31], v[224:227], a[100:103], a[16:31]
  v_mfma_f32_32x32x16_bf16 a[48:63], v[228:231], a[100:103], a[48:63]
  buffer_load_dwordx4 a[88:91], v14, s[52:55], s67 offen offset:3072 sc1
  buffer_load_dwordx4 a[92:95], v16, s[52:55], s67 offen offset:3072 sc1
  s_mov_b32 s67, 0x4000
  buffer_load_dwordx4 v[224:227], v14, s[52:55], s67 offen sc1
  buffer_load_dwordx4 v[228:231], v16, s[52:55], s67 offen sc1
  s_waitcnt vmcnt(23)
  v_mfma_f32_32x32x16_bf16 a[0:15], v[232:235], a[104:107], a[0:15]
  v_mfma_f32_32x32x16_bf16 a[32:47], v[236:239], a[104:107], a[32:47]
  s_waitcnt vmcnt(22)
  v_mfma_f32_32x32x16_bf16 a[16:31], v[232:235], a[108:111], a[16:31]
  v_mfma_f32_32x32x16_bf16 a[48:63], v[236:239], a[108:111], a[48:63]
  buffer_load_dwordx4 a[96:99], v14, s[52:55], s67 offen offset:1024 sc1
  buffer_load_dwordx4 a[100:103], v16, s[52:55], s67 offen offset:1024 sc1
  s_waitcnt vmcnt(23)
  v_mfma_f32_32x32x16_bf16 a[0:15], v[240:243], a[112:115], a[0:15]
  v_mfma_f32_32x32x16_bf16 a[32:47], v[244:247], a[112:115], a[32:47]
  s_waitcnt vmcnt(22)
  v_mfma_f32_32x32x16_bf16 a[16:31], v[240:243], a[116:119], a[16:31]
  v_mfma_f32_32x32x16_bf16 a[48:63], v[244:247], a[116:119], a[48:63]
  buffer_load_dwordx4 v[232:235], v14, s[52:55], s67 offen offset:2048 sc1
  buffer_load_dwordx4 v[236:239], v16, s[52:55], s67 offen offset:2048 sc1
  s_waitcnt vmcnt(23)
  v_mfma_f32_32x32x16_bf16 a[0:15], v[248:251], a[120:123], a[0:15]
  v_mfma_f32_32x32x16_bf16 a[32:47], v[252:255], a[120:123], a[32:47]
  s_waitcnt vmcnt(22)
  v_mfma_f32_32x32x16_bf16 a[16:31], v[248:251], a[124:127], a[16:31]
  v_mfma_f32_32x32x16_bf16 a[48:63], v[252:255], a[124:127], a[48:63]
  buffer_load_dwordx4 a[104:107], v14, s[52:55], s67 offen offset:3072 sc1
  buffer_load_dwordx4 a[108:111], v16, s[52:55], s67 offen offset:3072 sc1
  s_waitcnt vmcnt(23)
  v_mfma_f32_32x32x16_bf16 a[0:15], a[192:195], v[192:195], a[0:15]
  v_mfma_f32_32x32x16_bf16 a[32:47], a[196:199], v[192:195], a[32:47]
  s_waitcnt vmcnt(22)
  v_mfma_f32_32x32x16_bf16 a[16:31], a[192:195], v[196:199], a[16:31]
  v_mfma_f32_32x32x16_bf16 a[48:63], a[196:199], v[196:199], a[48:63]
  s_mov_b32 s67, 0x5000
  buffer_load_dwordx4 v[240:243], v14, s[52:55], s67 offen sc1
  buffer_load_dwordx4 v[244:247], v16, s[52:55], s67 offen sc1
  s_waitcnt vmcnt(23)
  v_mfma_f32_32x32x16_bf16 a[0:15], a[200:203], a[64:67], a[0:15]
  v_mfma_f32_32x32x16_bf16 a[32:47], a[204:207], a[64:67], a[32:47]
  s_waitcnt vmcnt(22)
  v_mfma_f32_32x32x16_bf16 a[16:31], a[200:203], a[68:71], a[16:31]
  v_mfma_f32_32x32x16_bf16 a[48:63], a[204:207], a[68:71], a[48:63]
  buffer_load_dwordx4 a[112:115], v14, s[52:55], s67 offen offset:1024 sc1
  buffer_load_dwordx4 a[116:119], v16, s[52:55], s67 offen offset:1024 sc1
  s_waitcnt vmcnt(23)
  v_mfma_f32_32x32x16_bf16 a[0:15], a[208:211], v[200:203], a[0:15]
  v_mfma_f32_32x32x16_bf16 a[32:47], a[212:215], v[200:203], a[32:47]
  s_waitcnt vmcnt(22)
  v_mfma_f32_32x32x16_bf16 a[16:31], a[208:211], v[204:207], a[16:31]
  v_mfma_f32_32x32x16_bf16 a[48:63], a[212:215], v[204:207], a[48:63]
  buffer_load_dwordx4 v[248:251], v14, s[52:55], s67 offen offset:2048 sc1
  buffer_load_dwordx4 v[252:255], v16, s[52:55], s67 offen offset:2048 sc1
  s_waitcnt vmcnt(23)
  v_mfma_f32_32x32x16_bf16 a[0:15], a[216:219], a[72:75], a[0:15]
  v_mfma_f32_32x32x16_bf16 a[32:47], a[220:223], a[72:75], a[32:47]
  s_waitcnt vmcnt(22)
  v_mfma_f32_32x32x16_bf16 a[16:31], a[216:219], a[76:79], a[16:31]
  v_mfma_f32_32x32x16_bf16 a[48:63], a[220:223], a[76:79], a[48:63]
  buffer_load_dwordx4 a[120:123], v14, s[52:55], s67 offen offset:3072 sc1
  buffer_load_dwordx4 a[124:127], v16, s[52:55], s67 offen offset:3072 sc1
  s_waitcnt vmcnt(23)
  v_mfma_f32_32x32x16_bf16 a[0:15], a[224:227], v[208:211], a[0:15]
  v_mfma_f32_32x32x16_bf16 a[32:47], a[228:231], v[208:211], a[32:47]
  s_waitcnt vmcnt(22)
  v_mfma_f32_32x32x16_bf16 a[16:31], a[224:227], v[212:215], a[16:31]
  v_mfma_f32_32x32x16_bf16 a[48:63], a[228:231], v[212:215], a[48:63]
  s_mov_b32 s67, 0x6000
  buffer_load_dwordx4 a[192:195], v14, s[52:55], s67 offen sc1
  buffer_load_dwordx4 a[196:199], v16, s[52:55], s67 offen sc1
  s_waitcnt vmcnt(23)
  v_mfma_f32_32x32x16_bf16 a[0:15], a[232:235], a[80:83], a[0:15]
  v_mfma_f32_32x32x16_bf16 a[32:47], a[236:239], a[80:83], a[32:47]
  s_waitcnt vmcnt(22)
  v_mfma_f32_32x32x16_bf16 a[16:31], a[232:235], a[84:87], a[16:31]
  v_mfma_f32_32x32x16_bf16 a[48:63], a[236:239], a[84:87], a[48:63]
  buffer_load_dwordx4 v[192:195], v14, s[52:55], s67 offen offset:1024 sc1
  buffer_load_dwordx4 v[196:199], v16, s[52:55], s67 offen offset:1024 sc1
  s_waitcnt vmcnt(23)
  v_mfma_f32_32x32x16_bf16 a[0:15], a[240:243], v[216:219], a[0:15]
  v_mfma_f32_32x32x16_bf16 a[32:47], a[244:247], v[216:219], a[32:47]
  s_waitcnt vmcnt(22)
  v_mfma_f32_32x32x16_bf16 a[16:31], a[240:243], v[220:223], a[16:31]
  v_mfma_f32_32x32x16_bf16 a[48:63], a[244:247], v[220:223], a[48:63]
  buffer_load_dwordx4 a[200:203], v14, s[52:55], s67 offen offset:2048 sc1
  buffer_load_dwordx4 a[204:207], v16, s[52:55], s67 offen offset:2048 sc1
  s_waitcnt vmcnt(23)
  v_mfma_f32_32x32x16_bf16 a[0:15], a[248:251], a[88:91], a[0:15]
  v_mfma_f32_32x32x16_bf16 a[32:47], a[252:255], a[88:91], a[32:47]
  s_waitcnt vmcnt(22)
  v_mfma_f32_32x32x16_bf16 a[16:31], a[248:251], a[92:95], a[16:31]
  v_mfma_f32_32x32x16_bf16 a[48:63], a[252:255], a[92:95], a[48:63]
  buffer_load_dwordx4 a[64:67], v14, s[52:55], s67 offen offset:3072 sc1
  buffer_load_dwordx4 a[68:71], v16, s[52:55], s67 offen offset:3072 sc1
  s_waitcnt vmcnt(23)
  v_mfma_f32_32x32x16_bf16 a[0:15], v[64:67], v[224:227], a[0:15]
  v_mfma_f32_32x32x16_bf16 a[32:47], v[68:71], v[224:227], a[32:47]
  s_waitcnt vmcnt(22)
  v_mfma_f32_32x32x16_bf16 a[16:31], v[64:67], v[228:231], a[16:31]
  v_mfma_f32_32x32x16_bf16 a[48:63], v[68:71], v[228:231], a[48:63]
  s_mov_b32 s67, 0x7000
  buffer_load_dwordx4 a[208:211], v14, s[52:55], s67 offen sc1
  buffer_load_dwordx4 a[212:215], v16, s[52:55], s67 offen sc1
  s_waitcnt vmcnt(23)
  v_mfma_f32_32x32x16_bf16 a[0:15], v[72:75], a[96:99], a[0:15]
  v_mfma_f32_32x32x16_bf16 a[32:47], v[76:79], a[96:99], a[32:47]
  s_waitcnt vmcnt(22)
  v_mfma_f32_32x32x16_bf16 a[16:31], v[72:75], a[100:103], a[16:31]
  v_mfma_f32_32x32x16_bf16 a[48:63], v[76:79], a[100:103], a[48:63]
  buffer_load_dwordx4 v[200:203], v14, s[52:55], s67 offen offset:1024 sc1
  buffer_load_dwordx4 v[204:207], v16, s[52:55], s67 offen offset:1024 sc1
  s_waitcnt vmcnt(23)
  v_mfma_f32_32x32x16_bf16 a[0:15], v[80:83], v[232:235], a[0:15]
  v_mfma_f32_32x32x16_bf16 a[32:47], v[84:87], v[232:235], a[32:47]
  s_waitcnt vmcnt(22)
  v_mfma_f32_32x32x16_bf16 a[16:31], v[80:83], v[236:239], a[16:31]
  v_mfma_f32_32x32x16_bf16 a[48:63], v[84:87], v[236:239], a[48:63]
  buffer_load_dwordx4 a[216:219], v14, s[52:55], s67 offen offset:2048 sc1
  buffer_load_dwordx4 a[220:223], v16, s[52:55], s67 offen offset:2048 sc1
  s_waitcnt vmcnt(23)
  v_mfma_f32_32x32x16_bf16 a[0:15], v[88:91], a[104:107], a[0:15]
  v_mfma_f32_32x32x16_bf16 a[32:47], v[92:95], a[104:107], a[32:47]
  s_waitcnt vmcnt(22)
  v_mfma_f32_32x32x16_bf16 a[16:31], v[88:91], a[108:111], a[16:31]
  v_mfma_f32_32x32x16_bf16 a[48:63], v[92:95], a[108:111], a[48:63]
  buffer_load_dwordx4 a[72:75], v14, s[52:55], s67 offen offset:3072 sc1
  buffer_load_dwordx4 a[76:79], v16, s[52:55], s67 offen offset:3072 sc1
  s_waitcnt vmcnt(23)
  v_mfma_f32_32x32x16_bf16 a[0:15], v[96:99], v[240:243], a[0:15]
  v_mfma_f32_32x32x16_bf16 a[32:47], v[100:103], v[240:243], a[32:47]
  s_waitcnt vmcnt(22)
  v_mfma_f32_32x32x16_bf16 a[16:31], v[96:99], v[244:247], a[16:31]
  v_mfma_f32_32x32x16_bf16 a[48:63], v[100:103], v[244:247], a[48:63]
  s_mov_b32 s67, 0x8000
  buffer_load_dwordx4 a[224:227], v14, s[52:55], s67 offen sc1
  buffer_load_dwordx4 a[228:231], v16, s[52:55], s67 offen sc1
  s_waitcnt vmcnt(23)
  v_mfma_f32_32x32x16_bf16 a[0:15], v[104:107], a[112:115], a[0:15]
  v_mfma_f32_32x32x16_bf16 a[32:47], v[108:111], a[112:115], a[32:47]
  s_waitcnt vmcnt(22)
  v_mfma_f32_32x32x16_bf16 a[16:31], v[104:107], a[116:119], a[16:31]
  v_mfma_f32_32x32x16_bf16 a[48:63], v[108:111], a[116:119], a[48:63]
  buffer_load_dwordx4 v[208:211], v14, s[52:55], s67 offen offset:1024 sc1
  buffer_load_dwordx4 v[212:215], v16, s[52:55], s67 offen offset:1024 sc1
  s_waitcnt vmcnt(23)
  v_mfma_f32_32x32x16_bf16 a[0:15], v[112:115], v[248:251], a[0:15]
  v_mfma_f32_32x32x16_bf16 a[32:47], v[116:119], v[248:251], a[32:47]
  s_waitcnt vmcnt(22)
  v_mfma_f32_32x32x16_bf16 a[16:31], v[112:115], v[252:255], a[16:31]
  v_mfma_f32_32x32x16_bf16 a[48:63], v[116:119], v[252:255], a[48:63]
  buffer_load_dwordx4 a[232:235], v14, s[52:55], s67 offen offset:2048 sc1
  buffer_load_dwordx4 a[236:239], v16, s[52:55], s67 offen offset:2048 sc1
  s_waitcnt vmcnt(23)
  v_mfma_f32_32x32x16_bf16 a[0:15], v[120:123], a[120:123], a[0:15]
  v_mfma_f32_32x32x16_bf16 a[32:47], v[124:127], a[120:123], a[32:47]
  s_waitcnt vmcnt(22)
  v_mfma_f32_32x32x16_bf16 a[16:31], v[120:123], a[124:127], a[16:31]
  v_mfma_f32_32x32x16_bf16 a[48:63], v[124:127], a[124:127], a[48:63]
  buffer_load_dwordx4 a[80:83], v14, s[52:55], s67 offen offset:3072 sc1
  buffer_load_dwordx4 a[84:87], v16, s[52:55], s67 offen offset:3072 sc1
  s_waitcnt vmcnt(23)
  v_mfma_f32_32x32x16_bf16 a[0:15], a[128:131], a[192:195], a[0:15]
  v_mfma_f32_32x32x16_bf16 a[32:47], a[132:135], a[192:195], a[32:47]
  s_waitcnt vmcnt(22)
  v_mfma_f32_32x32x16_bf16 a[16:31], a[128:131], a[196:199], a[16:31]
  v_mfma_f32_32x32x16_bf16 a[48:63], a[132:135], a[196:199], a[48:63]
  s_mov_b32 s67, 0x9000
  buffer_load_dwordx4 a[240:243], v14, s[52:55], s67 offen sc1
  buffer_load_dwordx4 a[244:247], v16, s[52:55], s67 offen sc1
  s_waitcnt vmcnt(23)
  v_mfma_f32_32x32x16_bf16 a[0:15], a[136:139], v[192:195], a[0:15]
  v_mfma_f32_32x32x16_bf16 a[32:47], a[140:143], v[192:195], a[32:47]
  s_waitcnt vmcnt(22)
  v_mfma_f32_32x32x16_bf16 a[16:31], a[136:139], v[196:199], a[16:31]
  v_mfma_f32_32x32x16_bf16 a[48:63], a[140:143], v[196:199], a[48:63]
  buffer_load_dwordx4 v[216:219], v14, s[52:55], s67 offen offset:1024 sc1
  buffer_load_dwordx4 v[220:223], v16, s[52:55], s67 offen offset:1024 sc1
  s_waitcnt vmcnt(23)
  v_mfma_f32_32x32x16_bf16 a[0:15], a[144:147], a[200:203], a[0:15]
  v_mfma_f32_32x32x16_bf16 a[32:47], a[148:151], a[200:203], a[32:47]
  s_waitcnt vmcnt(22)
  v_mfma_f32_32x32x16_bf16 a[16:31], a[144:147], a[204:207], a[16:31]
  v_mfma_f32_32x32x16_bf16 a[48:63], a[148:151], a[204:207], a[48:63]
  buffer_load_dwordx4 a[248:251], v14, s[52:55], s67 offen offset:2048 sc1
  buffer_load_dwordx4 a[252:255], v16, s[52:55], s67 offen offset:2048 sc1
  s_waitcnt vmcnt(23)
  v_mfma_f32_32x32x16_bf16 a[0:15], a[152:155], a[64:67], a[0:15]
  v_mfma_f32_32x32x16_bf16 a[32:47], a[156:159], a[64:67], a[32:47]
  s_waitcnt vmcnt(22)
  v_mfma_f32_32x32x16_bf16 a[16:31], a[152:155], a[68:71], a[16:31]
  v_mfma_f32_32x32x16_bf16 a[48:63], a[156:159], a[68:71], a[48:63]
  buffer_load_dwordx4 a[88:91], v14, s[52:55], s67 offen offset:3072 sc1
  buffer_load_dwordx4 a[92:95], v16, s[52:55], s67 offen offset:3072 sc1
  s_waitcnt vmcnt(23)
  v_mfma_f32_32x32x16_bf16 a[0:15], a[160:163], a[208:211], a[0:15]
  v_mfma_f32_32x32x16_bf16 a[32:47], a[164:167], a[208:211], a[32:47]
  s_waitcnt vmcnt(22)
  v_mfma_f32_32x32x16_bf16 a[16:31], a[160:163], a[212:215], a[16:31]
  v_mfma_f32_32x32x16_bf16 a[48:63], a[164:167], a[212:215], a[48:63]
  s_mov_b32 s67, 0xa000
  buffer_load_dwordx4 v[64:67], v14, s[52:55], s67 offen sc1
  buffer_load_dwordx4 v[68:71], v16, s[52:55], s67 offen sc1
  s_waitcnt vmcnt(23)
  v_mfma_f32_32x32x16_bf16 a[0:15], a[168:171], v[200:203], a[0:15]
  v_mfma_f32_32x32x16_bf16 a[32:47], a[172:175], v[200:203], a[32:47]
  s_waitcnt vmcnt(22)
  v_mfma_f32_32x32x16_bf16 a[16:31], a[168:171], v[204:207], a[16:31]
  v_mfma_f32_32x32x16_bf16 a[48:63], a[172:175], v[204:207], a[48:63]
  buffer_load_dwordx4 v[224:227], v14, s[52:55], s67 offen offset:1024 sc1
  buffer_load_dwordx4 v[228:231], v16, s[52:55], s67 offen offset:1024 sc1
  s_waitcnt vmcnt(23)
  v_mfma_f32_32x32x16_bf16 a[0:15], a[176:179], a[216:219], a[0:15]
  v_mfma_f32_32x32x16_bf16 a[32:47], a[180:183], a[216:219], a[32:47]
  s_waitcnt vmcnt(22)
  v_mfma_f32_32x32x16_bf16 a[16:31], a[176:179], a[220:223], a[16:31]
  v_mfma_f32_32x32x16_bf16 a[48:63], a[180:183], a[220:223], a[48:63]
  buffer_load_dwordx4 v[72:75], v14, s[52:55], s67 offen offset:2048 sc1
  buffer_load_dwordx4 v[76:79], v16, s[52:55], s67 offen offset:2048 sc1
  s_waitcnt vmcnt(23)
  v_mfma_f32_32x32x16_bf16 a[0:15], a[184:187], a[72:75], a[0:15]
  v_mfma_f32_32x32x16_bf16 a[32:47], a[188:191], a[72:75], a[32:47]
  s_waitcnt vmcnt(22)
  v_mfma_f32_32x32x16_bf16 a[16:31], a[184:187], a[76:79], a[16:31]
  v_mfma_f32_32x32x16_bf16 a[48:63], a[188:191], a[76:79], a[48:63]
  buffer_load_dwordx4 a[96:99], v14, s[52:55], s67 offen offset:3072 sc1
  buffer_load_dwordx4 a[100:103], v16, s[52:55], s67 offen offset:3072 sc1
  s_waitcnt vmcnt(23)
  v_mfma_f32_32x32x16_bf16 a[0:15], v[32:35], a[224:227], a[0:15]
  v_mfma_f32_32x32x16_bf16 a[32:47], v[36:39], a[224:227], a[32:47]
  s_waitcnt vmcnt(22)
  v_mfma_f32_32x32x16_bf16 a[16:31], v[32:35], a[228:231], a[16:31]
  v_mfma_f32_32x32x16_bf16 a[48:63], v[36:39], a[228:231], a[48:63]
  s_mov_b32 s67, 0xb000
  buffer_load_dwordx4 v[80:83], v14, s[52:55], s67 offen sc1
  buffer_load_dwordx4 v[84:87], v16, s[52:55], s67 offen sc1
  s_waitcnt vmcnt(23)
  v_mfma_f32_32x32x16_bf16 a[0:15], v[40:43], v[208:211], a[0:15]
  v_mfma_f32_32x32x16_bf16 a[32:47], v[44:47], v[208:211], a[32:47]
  s_waitcnt vmcnt(22)
  v_mfma_f32_32x32x16_bf16 a[16:31], v[40:43], v[212:215], a[16:31]
  v_mfma_f32_32x32x16_bf16 a[48:63], v[44:47], v[212:215], a[48:63]
  buffer_load_dwordx4 v[232:235], v14, s[52:55], s67 offen offset:1024 sc1
  buffer_load_dwordx4 v[236:239], v16, s[52:55], s67 offen offset:1024 sc1
  s_waitcnt vmcnt(23)
  v_mfma_f32_32x32x16_bf16 a[0:15], v[48:51], a[232:235], a[0:15]
  v_mfma_f32_32x32x16_bf16 a[32:47], v[52:55], a[232:235], a[32:47]
  s_waitcnt vmcnt(22)
  v_mfma_f32_32x32x16_bf16 a[16:31], v[48:51], a[236:239], a[16:31]
  v_mfma_f32_32x32x16_bf16 a[48:63], v[52:55], a[236:239], a[48:63]
  buffer_load_dwordx4 v[88:91], v14, s[52:55], s67 offen offset:2048 sc1
  buffer_load_dwordx4 v[92:95], v16, s[52:55], s67 offen offset:2048 sc1
  s_waitcnt vmcnt(23)
  v_mfma_f32_32x32x16_bf16 a[0:15], v[56:59], a[80:83], a[0:15]
  v_mfma_f32_32x32x16_bf16 a[32:47], v[60:63], a[80:83], a[32:47]
  s_waitcnt vmcnt(22)
  v_mfma_f32_32x32x16_bf16 a[16:31], v[56:59], a[84:87], a[16:31]
  v_mfma_f32_32x32x16_bf16 a[48:63], v[60:63], a[84:87], a[48:63]
  buffer_load_dwordx4 a[104:107], v14, s[52:55], s67 offen offset:3072 sc1
  buffer_load_dwordx4 a[108:111], v16, s[52:55], s67 offen offset:3072 sc1
  s_waitcnt vmcnt(23)
  v_mfma_f32_32x32x16_bf16 a[0:15], v[128:131], a[240:243], a[0:15]
  v_mfma_f32_32x32x16_bf16 a[32:47], v[132:135], a[240:243], a[32:47]
  s_waitcnt vmcnt(22)
  v_mfma_f32_32x32x16_bf16 a[16:31], v[128:131], a[244:247], a[16:31]
  v_mfma_f32_32x32x16_bf16 a[48:63], v[132:135], a[244:247], a[48:63]
  s_mov_b32 s67, 0xc000
  buffer_load_dwordx4 v[96:99], v14, s[52:55], s67 offen sc1
  buffer_load_dwordx4 v[100:103], v16, s[52:55], s67 offen sc1
  s_waitcnt vmcnt(23)
  v_mfma_f32_32x32x16_bf16 a[0:15], v[136:139], v[216:219], a[0:15]
  v_mfma_f32_32x32x16_bf16 a[32:47], v[140:143], v[216:219], a[32:47]
  s_waitcnt vmcnt(22)
  v_mfma_f32_32x32x16_bf16 a[16:31], v[136:139], v[220:223], a[16:31]
  v_mfma_f32_32x32x16_bf16 a[48:63], v[140:143], v[220:223], a[48:63]
  buffer_load_dwordx4 v[240:243], v14, s[52:55], s67 offen offset:1024 sc1
  buffer_load_dwordx4 v[244:247], v16, s[52:55], s67 offen offset:1024 sc1
  s_waitcnt vmcnt(23)
  v_mfma_f32_32x32x16_bf16 a[0:15], v[144:147], a[248:251], a[0:15]
  v_mfma_f32_32x32x16_bf16 a[32:47], v[148:151], a[248:251], a[32:47]
  s_waitcnt vmcnt(22)
  v_mfma_f32_32x32x16_bf16 a[16:31], v[144:147], a[252:255], a[16:31]
  v_mfma_f32_32x32x16_bf16 a[48:63], v[148:151], a[252:255], a[48:63]
  buffer_load_dwordx4 v[104:107], v14, s[52:55], s67 offen offset:2048 sc1
  buffer_load_dwordx4 v[108:111], v16, s[52:55], s67 offen offset:2048 sc1
  s_waitcnt vmcnt(23)
  v_mfma_f32_32x32x16_bf16 a[0:15], v[152:155], a[88:91], a[0:15]
  v_mfma_f32_32x32x16_bf16 a[32:47], v[156:159], a[88:91], a[32:47]
  s_waitcnt vmcnt(22)
  v_mfma_f32_32x32x16_bf16 a[16:31], v[152:155], a[92:95], a[16:31]
  v_mfma_f32_32x32x16_bf16 a[48:63], v[156:159], a[92:95], a[48:63]
  buffer_load_dwordx4 a[112:115], v14, s[52:55], s67 offen offset:3072 sc1
  buffer_load_dwordx4 a[116:119], v16, s[52:55], s67 offen offset:3072 sc1
  s_waitcnt vmcnt(23)
  v_mfma_f32_32x32x16_bf16 a[0:15], v[160:163], v[64:67], a[0:15]
  v_mfma_f32_32x32x16_bf16 a[32:47], v[164:167], v[64:67], a[32:47]
  s_waitcnt vmcnt(22)
  v_mfma_f32_32x32x16_bf16 a[16:31], v[160:163], v[68:71], a[16:31]
  v_mfma_f32_32x32x16_bf16 a[48:63], v[164:167], v[68:71], a[48:63]
  s_mov_b32 s67, 0xd000
  buffer_load_dwordx4 v[112:115], v14, s[52:55], s67 offen sc1
  buffer_load_dwordx4 v[116:119], v16, s[52:55], s67 offen sc1
  s_waitcnt vmcnt(23)
  v_mfma_f32_32x32x16_bf16 a[0:15], v[168:171], v[224:227], a[0:15]
  v_mfma_f32_32x32x16_bf16 a[32:47], v[172:175], v[224:227], a[32:47]
  s_waitcnt vmcnt(22)
  v_mfma_f32_32x32x16_bf16 a[16:31], v[168:171], v[228:231], a[16:31]
  v_mfma_f32_32x32x16_bf16 a[48:63], v[172:175], v[228:231], a[48:63]
  buffer_load_dwordx4 v[248:251], v14, s[52:55], s67 offen offset:1024 sc1
  buffer_load_dwordx4 v[252:255], v16, s[52:55], s67 offen offset:1024 sc1
  s_waitcnt vmcnt(23)
  v_mfma_f32_32x32x16_bf16 a[0:15], v[176:179], v[72:75], a[0:15]
  ds_read_b64_tr_b16 v[120:121], v6
  ds_read_b64_tr_b16 v[122:123], v6 offset:512
  v_mfma_f32_32x32x16_bf16 a[32:47], v[180:183], v[72:75], a[32:47]
  ds_read_b64_tr_b16 v[124:125], v7
  ds_read_b64_tr_b16 v[126:127], v7 offset:512
  s_waitcnt vmcnt(22)
  v_mfma_f32_32x32x16_bf16 a[16:31], v[176:179], v[76:79], a[16:31]
  v_mfma_f32_32x32x16_bf16 a[48:63], v[180:183], v[76:79], a[48:63]
  buffer_load_dwordx4 a[120:123], v14, s[52:55], s67 offen offset:2048 sc1
  buffer_load_dwordx4 a[124:127], v16, s[52:55], s67 offen offset:2048 sc1
  s_waitcnt vmcnt(23)
  v_mfma_f32_32x32x16_bf16 a[0:15], v[184:187], a[96:99], a[0:15]
  ds_read_b64_tr_b16 a[128:129], v6 offset:2048
  ds_read_b64_tr_b16 a[130:131], v6 offset:2560
  v_mfma_f32_32x32x16_bf16 a[32:47], v[188:191], a[96:99], a[32:47]
  ds_read_b64_tr_b16 a[132:133], v7 offset:2048
  ds_read_b64_tr_b16 a[134:135], v7 offset:2560
  s_waitcnt vmcnt(22)
  v_mfma_f32_32x32x16_bf16 a[16:31], v[184:187], a[100:103], a[16:31]
  v_mfma_f32_32x32x16_bf16 a[48:63], v[188:191], a[100:103], a[48:63]
  buffer_load_dwordx4 a[192:195], v14, s[52:55], s67 offen offset:3072 sc1
  buffer_load_dwordx4 a[196:199], v16, s[52:55], s67 offen offset:3072 sc1
  s_waitcnt vmcnt(23) lgkmcnt(6)
  v_mfma_f32_32x32x16_bf16 a[0:15], v[120:123], v[80:83], a[0:15]
  ds_read_b64_tr_b16 a[136:137], v6 offset:4096
  ds_read_b64_tr_b16 a[138:139], v6 offset:4608
  s_waitcnt lgkmcnt(6)
  v_mfma_f32_32x32x16_bf16 a[32:47], v[124:127], v[80:83], a[32:47]
  ds_read_b64_tr_b16 a[140:141], v7 offset:4096
  ds_read_b64_tr_b16 a[142:143], v7 offset:4608
  s_waitcnt vmcnt(22)
  v_mfma_f32_32x32x16_bf16 a[16:31], v[120:123], v[84:87], a[16:31]
  v_mfma_f32_32x32x16_bf16 a[48:63], v[124:127], v[84:87], a[48:63]
  s_mov_b32 s67, 0xe000
  buffer_load_dwordx4 v[192:195], v14, s[52:55], s67 offen sc1
  buffer_load_dwordx4 v[196:199], v16, s[52:55], s67 offen sc1
  s_waitcnt vmcnt(23) lgkmcnt(6)
  v_mfma_f32_32x32x16_bf16 a[0:15], a[128:131], v[232:235], a[0:15]
  ds_read_b64_tr_b16 a[144:145], v6 offset:6144
  ds_read_b64_tr_b16 a[146:147], v6 offset:6656
  s_waitcnt lgkmcnt(6)
  v_mfma_f32_32x32x16_bf16 a[32:47], a[132:135], v[232:235], a[32:47]
  ds_read_b64_tr_b16 a[148:149], v7 offset:6144
  ds_read_b64_tr_b16 a[150:151], v7 offset:6656
  s_waitcnt vmcnt(22)
  v_mfma_f32_32x32x16_bf16 a[16:31], a[128:131], v[236:239], a[16:31]
  v_mfma_f32_32x32x16_bf16 a[48:63], a[132:135], v[236:239], a[48:63]
  buffer_load_dwordx4 a[200:203], v14, s[52:55], s67 offen offset:1024 sc1
  buffer_load_dwordx4 a[204:207], v16, s[52:55], s67 offen offset:1024 sc1
  s_waitcnt vmcnt(23) lgkmcnt(6)
  v_mfma_f32_32x32x16_bf16 a[0:15], a[136:139], v[88:91], a[0:15]
  ds_read_b64_tr_b16 a[152:153], v8
  ds_read_b64_tr_b16 a[154:155], v8 offset:512
  s_waitcnt lgkmcnt(6)
  v_mfma_f32_32x32x16_bf16 a[32:47], a[140:143], v[88:91], a[32:47]
  ds_read_b64_tr_b16 a[156:157], v9
  ds_read_b64_tr_b16 a[158:159], v9 offset:512
  s_waitcnt vmcnt(22)
  v_mfma_f32_32x32x16_bf16 a[16:31], a[136:139], v[92:95], a[16:31]
  v_mfma_f32_32x32x16_bf16 a[48:63], a[140:143], v[92:95], a[48:63]
  buffer_load_dwordx4 a[64:67], v14, s[52:55], s67 offen offset:2048 sc1
  buffer_load_dwordx4 a[68:71], v16, s[52:55], s67 offen offset:2048 sc1
  s_waitcnt vmcnt(23) lgkmcnt(6)
  v_mfma_f32_32x32x16_bf16 a[0:15], a[144:147], a[104:107], a[0:15]
  ds_read_b64_tr_b16 a[160:161], v8 offset:2048
  ds_read_b64_tr_b16 a[162:163], v8 offset:2560
  s_waitcnt lgkmcnt(6)
  v_mfma_f32_32x32x16_bf16 a[32:47], a[148:151], a[104:107], a[32:47]
  ds_read_b64_tr_b16 a[164:165], v9 offset:2048
  ds_read_b64_tr_b16 a[166:167], v9 offset:2560
  s_waitcnt vmcnt(22)
  v_mfma_f32_32x32x16_bf16 a[16:31], a[144:147], a[108:111], a[16:31]
  v_mfma_f32_32x32x16_bf16 a[48:63], a[148:151], a[108:111], a[48:63]
  buffer_load_dwordx4 a[208:211], v14, s[52:55], s67 offen offset:3072 sc1
  buffer_load_dwordx4 a[212:215], v16, s[52:55], s67 offen offset:3072 sc1
  s_waitcnt vmcnt(23) lgkmcnt(6)
  v_mfma_f32_32x32x16_bf16 a[0:15], a[152:155], v[96:99], a[0:15]
  ds_read_b64_tr_b16 a[168:169], v8 offset:4096
  ds_read_b64_tr_b16 a[170:171], v8 offset:4608
  v_lshl_add_u32 v20, v0, 4, s62
  v_lshl_add_u32 v21, v0, 4, s63
  s_waitcnt lgkmcnt(6)
  v_mfma_f32_32x32x16_bf16 a[32:47], a[156:159], v[96:99], a[32:47]
  ds_read_b64_tr_b16 a[172:173], v9 offset:4096
  ds_read_b64_tr_b16 a[174:175], v9 offset:4608
  v_lshl_add_u32 v22, v0, 4, s64
  s_waitcnt vmcnt(22)
  v_mfma_f32_32x32x16_bf16 a[16:31], a[152:155], v[100:103], a[16:31]
  s_lshl_b32 s34, s28, 2
  s_or_b32 s34, s34, 0x40000
  v_mfma_f32_32x32x16_bf16 a[48:63], a[156:159], v[100:103], a[48:63]
  s_mov_b32 s67, 0xf000
  buffer_load_dwordx4 v[200:203], v14, s[52:55], s67 offen sc1
  buffer_load_dwordx4 v[204:207], v16, s[52:55], s67 offen sc1
  s_waitcnt vmcnt(23) lgkmcnt(6)
  v_mfma_f32_32x32x16_bf16 a[0:15], a[160:163], v[240:243], a[0:15]
  ds_read_b64_tr_b16 a[176:177], v8 offset:6144
  ds_read_b64_tr_b16 a[178:179], v8 offset:6656
  s_waitcnt lgkmcnt(6)
  v_mfma_f32_32x32x16_bf16 a[32:47], a[164:167], v[240:243], a[32:47]
  ds_read_b64_tr_b16 a[180:181], v9 offset:6144
  ds_read_b64_tr_b16 a[182:183], v9 offset:6656
  s_waitcnt vmcnt(22)
  v_mfma_f32_32x32x16_bf16 a[16:31], a[160:163], v[244:247], a[16:31]
  v_mfma_f32_32x32x16_bf16 a[48:63], a[164:167], v[244:247], a[48:63]
  buffer_load_dwordx4 a[216:219], v14, s[52:55], s67 offen offset:1024 sc1
  buffer_load_dwordx4 a[220:223], v16, s[52:55], s67 offen offset:1024 sc1
  s_waitcnt vmcnt(23) lgkmcnt(6)
  v_mfma_f32_32x32x16_bf16 a[0:15], a[168:171], v[104:107], a[0:15]
  ds_read_b64_tr_b16 a[184:185], v10
  ds_read_b64_tr_b16 a[186:187], v10 offset:512
  s_bfe_u32 s31, 0xd98c, s34
  s_lshl_b32 s31, s31, 13
  s_waitcnt lgkmcnt(6)
  v_mfma_f32_32x32x16_bf16 a[32:47], a[172:175], v[104:107], a[32:47]
  ds_read_b64_tr_b16 a[188:189], v11
  ds_read_b64_tr_b16 a[190:191], v11 offset:512
  v_lshl_add_u32 v23, v0, 4, s31
  s_bfe_u32 s31, 0x2673, s34
  s_waitcnt vmcnt(22)
  v_mfma_f32_32x32x16_bf16 a[16:31], a[168:171], v[108:111], a[16:31]
  s_lshl_b32 s31, s31, 13
  v_lshl_add_u32 v24, v0, 4, s31
  v_mfma_f32_32x32x16_bf16 a[48:63], a[172:175], v[108:111], a[48:63]
  buffer_load_dwordx4 a[72:75], v14, s[52:55], s67 offen offset:2048 sc1
  buffer_load_dwordx4 a[76:79], v16, s[52:55], s67 offen offset:2048 sc1
  s_waitcnt vmcnt(23) lgkmcnt(6)
  v_mfma_f32_32x32x16_bf16 a[0:15], a[176:179], a[112:115], a[0:15]
  ds_read_b64_tr_b16 v[32:33], v10 offset:2048
  ds_read_b64_tr_b16 v[34:35], v10 offset:2560
  s_waitcnt lgkmcnt(6)
  v_mfma_f32_32x32x16_bf16 a[32:47], a[180:183], a[112:115], a[32:47]
  ds_read_b64_tr_b16 v[36:37], v11 offset:2048
  ds_read_b64_tr_b16 v[38:39], v11 offset:2560
  s_waitcnt vmcnt(22)
  v_mfma_f32_32x32x16_bf16 a[16:31], a[176:179], a[116:119], a[16:31]
  v_mfma_f32_32x32x16_bf16 a[48:63], a[180:183], a[116:119], a[48:63]
  buffer_load_dwordx4 a[224:227], v14, s[52:55], s67 offen offset:3072 sc1
  buffer_load_dwordx4 a[228:231], v16, s[52:55], s67 offen offset:3072 sc1
  s_waitcnt vmcnt(23) lgkmcnt(6)
  s_branch PADO_14
PADA_14:
  s_branch HOPRET_g2
PAD_14:
  s_sub_u32 s40, s40, 1
  s_cbranch_scc1 HOPRET_gb
  s_branch PAD_7
PADO_14:
  v_mfma_f32_32x32x16_bf16 a[0:15], a[184:187], v[112:115], a[0:15]
  ds_read_b64_tr_b16 v[40:41], v10 offset:4096
  ds_read_b64_tr_b16 v[42:43], v10 offset:4608
  s_bfe_u32 s31, 0xefab, s34
  s_lshl_b32 s31, s31, 13
  v_lshl_add_u32 v25, v0, 4, s31
  s_waitcnt lgkmcnt(6)
  v_mfma_f32_32x32x16_bf16 a[32:47], a[188:191], v[112:115], a[32:47]
  ds_read_b64_tr_b16 v[44:45], v11 offset:4096
  ds_read_b64_tr_b16 v[46:47], v11 offset:4608
  s_lshr_b32 s31, s28, 1
  s_mul_i32 s31, s31, 0x9000
  s_waitcnt vmcnt(22)
  v_mfma_f32_32x32x16_bf16 a[16:31], a[184:187], v[116:119], a[16:31]
  s_and_b32 s32, s28, 1
  s_lshl_b32 s32, s32, 6
  s_add_u32 s31, s31, s32
  v_mfma_f32_32x32x16_bf16 a[48:63], a[188:191], v[116:119], a[48:63]
  s_waitcnt vmcnt(21) lgkmcnt(6)
  v_mfma_f32_32x32x16_bf16 a[0:15], v[32:35], v[248:251], a[0:15]
  ds_read_b64_tr_b16 v[208:209], v10 offset:6144
  ds_read_b64_tr_b16 v[210:211], v10 offset:6656
  s_waitcnt lgkmcnt(6)
  v_mfma_f32_32x32x16_bf16 a[32:47], v[36:39], v[248:251], a[32:47]
  ds_read_b64_tr_b16 v[212:213], v11 offset:6144
  ds_read_b64_tr_b16 v[214:215], v11 offset:6656
  s_waitcnt vmcnt(20)
  v_mfma_f32_32x32x16_bf16 a[16:31], v[32:35], v[252:255], a[16:31]
  v_mfma_f32_32x32x16_bf16 a[48:63], v[36:39], v[252:255], a[48:63]
  s_waitcnt vmcnt(19) lgkmcnt(6)
  v_mfma_f32_32x32x16_bf16 a[0:15], v[40:43], a[120:123], a[0:15]
  ds_read_b64_tr_b16 v[48:49], v2
  ds_read_b64_tr_b16 v[50:51], v2 offset:512
  v_and_b32 v26, 31, v0
  v_mul_u32_u24 v26, 0x480, v26
  s_waitcnt lgkmcnt(6)
  v_mfma_f32_32x32x16_bf16 a[32:47], v[44:47], a[120:123], a[32:47]
  ds_read_b64_tr_b16 v[52:53], v3
  ds_read_b64_tr_b16 v[54:55], v3 offset:512
  v_lshrrev_b32 v27, 5, v0
  s_waitcnt vmcnt(18)
  v_mfma_f32_32x32x16_bf16 a[16:31], v[40:43], a[124:127], a[16:31]
  v_lshl_add_u32 v26, v27, 4, v26
  v_add_u32 v26, s31, v26
  v_mfma_f32_32x32x16_bf16 a[48:63], v[44:47], a[124:127], a[48:63]
  s_waitcnt vmcnt(17) lgkmcnt(6)
  v_mfma_f32_32x32x16_bf16 a[0:15], v[208:211], a[192:195], a[0:15]
  ds_read_b64_tr_b16 a[232:233], v2 offset:2048
  ds_read_b64_tr_b16 a[234:235], v2 offset:2560
  s_waitcnt lgkmcnt(6)
  v_mfma_f32_32x32x16_bf16 a[32:47], v[212:215], a[192:195], a[32:47]
  ds_read_b64_tr_b16 a[236:237], v3 offset:2048
  ds_read_b64_tr_b16 a[238:239], v3 offset:2560
  s_waitcnt vmcnt(16)
  v_mfma_f32_32x32x16_bf16 a[16:31], v[208:211], a[196:199], a[16:31]
  v_mfma_f32_32x32x16_bf16 a[48:63], v[212:215], a[196:199], a[48:63]
  s_waitcnt vmcnt(15) lgkmcnt(6)
  v_mfma_f32_32x32x16_bf16 a[0:15], v[48:51], v[192:195], a[0:15]
  ds_read_b64_tr_b16 v[56:57], v2 offset:4096
  ds_read_b64_tr_b16 v[58:59], v2 offset:4608
  s_waitcnt lgkmcnt(6)
  v_mfma_f32_32x32x16_bf16 a[32:47], v[52:55], v[192:195], a[32:47]
  ds_read_b64_tr_b16 v[60:61], v3 offset:4096
  ds_read_b64_tr_b16 v[62:63], v3 offset:4608
  s_waitcnt vmcnt(14)
  v_mfma_f32_32x32x16_bf16 a[16:31], v[48:51], v[196:199], a[16:31]
  v_mfma_f32_32x32x16_bf16 a[48:63], v[52:55], v[196:199], a[48:63]
  s_waitcnt vmcnt(13) lgkmcnt(6)
  v_mfma_f32_32x32x16_bf16 a[0:15], a[232:235], a[200:203], a[0:15]
  ds_read_b64_tr_b16 a[80:81], v2 offset:6144
  ds_read_b64_tr_b16 a[82:83], v2 offset:6656
  s_waitcnt lgkmcnt(6)
  v_mfma_f32_32x32x16_bf16 a[32:47], a[236:239], a[200:203], a[32:47]
  ds_read_b64_tr_b16 a[84:85], v3 offset:6144
  ds_read_b64_tr_b16 a[86:87], v3 offset:6656
  s_waitcnt vmcnt(12)
  v_mfma_f32_32x32x16_bf16 a[16:31], a[232:235], a[204:207], a[16:31]
  v_mfma_f32_32x32x16_bf16 a[48:63], a[236:239], a[204:207], a[48:63]
  s_waitcnt vmcnt(11) lgkmcnt(6)
  v_mfma_f32_32x32x16_bf16 a[0:15], v[56:59], a[64:67], a[0:15]
  ds_read_b64_tr_b16 v[128:129], v4
  ds_read_b64_tr_b16 v[130:131], v4 offset:512
  s_waitcnt lgkmcnt(6)
  v_mfma_f32_32x32x16_bf16 a[32:47], v[60:63], a[64:67], a[32:47]
  ds_read_b64_tr_b16 v[132:133], v5
  ds_read_b64_tr_b16 v[134:135], v5 offset:512
  s_waitcnt vmcnt(10)
  v_mfma_f32_32x32x16_bf16 a[16:31], v[56:59], a[68:71], a[16:31]
  v_mfma_f32_32x32x16_bf16 a[48:63], v[60:63], a[68:71], a[48:63]
  s_waitcnt vmcnt(9) lgkmcnt(6)
  v_mfma_f32_32x32x16_bf16 a[0:15], a[80:83], a[208:211], a[0:15]
  ds_read_b64_tr_b16 a[240:241], v4 offset:2048
  ds_read_b64_tr_b16 a[242:243], v4 offset:2560
  s_waitcnt lgkmcnt(6)
  v_mfma_f32_32x32x16_bf16 a[32:47], a[84:87], a[208:211], a[32:47]
  ds_read_b64_tr_b16 a[244:245], v5 offset:2048
  ds_read_b64_tr_b16 a[246:247], v5 offset:2560
  s_waitcnt vmcnt(8)
  v_mfma_f32_32x32x16_bf16 a[16:31], a[80:83], a[212:215], a[16:31]
  v_mfma_f32_32x32x16_bf16 a[48:63], a[84:87], a[212:215], a[48:63]
  s_waitcnt vmcnt(7) lgkmcnt(6)
  v_mfma_f32_32x32x16_bf16 a[0:15], v[128:131], v[200:203], a[0:15]
  ds_read_b64_tr_b16 v[136:137], v4 offset:4096
  ds_read_b64_tr_b16 v[138:139], v4 offset:4608
  s_waitcnt lgkmcnt(6)
  v_mfma_f32_32x32x16_bf16 a[32:47], v[132:135], v[200:203], a[32:47]
  ds_read_b64_tr_b16 v[140:141], v5 offset:4096
  ds_read_b64_tr_b16 v[142:143], v5 offset:4608
  s_waitcnt vmcnt(6)
  v_mfma_f32_32x32x16_bf16 a[16:31], v[128:131], v[204:207], a[16:31]
  v_mfma_f32_32x32x16_bf16 a[48:63], v[132:135], v[204:207], a[48:63]
  s_waitcnt vmcnt(5) lgkmcnt(6)
  v_mfma_f32_32x32x16_bf16 a[0:15], a[240:243], a[216:219], a[0:15]
  ds_read_b64_tr_b16 v[216:217], v4 offset:6144
  ds_read_b64_tr_b16 v[218:219], v4 offset:6656
  s_waitcnt lgkmcnt(6)
  v_mfma_f32_32x32x16_bf16 a[32:47], a[244:247], a[216:219], a[32:47]
  ds_read_b64_tr_b16 v[220:221], v5 offset:6144
  ds_read_b64_tr_b16 v[222:223], v5 offset:6656
  s_waitcnt vmcnt(4)
  v_mfma_f32_32x32x16_bf16 a[16:31], a[240:243], a[220:223], a[16:31]
  v_mfma_f32_32x32x16_bf16 a[48:63], a[244:247], a[220:223], a[48:63]
  s_waitcnt vmcnt(3) lgkmcnt(6)
  v_mfma_f32_32x32x16_bf16 a[0:15], v[136:139], a[72:75], a[0:15]
  s_waitcnt lgkmcnt(4)
  v_mfma_f32_32x32x16_bf16 a[32:47], v[140:143], a[72:75], a[32:47]
  s_waitcnt vmcnt(2)
  v_mfma_f32_32x32x16_bf16 a[16:31], v[136:139], a[76:79], a[16:31]
  v_mfma_f32_32x32x16_bf16 a[48:63], v[140:143], a[76:79], a[48:63]
  s_waitcnt vmcnt(1) lgkmcnt(0)
  v_mfma_f32_32x32x16_bf16 a[32:47], v[220:223], a[224:227], a[32:47]
  s_waitcnt vmcnt(0)
  v_mfma_f32_32x32x16_bf16 a[16:31], v[216:219], a[228:231], a[16:31]
  v_mfma_f32_32x32x16_bf16 a[48:63], v[220:223], a[228:231], a[48:63]
  v_mfma_f32_32x32x16_bf16 a[0:15], v[216:219], a[224:227], a[0:15]
  ds_write_b128 v20, a[32:35]
  ds_write_b128 v20, a[36:39] offset:1024
  ds_write_b128 v20, a[40:43] offset:2048
  ds_write_b128 v20, a[44:47] offset:3072
  ds_write_b128 v21, a[16:19]
  ds_write_b128 v21, a[20:23] offset:1024
  ds_write_b128 v21, a[24:27] offset:2048
  ds_write_b128 v21, a[28:31] offset:3072
  ds_write_b128 v22, a[48:51]
  ds_write_b128 v22, a[52:55] offset:1024
  ds_write_b128 v22, a[56:59] offset:2048
  ds_write_b128 v22, a[60:63] offset:3072
  v_accvgpr_read_b32 v32, a0
  v_accvgpr_read_b32 v33, a1
  v_accvgpr_read_b32 v34, a2
  v_accvgpr_read_b32 v35, a3
  v_accvgpr_read_b32 v36, a4
  v_accvgpr_read_b32 v37, a5
  v_accvgpr_read_b32 v38, a6
  v_accvgpr_read_b32 v39, a7
  v_accvgpr_read_b32 v40, a8
  v_accvgpr_read_b32 v41, a9
  v_accvgpr_read_b32 v42, a10
  v_accvgpr_read_b32 v43, a11
  v_accvgpr_read_b32 v44, a12
  v_accvgpr_read_b32 v45, a13
  v_accvgpr_read_b32 v46, a14
  v_accvgpr_read_b32 v47, a15
  s_waitcnt lgkmcnt(0)
  s_barrier
  ds_read_b128 v[48:51], v23
  ds_read_b128 v[52:55], v23 offset:1024
  ds_read_b128 v[56:59], v23 offset:2048
  ds_read_b128 v[60:63], v23 offset:3072
  ds_read_b128 v[64:67], v24
  ds_read_b128 v[68:71], v24 offset:1024
  ds_read_b128 v[72:75], v24 offset:2048
  ds_read_b128 v[76:79], v24 offset:3072
  ds_read_b128 v[80:83], v25
  ds_read_b128 v[84:87], v25 offset:1024
  ds_read_b128 v[88:91], v25 offset:2048
  ds_read_b128 v[92:95], v25 offset:3072
  s_waitcnt lgkmcnt(11)
  v_add_f32 v32, v32, v48
  v_add_f32 v33, v33, v49
  v_add_f32 v34, v34, v50
  v_add_f32 v35, v35, v51
  s_waitcnt lgkmcnt(10)
  v_add_f32 v36, v36, v52
  v_add_f32 v37, v37, v53
  v_add_f32 v38, v38, v54
  v_add_f32 v39, v39, v55
  s_waitcnt lgkmcnt(3)
  v_add_f32 v64, v64, v80
  v_add_f32 v65, v65, v81
  v_add_f32 v66, v66, v82
  v_add_f32 v67, v67, v83
  s_waitcnt lgkmcnt(2)
  v_add_f32 v68, v68, v84
  v_add_f32 v69, v69, v85
  v_add_f32 v70, v70, v86
  v_add_f32 v71, v71, v87
  v_add_f32 v32, v32, v64
  v_add_f32 v33, v33, v65
  v_add_f32 v34, v34, v66
  v_add_f32 v35, v35, v67
  v_add_f32 v36, v36, v68
  v_add_f32 v37, v37, v69
  v_add_f32 v38, v38, v70
  v_add_f32 v39, v39, v71
  v_cvt_pk_bf16_f32 v100, v32, v33
  v_cvt_pk_bf16_f32 v101, v34, v35
  v_cvt_pk_bf16_f32 v102, v36, v37
  v_cvt_pk_bf16_f32 v103, v38, v39
  buffer_store_dwordx4 v[100:103], v26, s[56:59], 0 offen
  v_add_f32 v40, v40, v56
  v_add_f32 v41, v41, v57
  v_add_f32 v42, v42, v58
  v_add_f32 v43, v43, v59
  v_add_f32 v44, v44, v60
  v_add_f32 v45, v45, v61
  v_add_f32 v46, v46, v62
  v_add_f32 v47, v47, v63
  s_waitcnt lgkmcnt(1)
  v_add_f32 v72, v72, v88
  v_add_f32 v73, v73, v89
  v_add_f32 v74, v74, v90
  v_add_f32 v75, v75, v91
  s_waitcnt lgkmcnt(0)
  v_add_f32 v76, v76, v92
  v_add_f32 v77, v77, v93
  v_add_f32 v78, v78, v94
  v_add_f32 v79, v79, v95
  v_add_f32 v40, v40, v72
  v_add_f32 v41, v41, v73
  v_add_f32 v42, v42, v74
  v_add_f32 v43, v43, v75
  v_add_f32 v44, v44, v76
  v_add_f32 v45, v45, v77
  v_add_f32 v46, v46, v78
  v_add_f32 v47, v47, v79
  v_cvt_pk_bf16_f32 v104, v40, v41
  v_cvt_pk_bf16_f32 v105, v42, v43
  v_cvt_pk_bf16_f32 v106, v44, v45
  v_cvt_pk_bf16_f32 v107, v46, v47
  buffer_store_dwordx4 v[104:107], v26, s[56:59], 0 offen offset:32
F_EXIT:
  s_waitcnt vmcnt(0)
A_DONE:
A_end:
  s_endpgm
FBS_1:
  s_mov_b32 s41, 1
  s_branch FB_A
FBS_3:
  s_mov_b32 s41, 3
  s_branch FB_A
FBS_5:
  s_mov_b32 s41, 5
  s_branch FB_A
FBS_7:
  s_mov_b32 s41, 7
  s_branch FB_A
FBS_9:
  s_mov_b32 s41, 9
  s_branch FB_A
FBS_11:
  s_mov_b32 s41, 11
  s_branch FB_A
FBS_13:
  s_mov_b32 s41, 13
  s_branch FB_A
FBS_15:
  s_mov_b32 s41, 15
  s_branch FB_A
FB_A:
  s_nop 15
  s_nop 15
  v_max3_f32 v28, v128, v129, v130
  v_max3_f32 v28, v28, v131, v132
  v_max3_f32 v28, v28, v133, v134
  v_max3_f32 v28, v28, v135, v136
  v_max3_f32 v28, v28, v137, v138
  v_max3_f32 v28, v28, v139, v140
  v_max3_f32 v28, v28, v141, v142
  v_max_f32 v28, v28, v143
  v_mov_b32 v29, v28
  s_nop 1
  v_permlane32_swap_b32 v28, v29
  v_max_f32 v28, v28, v29
  v_max_f32 v28, 0, v28
  v_sub_f32 v29, 0, v28
  v_exp_f32 v29, v29
  s_nop 1
  v_mul_f32 v26, v26, v29
  v_accvgpr_read_b32 v30, a0
  v_mul_f32 v30, v30, v29
  v_accvgpr_write_b32 a0, v30
  v_accvgpr_read_b32 v30, a1
  v_mul_f32 v30, v30, v29
  v_accvgpr_write_b32 a1, v30
  v_accvgpr_read_b32 v30, a2
  v_mul_f32 v30, v30, v29
  v_accvgpr_write_b32 a2, v30
  v_accvgpr_read_b32 v30, a3
  v_mul_f32 v30, v30, v29
  v_accvgpr_write_b32 a3, v30
  v_accvgpr_read_b32 v30, a4
  v_mul_f32 v30, v30, v29
  v_accvgpr_write_b32 a4, v30
  v_accvgpr_read_b32 v30, a5
  v_mul_f32 v30, v30, v29
  v_accvgpr_write_b32 a5, v30
  v_accvgpr_read_b32 v30, a6
  v_mul_f32 v30, v30, v29
  v_accvgpr_write_b32 a6, v30
  v_accvgpr_read_b32 v30, a7
  v_mul_f32 v30, v30, v29
  v_accvgpr_write_b32 a7, v30
  v_accvgpr_read_b32 v30, a8
  v_mul_f32 v30, v30, v29
  v_accvgpr_write_b32 a8, v30
  v_accvgpr_read_b32 v30, a9
  v_mul_f32 v30, v30, v29
  v_accvgpr_write_b32 a9, v30
  v_accvgpr_read_b32 v30, a10
  v_mul_f32 v30, v30, v29
  v_accvgpr_write_b32 a10, v30
  v_accvgpr_read_b32 v30, a11
  v_mul_f32 v30, v30, v29
  v_accvgpr_write_b32 a11, v30
  v_accvgpr_read_b32 v30, a12
  v_mul_f32 v30, v30, v29
  v_accvgpr_write_b32 a12, v30
  v_accvgpr_read_b32 v30, a13
  v_mul_f32 v30, v30, v29
  v_accvgpr_write_b32 a13, v30
  v_accvgpr_read_b32 v30, a14
  v_mul_f32 v30, v30, v29
  v_accvgpr_write_b32 a14, v30
  v_accvgpr_read_b32 v30, a15
  v_mul_f32 v30, v30, v29
  v_accvgpr_write_b32 a15, v30
  v_accvgpr_read_b32 v30, a16
  v_mul_f32 v30, v30, v29
  v_accvgpr_write_b32 a16, v30
  v_accvgpr_read_b32 v30, a17
  v_mul_f32 v30, v30, v29
  v_accvgpr_write_b32 a17, v30
  v_accvgpr_read_b32 v30, a18
  v_mul_f32 v30, v30, v29
  v_accvgpr_write_b32 a18, v30
  v_accvgpr_read_b32 v30, a19
  v_mul_f32 v30, v30, v29
  v_accvgpr_write_b32 a19, v30
  v_accvgpr_read_b32 v30, a20
  v_mul_f32 v30, v30, v29
  v_accvgpr_write_b32 a20, v30
  v_accvgpr_read_b32 v30, a21
  v_mul_f32 v30, v30, v29
  v_accvgpr_write_b32 a21, v30
  v_accvgpr_read_b32 v30, a22
  v_mul_f32 v30, v30, v29
  v_accvgpr_write_b32 a22, v30
  v_accvgpr_read_b32 v30, a23
  v_mul_f32 v30, v30, v29
  v_accvgpr_write_b32 a23, v30
  v_accvgpr_read_b32 v30, a24
  v_mul_f32 v30, v30, v29
  v_accvgpr_write_b32 a24, v30
  v_accvgpr_read_b32 v30, a25
  v_mul_f32 v30, v30, v29
  v_accvgpr_write_b32 a25, v30
  v_accvgpr_read_b32 v30, a26
  v_mul_f32 v30, v30, v29
  v_accvgpr_write_b32 a26, v30
  v_accvgpr_read_b32 v30, a27
  v_mul_f32 v30, v30, v29
  v_accvgpr_write_b32 a27, v30
  v_accvgpr_read_b32 v30, a28
  v_mul_f32 v30, v30, v29
  v_accvgpr_write_b32 a28, v30
  v_accvgpr_read_b32 v30, a29
  v_mul_f32 v30, v30, v29
  v_accvgpr_write_b32 a29, v30
  v_accvgpr_read_b32 v30, a30
  v_mul_f32 v30, v30, v29
  v_accvgpr_write_b32 a30, v30
  v_accvgpr_read_b32 v30, a31
  v_mul_f32 v30, v30, v29
  v_accvgpr_write_b32 a31, v30
  v_accvgpr_read_b32 v30, a32
  v_mul_f32 v30, v30, v29
  v_accvgpr_write_b32 a32, v30
  v_accvgpr_read_b32 v30, a33
  v_mul_f32 v30, v30, v29
  v_accvgpr_write_b32 a33, v30
  v_accvgpr_read_b32 v30, a34
  v_mul_f32 v30, v30, v29
  v_accvgpr_write_b32 a34, v30
  v_accvgpr_read_b32 v30, a35
  v_mul_f32 v30, v30, v29
  v_accvgpr_write_b32 a35, v30
  v_accvgpr_read_b32 v30, a36
  v_mul_f32 v30, v30, v29
  v_accvgpr_write_b32 a36, v30
  v_accvgpr_read_b32 v30, a37
  v_mul_f32 v30, v30, v29
  v_accvgpr_write_b32 a37, v30
  v_accvgpr_read_b32 v30, a38
  v_mul_f32 v30, v30, v29
  v_accvgpr_write_b32 a38, v30
  v_accvgpr_read_b32 v30, a39
  v_mul_f32 v30, v30, v29
  v_accvgpr_write_b32 a39, v30
  v_accvgpr_read_b32 v30, a40
  v_mul_f32 v30, v30, v29
  v_accvgpr_write_b32 a40, v30
  v_accvgpr_read_b32 v30, a41
  v_mul_f32 v30, v30, v29
  v_accvgpr_write_b32 a41, v30
  v_accvgpr_read_b32 v30, a42
  v_mul_f32 v30, v30, v29
  v_accvgpr_write_b32 a42, v30
  v_accvgpr_read_b32 v30, a43
  v_mul_f32 v30, v30, v29
  v_accvgpr_write_b32 a43, v30
  v_accvgpr_read_b32 v30, a44
  v_mul_f32 v30, v30, v29
  v_accvgpr_write_b32 a44, v30
  v_accvgpr_read_b32 v30, a45
  v_mul_f32 v30, v30, v29
  v_accvgpr_write_b32 a45, v30
  v_accvgpr_read_b32 v30, a46
  v_mul_f32 v30, v30, v29
  v_accvgpr_write_b32 a46, v30
  v_accvgpr_read_b32 v30, a47
  v_mul_f32 v30, v30, v29
  v_accvgpr_write_b32 a47, v30
  v_accvgpr_read_b32 v30, a48
  v_mul_f32 v30, v30, v29
  v_accvgpr_write_b32 a48, v30
  v_accvgpr_read_b32 v30, a49
  v_mul_f32 v30, v30, v29
  v_accvgpr_write_b32 a49, v30
  v_accvgpr_read_b32 v30, a50
  v_mul_f32 v30, v30, v29
  v_accvgpr_write_b32 a50, v30
  v_accvgpr_read_b32 v30, a51
  v_mul_f32 v30, v30, v29
  v_accvgpr_write_b32 a51, v30
  v_accvgpr_read_b32 v30, a52
  v_mul_f32 v30, v30, v29
  v_accvgpr_write_b32 a52, v30
  v_accvgpr_read_b32 v30, a53
  v_mul_f32 v30, v30, v29
  v_accvgpr_write_b32 a53, v30
  v_accvgpr_read_b32 v30, a54
  v_mul_f32 v30, v30, v29
  v_accvgpr_write_b32 a54, v30
  v_accvgpr_read_b32 v30, a55
  v_mul_f32 v30, v30, v29
  v_accvgpr_write_b32 a55, v30
  v_accvgpr_read_b32 v30, a56
  v_mul_f32 v30, v30, v29
  v_accvgpr_write_b32 a56, v30
  v_accvgpr_read_b32 v30, a57
  v_mul_f32 v30, v30, v29
  v_accvgpr_write_b32 a57, v30
  v_accvgpr_read_b32 v30, a58
  v_mul_f32 v30, v30, v29
  v_accvgpr_write_b32 a58, v30
  v_accvgpr_read_b32 v30, a59
  v_mul_f32 v30, v30, v29
  v_accvgpr_write_b32 a59, v30
  v_accvgpr_read_b32 v30, a60
  v_mul_f32 v30, v30, v29
  v_accvgpr_write_b32 a60, v30
  v_accvgpr_read_b32 v30, a61
  v_mul_f32 v30, v30, v29
  v_accvgpr_write_b32 a61, v30
  v_accvgpr_read_b32 v30, a62
  v_mul_f32 v30, v30, v29
  v_accvgpr_write_b32 a62, v30
  v_accvgpr_read_b32 v30, a63
  v_mul_f32 v30, v30, v29
  v_accvgpr_write_b32 a63, v30
  v_sub_f32 v160, v160, v28
  v_sub_f32 v128, v128, v28
  v_sub_f32 v161, v161, v28
  v_sub_f32 v129, v129, v28
  v_sub_f32 v162, v162, v28
  v_sub_f32 v130, v130, v28
  v_sub_f32 v163, v163, v28
  v_sub_f32 v131, v131, v28
  v_sub_f32 v164, v164, v28
  v_sub_f32 v132, v132, v28
  v_sub_f32 v165, v165, v28
  v_sub_f32 v133, v133, v28
  v_sub_f32 v166, v166, v28
  v_sub_f32 v134, v134, v28
  v_sub_f32 v167, v167, v28
  v_sub_f32 v135, v135, v28
  v_sub_f32 v168, v168, v28
  v_sub_f32 v136, v136, v28
  v_sub_f32 v169, v169, v28
  v_sub_f32 v137, v137, v28
  v_sub_f32 v170, v170, v28
  v_sub_f32 v138, v138, v28
  v_sub_f32 v171, v171, v28
  v_sub_f32 v139, v139, v28
  v_sub_f32 v172, v172, v28
  v_sub_f32 v140, v140, v28
  v_sub_f32 v173, v173, v28
  v_sub_f32 v141, v141, v28
  v_sub_f32 v174, v174, v28
  v_sub_f32 v142, v142, v28
  v_sub_f32 v175, v175, v28
  v_sub_f32 v143, v143, v28
  v_exp_f32 v16, v128
  v_exp_f32 v17, v129
  v_exp_f32 v18, v130
  v_add_f32 v24, v16, v17
  v_cvt_pk_bf16_f32 v32, v16, v17
  v_exp_f32 v19, v131
  v_add_f32 v24, v24, v18
  v_exp_f32 v20, v132
  v_add_f32 v24, v24, v19
  v_cvt_pk_bf16_f32 v33, v18, v19
  v_exp_f32 v21, v133
  v_add_f32 v24, v24, v20
  v_exp_f32 v22, v134
  v_add_f32 v24, v24, v21
  v_cvt_pk_bf16_f32 v34, v20, v21
  v_exp_f32 v23, v135
  v_add_f32 v24, v24, v22
  v_exp_f32 v16, v136
  v_add_f32 v24, v24, v23
  v_cvt_pk_bf16_f32 v35, v22, v23
  v_exp_f32 v17, v137
  v_add_f32 v24, v24, v16
  v_exp_f32 v18, v138
  v_add_f32 v24, v24, v17
  v_cvt_pk_bf16_f32 v36, v16, v17
  v_exp_f32 v19, v139
  v_add_f32 v24, v24, v18
  v_exp_f32 v20, v140
  v_add_f32 v24, v24, v19
  v_cvt_pk_bf16_f32 v37, v18, v19
  v_exp_f32 v21, v141
  v_add_f32 v24, v24, v20
  v_exp_f32 v22, v142
  v_add_f32 v24, v24, v21
  v_cvt_pk_bf16_f32 v38, v20, v21
  v_exp_f32 v23, v143
  v_add_f32 v24, v24, v22
  v_add_f32 v24, v24, v23
  v_cvt_pk_bf16_f32 v39, v22, v23
  s_nop 7
  s_cmp_eq_u32 s41, 1
  s_cbranch_scc1 RET_1
  s_cmp_eq_u32 s41, 3
  s_cbranch_scc1 RET_3
  s_cmp_eq_u32 s41, 5
  s_cbranch_scc1 RET_5
  s_cmp_eq_u32 s41, 7
  s_cbranch_scc1 RET_7
  s_cmp_eq_u32 s41, 9
  s_cbranch_scc1 RET_9
  s_cmp_eq_u32 s41, 11
  s_cbranch_scc1 RET_11
  s_cmp_eq_u32 s41, 13
  s_cbranch_scc1 RET_13
  s_branch RET_15
FBS_0:
  s_mov_b32 s41, 0
  s_branch FB_B
FBS_2:
  s_mov_b32 s41, 2
  s_branch FB_B
FBS_4:
  s_mov_b32 s41, 4
  s_branch FB_B
FBS_6:
  s_mov_b32 s41, 6
  s_branch FB_B
FBS_8:
  s_mov_b32 s41, 8
  s_branch FB_B
FBS_10:
  s_mov_b32 s41, 10
  s_branch FB_B
FBS_12:
  s_mov_b32 s41, 12
  s_branch FB_B
FBS_14:
  s_mov_b32 s41, 14
  s_branch FB_B
FBS_16:
  s_mov_b32 s41, 16
  s_branch FB_B
FB_B:
  s_nop 15
  s_nop 15
  v_max3_f32 v28, v144, v145, v146
  v_max3_f32 v28, v28, v147, v148
  v_max3_f32 v28, v28, v149, v150
  v_max3_f32 v28, v28, v151, v152
  v_max3_f32 v28, v28, v153, v154
  v_max3_f32 v28, v28, v155, v156
  v_max3_f32 v28, v28, v157, v158
  v_max_f32 v28, v28, v159
  v_mov_b32 v29, v28
  s_nop 1
  v_permlane32_swap_b32 v28, v29
  v_max_f32 v28, v28, v29
  v_max_f32 v28, 0, v28
  v_sub_f32 v29, 0, v28
  v_exp_f32 v29, v29
  s_nop 1
  v_mul_f32 v27, v27, v29
  v_accvgpr_read_b32 v30, a64
  v_mul_f32 v30, v30, v29
  v_accvgpr_write_b32 a64, v30
  v_accvgpr_read_b32 v30, a65
  v_mul_f32 v30, v30, v29
  v_accvgpr_write_b32 a65, v30
  v_accvgpr_read_b32 v30, a66
  v_mul_f32 v30, v30, v29
  v_accvgpr_write_b32 a66, v30
  v_accvgpr_read_b32 v30, a67
  v_mul_f32 v30, v30, v29
  v_accvgpr_write_b32 a67, v30
  v_accvgpr_read_b32 v30, a68
  v_mul_f32 v30, v30, v29
  v_accvgpr_write_b32 a68, v30
  v_accvgpr_read_b32 v30, a69
  v_mul_f32 v30, v30, v29
  v_accvgpr_write_b32 a69, v30
  v_accvgpr_read_b32 v30, a70
  v_mul_f32 v30, v30, v29
  v_accvgpr_write_b32 a70, v30
  v_accvgpr_read_b32 v30, a71
  v_mul_f32 v30, v30, v29
  v_accvgpr_write_b32 a71, v30
  v_accvgpr_read_b32 v30, a72
  v_mul_f32 v30, v30, v29
  v_accvgpr_write_b32 a72, v30
  v_accvgpr_read_b32 v30, a73
  v_mul_f32 v30, v30, v29
  v_accvgpr_write_b32 a73, v30
  v_accvgpr_read_b32 v30, a74
  v_mul_f32 v30, v30, v29
  v_accvgpr_write_b32 a74, v30
  v_accvgpr_read_b32 v30, a75
  v_mul_f32 v30, v30, v29
  v_accvgpr_write_b32 a75, v30
  v_accvgpr_read_b32 v30, a76
  v_mul_f32 v30, v30, v29
  v_accvgpr_write_b32 a76, v30
  v_accvgpr_read_b32 v30, a77
  v_mul_f32 v30, v30, v29
  v_accvgpr_write_b32 a77, v30
  v_accvgpr_read_b32 v30, a78
  v_mul_f32 v30, v30, v29
  v_accvgpr_write_b32 a78, v30
  v_accvgpr_read_b32 v30, a79
  v_mul_f32 v30, v30, v29
  v_accvgpr_write_b32 a79, v30
  v_accvgpr_read_b32 v30, a80
  v_mul_f32 v30, v30, v29
  v_accvgpr_write_b32 a80, v30
  v_accvgpr_read_b32 v30, a81
  v_mul_f32 v30, v30, v29
  v_accvgpr_write_b32 a81, v30
  v_accvgpr_read_b32 v30, a82
  v_mul_f32 v30, v30, v29
  v_accvgpr_write_b32 a82, v30
  v_accvgpr_read_b32 v30, a83
  v_mul_f32 v30, v30, v29
  v_accvgpr_write_b32 a83, v30
  v_accvgpr_read_b32 v30, a84
  v_mul_f32 v30, v30, v29
  v_accvgpr_write_b32 a84, v30
  v_accvgpr_read_b32 v30, a85
  v_mul_f32 v30, v30, v29
  v_accvgpr_write_b32 a85, v30
  v_accvgpr_read_b32 v30, a86
  v_mul_f32 v30, v30, v29
  v_accvgpr_write_b32 a86, v30
  v_accvgpr_read_b32 v30, a87
  v_mul_f32 v30, v30, v29
  v_accvgpr_write_b32 a87, v30
  v_accvgpr_read_b32 v30, a88
  v_mul_f32 v30, v30, v29
  v_accvgpr_write_b32 a88, v30
  v_accvgpr_read_b32 v30, a89
  v_mul_f32 v30, v30, v29
  v_accvgpr_write_b32 a89, v30
  v_accvgpr_read_b32 v30, a90
  s_branch PADO_15
  s_nop 0
PAD_15:
  s_nop 0
  s_nop 0
  s_endpgm
PADO_15:
  v_mul_f32 v30, v30, v29
  v_accvgpr_write_b32 a90, v30
  v_accvgpr_read_b32 v30, a91
  v_mul_f32 v30, v30, v29
  v_accvgpr_write_b32 a91, v30
  v_accvgpr_read_b32 v30, a92
  v_mul_f32 v30, v30, v29
  v_accvgpr_write_b32 a92, v30
  v_accvgpr_read_b32 v30, a93
  v_mul_f32 v30, v30, v29
  v_accvgpr_write_b32 a93, v30
  v_accvgpr_read_b32 v30, a94
  v_mul_f32 v30, v30, v29
  v_accvgpr_write_b32 a94, v30
  v_accvgpr_read_b32 v30, a95
  v_mul_f32 v30, v30, v29
  v_accvgpr_write_b32 a95, v30
  v_accvgpr_read_b32 v30, a96
  v_mul_f32 v30, v30, v29
  v_accvgpr_write_b32 a96, v30
  v_accvgpr_read_b32 v30, a97
  v_mul_f32 v30, v30, v29
  v_accvgpr_write_b32 a97, v30
  v_accvgpr_read_b32 v30, a98
  v_mul_f32 v30, v30, v29
  v_accvgpr_write_b32 a98, v30
  v_accvgpr_read_b32 v30, a99
  v_mul_f32 v30, v30, v29
  v_accvgpr_write_b32 a99, v30
  v_accvgpr_read_b32 v30, a100
  v_mul_f32 v30, v30, v29
  v_accvgpr_write_b32 a100, v30
  v_accvgpr_read_b32 v30, a101
  v_mul_f32 v30, v30, v29
  v_accvgpr_write_b32 a101, v30
  v_accvgpr_read_b32 v30, a102
  v_mul_f32 v30, v30, v29
  v_accvgpr_write_b32 a102, v30
  v_accvgpr_read_b32 v30, a103
  v_mul_f32 v30, v30, v29
  v_accvgpr_write_b32 a103, v30
  v_accvgpr_read_b32 v30, a104
  v_mul_f32 v30, v30, v29
  v_accvgpr_write_b32 a104, v30
  v_accvgpr_read_b32 v30, a105
  v_mul_f32 v30, v30, v29
  v_accvgpr_write_b32 a105, v30
  v_accvgpr_read_b32 v30, a106
  v_mul_f32 v30, v30, v29
  v_accvgpr_write_b32 a106, v30
  v_accvgpr_read_b32 v30, a107
  v_mul_f32 v30, v30, v29
  v_accvgpr_write_b32 a107, v30
  v_accvgpr_read_b32 v30, a108
  v_mul_f32 v30, v30, v29
  v_accvgpr_write_b32 a108, v30
  v_accvgpr_read_b32 v30, a109
  v_mul_f32 v30, v30, v29
  v_accvgpr_write_b32 a109, v30
  v_accvgpr_read_b32 v30, a110
  v_mul_f32 v30, v30, v29
  v_accvgpr_write_b32 a110, v30
  v_accvgpr_read_b32 v30, a111
  v_mul_f32 v30, v30, v29
  v_accvgpr_write_b32 a111, v30
  v_accvgpr_read_b32 v30, a112
  v_mul_f32 v30, v30, v29
  v_accvgpr_write_b32 a112, v30
  v_accvgpr_read_b32 v30, a113
  v_mul_f32 v30, v30, v29
  v_accvgpr_write_b32 a113, v30
  v_accvgpr_read_b32 v30, a114
  v_mul_f32 v30, v30, v29
  v_accvgpr_write_b32 a114, v30
  v_accvgpr_read_b32 v30, a115
  v_mul_f32 v30, v30, v29
  v_accvgpr_write_b32 a115, v30
  v_accvgpr_read_b32 v30, a116
  v_mul_f32 v30, v30, v29
  v_accvgpr_write_b32 a116, v30
  v_accvgpr_read_b32 v30, a117
  v_mul_f32 v30, v30, v29
  v_accvgpr_write_b32 a117, v30
  v_accvgpr_read_b32 v30, a118
  v_mul_f32 v30, v30, v29
  v_accvgpr_write_b32 a118, v30
  v_accvgpr_read_b32 v30, a119
  v_mul_f32 v30, v30, v29
  v_accvgpr_write_b32 a119, v30
  v_accvgpr_read_b32 v30, a120
  v_mul_f32 v30, v30, v29
  v_accvgpr_write_b32 a120, v30
  v_accvgpr_read_b32 v30, a121
  v_mul_f32 v30, v30, v29
  v_accvgpr_write_b32 a121, v30
  v_accvgpr_read_b32 v30, a122
  v_mul_f32 v30, v30, v29
  v_accvgpr_write_b32 a122, v30
  v_accvgpr_read_b32 v30, a123
  v_mul_f32 v30, v30, v29
  v_accvgpr_write_b32 a123, v30
  v_accvgpr_read_b32 v30, a124
  v_mul_f32 v30, v30, v29
  v_accvgpr_write_b32 a124, v30
  v_accvgpr_read_b32 v30, a125
  v_mul_f32 v30, v30, v29
  v_accvgpr_write_b32 a125, v30
  v_accvgpr_read_b32 v30, a126
  v_mul_f32 v30, v30, v29
  v_accvgpr_write_b32 a126, v30
  v_accvgpr_read_b32 v30, a127
  v_mul_f32 v30, v30, v29
  v_accvgpr_write_b32 a127, v30
  v_sub_f32 v176, v176, v28
  v_sub_f32 v144, v144, v28
  v_sub_f32 v177, v177, v28
  v_sub_f32 v145, v145, v28
  v_sub_f32 v178, v178, v28
  v_sub_f32 v146, v146, v28
  v_sub_f32 v179, v179, v28
  v_sub_f32 v147, v147, v28
  v_sub_f32 v180, v180, v28
  v_sub_f32 v148, v148, v28
  v_sub_f32 v181, v181, v28
  v_sub_f32 v149, v149, v28
  v_sub_f32 v182, v182, v28
  v_sub_f32 v150, v150, v28
  v_sub_f32 v183, v183, v28
  v_sub_f32 v151, v151, v28
  v_sub_f32 v184, v184, v28
  v_sub_f32 v152, v152, v28
  v_sub_f32 v185, v185, v28
  v_sub_f32 v153, v153, v28
  v_sub_f32 v186, v186, v28
  v_sub_f32 v154, v154, v28
  v_sub_f32 v187, v187, v28
  v_sub_f32 v155, v155, v28
  v_sub_f32 v188, v188, v28
  v_sub_f32 v156, v156, v28
  v_sub_f32 v189, v189, v28
  v_sub_f32 v157, v157, v28
  v_sub_f32 v190, v190, v28
  v_sub_f32 v158, v158, v28
  v_sub_f32 v191, v191, v28
  v_sub_f32 v159, v159, v28
  v_exp_f32 v16, v144
  v_exp_f32 v17, v145
  v_exp_f32 v18, v146
  v_add_f32 v25, v16, v17
  v_cvt_pk_bf16_f32 v40, v16, v17
  v_exp_f32 v19, v147
  v_add_f32 v25, v25, v18
  v_exp_f32 v20, v148
  v_add_f32 v25, v25, v19
  v_cvt_pk_bf16_f32 v41, v18, v19
  v_exp_f32 v21, v149
  v_add_f32 v25, v25, v20
  v_exp_f32 v22, v150
  v_add_f32 v25, v25, v21
  v_cvt_pk_bf16_f32 v42, v20, v21
  v_exp_f32 v23, v151
  v_add_f32 v25, v25, v22
  v_exp_f32 v16, v152
  v_add_f32 v25, v25, v23
  v_cvt_pk_bf16_f32 v43, v22, v23
  v_exp_f32 v17, v153
  v_add_f32 v25, v25, v16
  v_exp_f32 v18, v154
  v_add_f32 v25, v25, v17
  v_cvt_pk_bf16_f32 v44, v16, v17
  v_exp_f32 v19, v155
  v_add_f32 v25, v25, v18
  v_exp_f32 v20, v156
  v_add_f32 v25, v25, v19
  v_cvt_pk_bf16_f32 v45, v18, v19
  v_exp_f32 v21, v157
  v_add_f32 v25, v25, v20
  v_exp_f32 v22, v158
  v_add_f32 v25, v25, v21
  v_cvt_pk_bf16_f32 v46, v20, v21
  v_exp_f32 v23, v159
  v_add_f32 v25, v25, v22
  v_add_f32 v25, v25, v23
  v_cvt_pk_bf16_f32 v47, v22, v23
  s_nop 7
  s_cmp_eq_u32 s41, 0
  s_cbranch_scc1 RET_0
  s_cmp_eq_u32 s41, 2
  s_cbranch_scc1 RET_2
  s_cmp_eq_u32 s41, 4
  s_cbranch_scc1 RET_4
  s_cmp_eq_u32 s41, 6
  s_cbranch_scc1 RET_6
  s_cmp_eq_u32 s41, 8
  s_cbranch_scc1 RET_8
  s_cmp_eq_u32 s41, 10
  s_cbranch_scc1 RET_10
  s_cmp_eq_u32 s41, 12
  s_cbranch_scc1 RET_12
  s_cmp_eq_u32 s41, 14
  s_cbranch_scc1 RET_14
  s_branch RET_16
FBS_32:
  s_mov_b32 s41, 32
  s_branch FB_A3
FBS_33:
  s_mov_b32 s41, 33
  s_branch FB_A3
FBS_34:
  s_mov_b32 s41, 34
  s_branch FB_A3
FBS_35:
  s_mov_b32 s41, 35
  s_branch FB_A3
FBS_36:
  s_mov_b32 s41, 36
  s_branch FB_A3
FBS_37:
  s_mov_b32 s41, 37
  s_branch FB_A3
FBS_38:
  s_mov_b32 s41, 38
  s_branch FB_A3
FBS_39:
  s_mov_b32 s41, 39
  s_branch FB_A3
FBS_40:
  s_mov_b32 s41, 40
  s_branch FB_A3
FBS_41:
  s_mov_b32 s41, 41
  s_branch FB_A3
FBS_42:
  s_mov_b32 s41, 42
  s_branch FB_A3
FBS_43:
  s_mov_b32 s41, 43
  s_branch FB_A3
FBS_44:
  s_mov_b32 s41, 44
  s_branch FB_A3
FBS_45:
  s_mov_b32 s41, 45
  s_branch FB_A3
FBS_46:
  s_mov_b32 s41, 46
  s_branch FB_A3
FB_A3:
  s_nop 15
  s_nop 15
  v_max3_f32 v28, v128, v129, v130
  v_max3_f32 v28, v28, v131, v132
  v_max3_f32 v28, v28, v133, v134
  v_max3_f32 v28, v28, v135, v136
  v_max3_f32 v28, v28, v137, v138
  v_max3_f32 v28, v28, v139, v140
  v_max3_f32 v28, v28, v141, v142
  v_max_f32 v28, v28, v143
  v_mov_b32 v29, v28
  s_nop 1
  v_permlane32_swap_b32 v28, v29
  v_max_f32 v28, v28, v29
  v_max_f32 v28, 0, v28
  v_sub_f32 v29, 0, v28
  v_exp_f32 v29, v29
  s_nop 1
  v_mul_f32 v26, v26, v29
  v_accvgpr_read_b32 v30, a0
  v_mul_f32 v30, v30, v29
  v_accvgpr_write_b32 a0, v30
  v_accvgpr_read_b32 v30, a1
  v_mul_f32 v30, v30, v29
  v_accvgpr_write_b32 a1, v30
  v_accvgpr_read_b32 v30, a2
  v_mul_f32 v30, v30, v29
  v_accvgpr_write_b32 a2, v30
  v_accvgpr_read_b32 v30, a3
  v_mul_f32 v30, v30, v29
  v_accvgpr_write_b32 a3, v30
  v_accvgpr_read_b32 v30, a4
  v_mul_f32 v30, v30, v29
  v_accvgpr_write_b32 a4, v30
  v_accvgpr_read_b32 v30, a5
  v_mul_f32 v30, v30, v29
  v_accvgpr_write_b32 a5, v30
  v_accvgpr_read_b32 v30, a6
  v_mul_f32 v30, v30, v29
  v_accvgpr_write_b32 a6, v30
  v_accvgpr_read_b32 v30, a7
  v_mul_f32 v30, v30, v29
  v_accvgpr_write_b32 a7, v30
  v_accvgpr_read_b32 v30, a8
  v_mul_f32 v30, v30, v29
  v_accvgpr_write_b32 a8, v30
  v_accvgpr_read_b32 v30, a9
  v_mul_f32 v30, v30, v29
  v_accvgpr_write_b32 a9, v30
  v_accvgpr_read_b32 v30, a10
  v_mul_f32 v30, v30, v29
  v_accvgpr_write_b32 a10, v30
  v_accvgpr_read_b32 v30, a11
  v_mul_f32 v30, v30, v29
  v_accvgpr_write_b32 a11, v30
  v_accvgpr_read_b32 v30, a12
  v_mul_f32 v30, v30, v29
  v_accvgpr_write_b32 a12, v30
  v_accvgpr_read_b32 v30, a13
  v_mul_f32 v30, v30, v29
  v_accvgpr_write_b32 a13, v30
  v_accvgpr_read_b32 v30, a14
  v_mul_f32 v30, v30, v29
  v_accvgpr_write_b32 a14, v30
  v_accvgpr_read_b32 v30, a15
  v_mul_f32 v30, v30, v29
  v_accvgpr_write_b32 a15, v30
  v_accvgpr_read_b32 v30, a16
  v_mul_f32 v30, v30, v29
  v_accvgpr_write_b32 a16, v30
  v_accvgpr_read_b32 v30, a17
  v_mul_f32 v30, v30, v29
  v_accvgpr_write_b32 a17, v30
  v_accvgpr_read_b32 v30, a18
  v_mul_f32 v30, v30, v29
  v_accvgpr_write_b32 a18, v30
  v_accvgpr_read_b32 v30, a19
  v_mul_f32 v30, v30, v29
  v_accvgpr_write_b32 a19, v30
  v_accvgpr_read_b32 v30, a20
  v_mul_f32 v30, v30, v29
  v_accvgpr_write_b32 a20, v30
  v_accvgpr_read_b32 v30, a21
  v_mul_f32 v30, v30, v29
  v_accvgpr_write_b32 a21, v30
  v_accvgpr_read_b32 v30, a22
  v_mul_f32 v30, v30, v29
  v_accvgpr_write_b32 a22, v30
  v_accvgpr_read_b32 v30, a23
  v_mul_f32 v30, v30, v29
  v_accvgpr_write_b32 a23, v30
  v_accvgpr_read_b32 v30, a24
  v_mul_f32 v30, v30, v29
  v_accvgpr_write_b32 a24, v30
  v_accvgpr_read_b32 v30, a25
  v_mul_f32 v30, v30, v29
  v_accvgpr_write_b32 a25, v30
  v_accvgpr_read_b32 v30, a26
  v_mul_f32 v30, v30, v29
  v_accvgpr_write_b32 a26, v30
  v_accvgpr_read_b32 v30, a27
  v_mul_f32 v30, v30, v29
  v_accvgpr_write_b32 a27, v30
  v_accvgpr_read_b32 v30, a28
  v_mul_f32 v30, v30, v29
  v_accvgpr_write_b32 a28, v30
  v_accvgpr_read_b32 v30, a29
  v_mul_f32 v30, v30, v29
  v_accvgpr_write_b32 a29, v30
  v_accvgpr_read_b32 v30, a30
  v_mul_f32 v30, v30, v29
  v_accvgpr_write_b32 a30, v30
  v_accvgpr_read_b32 v30, a31
  v_mul_f32 v30, v30, v29
  v_accvgpr_write_b32 a31, v30
  v_accvgpr_read_b32 v30, a32
  v_mul_f32 v30, v30, v29
  v_accvgpr_write_b32 a32, v30
  v_accvgpr_read_b32 v30, a33
  v_mul_f32 v30, v30, v29
  v_accvgpr_write_b32 a33, v30
  v_accvgpr_read_b32 v30, a34
  v_mul_f32 v30, v30, v29
  v_accvgpr_write_b32 a34, v30
  v_accvgpr_read_b32 v30, a35
  v_mul_f32 v30, v30, v29
  v_accvgpr_write_b32 a35, v30
  v_accvgpr_read_b32 v30, a36
  v_mul_f32 v30, v30, v29
  v_accvgpr_write_b32 a36, v30
  v_accvgpr_read_b32 v30, a37
  v_mul_f32 v30, v30, v29
  v_accvgpr_write_b32 a37, v30
  v_accvgpr_read_b32 v30, a38
  v_mul_f32 v30, v30, v29
  v_accvgpr_write_b32 a38, v30
  v_accvgpr_read_b32 v30, a39
  v_mul_f32 v30, v30, v29
  v_accvgpr_write_b32 a39, v30
  v_accvgpr_read_b32 v30, a40
  v_mul_f32 v30, v30, v29
  v_accvgpr_write_b32 a40, v30
  v_accvgpr_read_b32 v30, a41
  v_mul_f32 v30, v30, v29
  v_accvgpr_write_b32 a41, v30
  v_accvgpr_read_b32 v30, a42
  v_mul_f32 v30, v30, v29
  v_accvgpr_write_b32 a42, v30
  v_accvgpr_read_b32 v30, a43
  v_mul_f32 v30, v30, v29
  v_accvgpr_write_b32 a43, v30
  v_accvgpr_read_b32 v30, a44
  v_mul_f32 v30, v30, v29
  v_accvgpr_write_b32 a44, v30
  v_accvgpr_read_b32 v30, a45
  v_mul_f32 v30, v30, v29
  v_accvgpr_write_b32 a45, v30
  v_accvgpr_read_b32 v30, a46
  v_mul_f32 v30, v30, v29
  v_accvgpr_write_b32 a46, v30
  v_accvgpr_read_b32 v30, a47
  v_mul_f32 v30, v30, v29
  v_accvgpr_write_b32 a47, v30
  v_accvgpr_read_b32 v30, a48
  v_mul_f32 v30, v30, v29
  v_accvgpr_write_b32 a48, v30
  v_accvgpr_read_b32 v30, a49
  v_mul_f32 v30, v30, v29
  v_accvgpr_write_b32 a49, v30
  v_accvgpr_read_b32 v30, a50
  v_mul_f32 v30, v30, v29
  v_accvgpr_write_b32 a50, v30
  v_accvgpr_read_b32 v30, a51
  v_mul_f32 v30, v30, v29
  v_accvgpr_write_b32 a51, v30
  v_accvgpr_read_b32 v30, a52
  v_mul_f32 v30, v30, v29
  v_accvgpr_write_b32 a52, v30
  v_accvgpr_read_b32 v30, a53
  v_mul_f32 v30, v30, v29
  v_accvgpr_write_b32 a53, v30
  v_accvgpr_read_b32 v30, a54
  v_mul_f32 v30, v30, v29
  v_accvgpr_write_b32 a54, v30
  v_accvgpr_read_b32 v30, a55
  v_mul_f32 v30, v30, v29
  v_accvgpr_write_b32 a55, v30
  v_accvgpr_read_b32 v30, a56
  v_mul_f32 v30, v30, v29
  v_accvgpr_write_b32 a56, v30
  v_accvgpr_read_b32 v30, a57
  v_mul_f32 v30, v30, v29
  v_accvgpr_write_b32 a57, v30
  v_accvgpr_read_b32 v30, a58
  v_mul_f32 v30, v30, v29
  v_accvgpr_write_b32 a58, v30
  v_accvgpr_read_b32 v30, a59
  v_mul_f32 v30, v30, v29
  v_accvgpr_write_b32 a59, v30
  v_accvgpr_read_b32 v30, a60
  v_mul_f32 v30, v30, v29
  v_accvgpr_write_b32 a60, v30
  v_accvgpr_read_b32 v30, a61
  v_mul_f32 v30, v30, v29
  v_accvgpr_write_b32 a61, v30
  v_accvgpr_read_b32 v30, a62
  v_mul_f32 v30, v30, v29
  v_accvgpr_write_b32 a62, v30
  v_accvgpr_read_b32 v30, a63
  v_mul_f32 v30, v30, v29
  v_accvgpr_write_b32 a63, v30
  v_sub_f32 v160, v160, v28
  v_sub_f32 v128, v128, v28
  v_sub_f32 v161, v161, v28
  v_sub_f32 v129, v129, v28
  v_sub_f32 v162, v162, v28
  v_sub_f32 v130, v130, v28
  v_sub_f32 v163, v163, v28
  v_sub_f32 v131, v131, v28
  v_sub_f32 v164, v164, v28
  v_sub_f32 v132, v132, v28
  v_sub_f32 v165, v165, v28
  v_sub_f32 v133, v133, v28
  v_sub_f32 v166, v166, v28
  v_sub_f32 v134, v134, v28
  v_sub_f32 v167, v167, v28
  v_sub_f32 v135, v135, v28
  v_sub_f32 v168, v168, v28
  v_sub_f32 v136, v136, v28
  v_sub_f32 v169, v169, v28
  v_sub_f32 v137, v137, v28
  v_sub_f32 v170, v170, v28
  v_sub_f32 v138, v138, v28
  v_sub_f32 v171, v171, v28
  v_sub_f32 v139, v139, v28
  v_sub_f32 v172, v172, v28
  v_sub_f32 v140, v140, v28
  v_sub_f32 v173, v173, v28
  v_sub_f32 v141, v141, v28
  v_sub_f32 v174, v174, v28
  v_sub_f32 v142, v142, v28
  v_sub_f32 v175, v175, v28
  v_sub_f32 v143, v143, v28
  v_exp_f32 v16, v128
  v_exp_f32 v17, v129
  v_exp_f32 v18, v130
  v_add_f32 v24, v16, v17
  v_cvt_pk_bf16_f32 v32, v16, v17
  v_exp_f32 v19, v131
  v_add_f32 v24, v24, v18
  v_exp_f32 v20, v132
  v_add_f32 v24, v24, v19
  v_cvt_pk_bf16_f32 v33, v18, v19
  v_exp_f32 v21, v133
  v_add_f32 v24, v24, v20
  v_exp_f32 v22, v134
  v_add_f32 v24, v24, v21
  v_cvt_pk_bf16_f32 v34, v20, v21
  v_exp_f32 v23, v135
  v_add_f32 v24, v24, v22
  v_exp_f32 v16, v136
  v_add_f32 v24, v24, v23
  v_cvt_pk_bf16_f32 v35, v22, v23
  v_exp_f32 v17, v137
  v_add_f32 v24, v24, v16
  v_exp_f32 v18, v138
  v_add_f32 v24, v24, v17
  v_cvt_pk_bf16_f32 v36, v16, v17
  v_exp_f32 v19, v139
  v_add_f32 v24, v24, v18
  v_exp_f32 v20, v140
  v_add_f32 v24, v24, v19
  v_cvt_pk_bf16_f32 v37, v18, v19
  v_exp_f32 v21, v141
  v_add_f32 v24, v24, v20
  v_exp_f32 v22, v142
  v_add_f32 v24, v24, v21
  v_cvt_pk_bf16_f32 v38, v20, v21
  v_exp_f32 v23, v143
  v_add_f32 v24, v24, v22
  v_add_f32 v24, v24, v23
  v_cvt_pk_bf16_f32 v39, v22, v23
  s_nop 7
  s_cmp_eq_u32 s41, 32
  s_cbranch_scc1 RET_32
  s_cmp_eq_u32 s41, 33
  s_cbranch_scc1 RET_33
  s_cmp_eq_u32 s41, 34
  s_cbranch_scc1 RET_34
  s_cmp_eq_u32 s41, 35
  s_cbranch_scc1 RET_35
  s_cmp_eq_u32 s41, 36
  s_cbranch_scc1 RET_36
  s_cmp_eq_u32 s41, 37
  s_cbranch_scc1 RET_37
  s_cmp_eq_u32 s41, 38
  s_cbranch_scc1 RET_38
  s_cmp_eq_u32 s41, 39
  s_cbranch_scc1 RET_39
  s_cmp_eq_u32 s41, 40
  s_cbranch_scc1 RET_40
  s_cmp_eq_u32 s41, 41
  s_cbranch_scc1 RET_41
  s_cmp_eq_u32 s41, 42
  s_cbranch_scc1 RET_42
  s_cmp_eq_u32 s41, 43
  s_cbranch_scc1 RET_43
  s_cmp_eq_u32 s41, 44
  s_cbranch_scc1 RET_44
  s_cmp_eq_u32 s41, 45
  s_cbranch_scc1 RET_45
  s_branch RET_46
.section .rodata,"a"
.p2align 6
.amdhsa_kernel standalone__mha_block_cached__near_ridge_kernel
  .amdhsa_next_free_vgpr 512
  .amdhsa_next_free_sgpr 102
  .amdhsa_accum_offset 256
  .amdhsa_group_segment_fixed_size 0
  .amdhsa_kernarg_size 64
  .amdhsa_user_sgpr_count 2
  .amdhsa_user_sgpr_kernarg_segment_ptr 1
  .amdhsa_system_sgpr_workgroup_id_x 1
.end_amdhsa_kernel
```
